```python
import torch

def _softmax(x, axis=-1):
    return torch.softmax(x, dim=axis)
def _gelu(x):
    return torch.nn.functional.gelu(x, approximate="tanh")
def _silu(x):
    return torch.nn.functional.silu(x)
def _sigmoid(x):
    return torch.sigmoid(x)
def _layernorm(x, axis=-1, eps=1e-5):
    m = x.mean(dim=axis, keepdim=True)
    v = x.var(dim=axis, keepdim=True, unbiased=False)
    return (x - m) / torch.sqrt(v + eps)
def _scatter_add(tgt, idx, src, axis=0):
    return tgt.clone().index_add_(axis, idx, src)
def _segment_sum(src, seg, n):
    out = torch.zeros((n,) + src.shape[1:], dtype=src.dtype)
    return out.index_add_(0, seg, src)
def _pad(x, pw):
    flat = tuple(v for pair in reversed(pw) for v in pair)
    return torch.nn.functional.pad(x, flat)

kernel_name = 'recurrent_scan__sliding_local_dilated__dense_activation_silu__prompt'

def setup_inputs():

    _w = (lambda a: (lambda t: t.to(torch.bfloat16) if t.is_floating_point() else t)(torch.as_tensor(a)))
    def _A_setup():
        B, S, D = 1, 2048, 640
        return {
            "x": _w((lambda *s: torch.randn(*s, dtype=torch.bfloat16) * 0.1)(B, S, D)),
            "wqkv": _w((lambda *s: torch.randn(*s, dtype=torch.bfloat16) * 0.2)(D, 3 * D)),
            "wo": _w((lambda *s: torch.randn(*s, dtype=torch.bfloat16) * 0.4)(D, D)),
        }
    _A_in = _A_setup()

    def _B_setup():
        B, S, D, F = 1, 2048, 640, 1728
        return {
            "x": _w((lambda *s: torch.randn(*s, dtype=torch.bfloat16) * 0.1)(B, S, D)),
            "w1": _w((lambda *s: torch.randn(*s, dtype=torch.bfloat16) * 3.2)(D, F) * (D ** -0.5)),
            "w2": _w((lambda *s: torch.randn(*s, dtype=torch.bfloat16) * 3.2)(F, D) * (F ** -0.5)),
        }
    _B_in = _B_setup()

    return {
        "A_x": _A_in["x"],
        "A_wqkv": _A_in["wqkv"],
        "A_wo": _A_in["wo"],
        "B_x": _B_in["x"],
        "B_w1": _B_in["w1"],
        "B_w2": _B_in["w2"],
    }

def reference(A_x, A_wqkv, A_wo, B_x, B_w1, B_w2):
    def _A_ref(x, wqkv, wo):
        B, S, D = x.shape
        H = 32; Dh = D // H
        W, dil = 8, 2
        qkv = (lambda x, *d: x.permute(*d))((x @ wqkv).reshape(B, S, 3, H, Dh), 2, 0, 3, 1, 4)
        q, k, v = qkv[0], qkv[1], qkv[2]
        scale = Dh ** -0.5
        pos = torch.arange(S)
        off = torch.arange(W) * dil
        idx = pos[:, None] - off[None, :]
        mask = idx >= 0
        idx_c = torch.where(mask, idx, 0).reshape(-1)
        kg = k[:, :, idx_c, :].reshape(B, H, S, W, Dh)
        vg = v[:, :, idx_c, :].reshape(B, H, S, W, Dh)
        logits = torch.einsum("bhsd,bhswd->bhsw", q, kg) * scale
        logits = torch.where(mask[None, None, :, :], logits, -1e9)
        attn = _softmax(logits, axis=-1)
        o = torch.einsum("bhsw,bhswd->bhsd", attn, vg)
        return (lambda x, *d: x.permute(*d))(o, 0, 2, 1, 3).reshape(B, S, D) @ wo

    def _B_ref(x, w1, w2):
        h = torch.einsum("bsd,df->bsf", x, w1)
        h = _silu(h)
        out = torch.einsum("bsf,fd->bsd", h, w2)
        return out

    x = A_x
    xn = _layernorm(x, axis=-1)
    s = _A_ref(xn, A_wqkv, A_wo)
    g = _silu(_B_ref(xn, B_w1, B_w2))
    return x + s * g
```

```asm
; @launch kernel=k1_proj_kernel grid=(256,1,1) block=(512,1,1) lds=162816
; @launch kernel=k2_out_kernel grid=(256,1,1) block=(256,1,1) lds=81920
.amdgcn_target "amdgcn-amd-amdhsa--gfx950"
.text

.macro M d, a, b
v_mfma_f32_16x16x32_bf16 v[\d:\d+3], v[\a:\a+3], v[\b:\b+3], v[\d:\d+3]
.endm
.macro MZ d, a, b
v_mfma_f32_16x16x32_bf16 v[\d:\d+3], v[\a:\a+3], v[\b:\b+3], 0
.endm
.macro RX f, ad, off
ds_read_b128 v[\f:\f+3], v\ad offset:\off
.endm
.macro TR f, ad, off
ds_read_b64_tr_b16 v[\f:\f+1], v\ad offset:\off
.endm
.macro PFN d, m, c
v_pk_fma_f32 v[\d:\d+1], v[\m:\m+1], v[\c:\c+1], v[\d:\d+1] op_sel_hi:[0,1,1] neg_lo:[1,0,0] neg_hi:[1,0,0]
.endm
.macro PMB d, m, c
v_pk_mul_f32 v[\d:\d+1], v[\m:\m+1], v[\c:\c+1] op_sel_hi:[0,1]
.endm
.macro PM d, x, y
v_pk_mul_f32 v[\d:\d+1], v[\x:\x+1], v[\y:\y+1]
.endm
.macro PA d, x, y
v_pk_add_f32 v[\d:\d+1], v[\x:\x+1], v[\y:\y+1]
.endm
.macro CV d, x, y
v_cvt_pk_bf16_f32 v\d, v\x, v\y
.endm
.globl k1_proj_kernel
.p2align 8
.type k1_proj_kernel,@function
k1_proj_kernel:
s_cmp_ge_u32 s2, 256
s_cbranch_scc1 K1_EXIT
s_load_dwordx4 s[4:7], s[0:1], 0
s_load_dwordx2 s[50:51], s[0:1], 16
s_load_dwordx4 s[60:63], s[0:1], 32
s_load_dwordx2 s[16:17], s[0:1], 64
s_mov_b32 s37, s2
s_and_b32 s33, s2, 7
s_lshr_b32 s34, s2, 3
s_lshr_b32 s35, s33, 2
s_lshl_b32 s24, s35, 3
s_and_b32 s35, s34, 7
s_add_u32 s24, s24, s35
s_and_b32 s35, s33, 3
s_lshl_b32 s25, s35, 1
s_bfe_u32 s35, s34, 0x10003
s_add_u32 s25, s25, s35
s_lshr_b32 s35, s34, 4
s_lshl_b32 s35, s35, 3
s_add_u32 s25, s25, s35
v_lshrrev_b32 v14, 6, v0
v_and_b32 v1, 63, v0
s_mov_b32 s10, 2621440
v_readfirstlane_b32 s26, v14
s_mov_b32 s11, 0x00020000
s_mov_b32 s18, 14680064
s_mov_b32 s19, 0x00020000
s_mov_b32 s15, 0x00020000
s_mov_b32 s42, 0xffff
s_lshl_b32 s32, s24, 7
s_sub_u32 s32, s32, 16
s_cmp_ge_u32 s25, 8
s_cbranch_scc1 K1_FFN
s_mov_b32 s14, 2457600
s_mul_i32 s36, s25, 160
s_cmp_eq_u32 s26, 0
s_cbranch_scc1 K1_ATT0
s_cmp_eq_u32 s26, 1
s_cbranch_scc1 K1_ATT1
s_cmp_eq_u32 s26, 2
s_cbranch_scc1 K1_ATT2
s_cmp_eq_u32 s26, 3
s_cbranch_scc1 K1_ATT3
s_cmp_eq_u32 s26, 4
s_cbranch_scc1 K1_ATT4
s_cmp_eq_u32 s26, 5
s_cbranch_scc1 K1_ATT5
s_cmp_eq_u32 s26, 6
s_cbranch_scc1 K1_ATT6
s_cmp_eq_u32 s26, 7
s_cbranch_scc1 K1_ATT7
s_endpgm
K1_FFN:
s_mov_b32 s14, 2211840
s_sub_u32 s25, s25, 8
s_mul_i32 s36, s25, 448
s_cmp_eq_u32 s26, 0
s_cbranch_scc1 K1_FFN0
s_cmp_eq_u32 s26, 1
s_cbranch_scc1 K1_FFN1
s_cmp_eq_u32 s26, 2
s_cbranch_scc1 K1_FFN2
s_cmp_eq_u32 s26, 3
s_cbranch_scc1 K1_FFN3
s_cmp_eq_u32 s26, 4
s_cbranch_scc1 K1_FFN4
s_cmp_eq_u32 s26, 5
s_cbranch_scc1 K1_FFN5
s_cmp_eq_u32 s26, 6
s_cbranch_scc1 K1_FFN6
s_cmp_eq_u32 s26, 7
s_cbranch_scc1 K1_FFN7
K1_EXIT:
s_endpgm
K1_ATT0:
v_lshrrev_b32 v14, 3, v1
v_and_b32 v15, 7, v1
v_xor_b32 v15, v15, v14
v_lshlrev_b32 v15, 4, v15
s_mov_b32 s30, 0
s_mov_b32 s31, 0
s_mov_b32 s29, 0
s_mov_b32 s28, 0
s_mov_b32 s43, 245760
s_mov_b32 s38, 128
s_mov_b32 s39, 49152
s_add_i32 s33, s32, 0
v_add_u32 v2, s33, v14
v_max_i32 v2, 0, v2
v_mul_u32_u24 v2, 1280, v2
v_add_u32 v2, v2, v15
s_waitcnt lgkmcnt(0)
s_mov_b32 s8, s4
s_mov_b32 s9, s5
s_mov_b32 s52, s62
s_mov_b32 s53, s63
s_mov_b32 s12, s6
s_mov_b32 s13, s7
s_add_u32 m0, s29, 0
s_nop 0
buffer_load_dwordx4 v2, s[8:11], s30 offen lds
s_add_i32 s33, s32, 64
v_add_u32 v3, s33, v14
v_max_i32 v3, 0, v3
v_mul_u32_u24 v3, 1280, v3
v_add_u32 v3, v3, v15
s_add_u32 m0, s29, 8192
s_nop 0
buffer_load_dwordx4 v3, s[8:11], s30 offen lds
s_add_i32 s33, s32, 128
v_add_u32 v4, s33, v14
v_max_i32 v4, 0, v4
v_mul_u32_u24 v4, 1280, v4
v_add_u32 v4, v4, v15
s_add_u32 m0, s29, 16384
s_nop 0
buffer_load_dwordx4 v4, s[8:11], s30 offen lds
v_add_u32 v16, 384, v1
v_mul_u32_u24 v17, 2185, v16
v_lshrrev_b32 v17, 16, v17
v_mul_u32_u24 v18, 30, v17
v_sub_u32 v18, v16, v18
v_and_b32 v19, 0x33, v17
v_and_b32 v20, 4, v17
v_lshl_or_b32 v19, v20, 1, v19
v_bfe_u32 v20, v17, 3, 1
v_lshl_or_b32 v19, v20, 2, v19
v_mul_u32_u24 v20, 6554, v18
v_lshrrev_b32 v20, 16, v20
v_mul_u32_u24 v20, 1120, v20
v_lshl_add_u32 v18, v18, 4, v20
v_mul_u32_u24 v5, 3840, v19
v_add3_u32 v5, v5, v18, s36
s_add_u32 m0, s29, 24576
s_nop 0
buffer_load_dwordx4 v5, s[12:15], s31 offen lds
v_add_u32 v16, 896, v1
v_mul_u32_u24 v17, 2185, v16
v_lshrrev_b32 v17, 16, v17
v_mul_u32_u24 v18, 30, v17
v_sub_u32 v18, v16, v18
v_and_b32 v19, 0x33, v17
v_and_b32 v20, 4, v17
v_lshl_or_b32 v19, v20, 1, v19
v_bfe_u32 v20, v17, 3, 1
v_lshl_or_b32 v19, v20, 2, v19
v_mul_u32_u24 v20, 6554, v18
v_lshrrev_b32 v20, 16, v20
v_mul_u32_u24 v20, 1120, v20
v_lshl_add_u32 v18, v18, 4, v20
v_mul_u32_u24 v6, 3840, v19
v_add3_u32 v6, v6, v18, s36
s_add_u32 m0, s29, 32768
s_nop 0
buffer_load_dwordx4 v6, s[12:15], s31 offen lds
v_add_u32 v16, 1408, v1
v_mul_u32_u24 v17, 2185, v16
v_lshrrev_b32 v17, 16, v17
v_mul_u32_u24 v18, 30, v17
v_sub_u32 v18, v16, v18
v_and_b32 v19, 0x33, v17
v_and_b32 v20, 4, v17
v_lshl_or_b32 v19, v20, 1, v19
v_bfe_u32 v20, v17, 3, 1
v_lshl_or_b32 v19, v20, 2, v19
v_mul_u32_u24 v20, 6554, v18
v_lshrrev_b32 v20, 16, v20
v_mul_u32_u24 v20, 1120, v20
v_lshl_add_u32 v18, v18, 4, v20
v_mul_u32_u24 v7, 3840, v19
v_add3_u32 v7, v7, v18, s36
s_add_u32 m0, s29, 40960
s_nop 0
buffer_load_dwordx4 v7, s[12:15], s31 offen lds
s_add_u32 s30, s30, s38
s_add_u32 s31, s31, s43
s_add_u32 s29, s29, s39
s_cmp_eq_u32 s29, 147456
s_cselect_b32 s29, 0, s29
s_cmp_eq_u32 s30, 1280
s_cselect_b32 s30, 0, s30
s_cselect_b32 s31, 0, s31
s_cselect_b32 s38, 0, s38
s_cselect_b32 s43, 0, s43
s_cselect_b32 s39, 0, s39
s_cselect_b32 s29, 0x30000, s29
s_cselect_b32 s10, 0, s10
s_cselect_b32 s14, 0, s14
s_add_u32 m0, s29, 0
s_nop 0
buffer_load_dwordx4 v2, s[8:11], s30 offen lds
s_add_u32 m0, s29, 8192
s_nop 0
buffer_load_dwordx4 v3, s[8:11], s30 offen lds
s_add_u32 m0, s29, 16384
s_nop 0
buffer_load_dwordx4 v4, s[8:11], s30 offen lds
s_add_u32 m0, s29, 24576
s_nop 0
buffer_load_dwordx4 v5, s[12:15], s31 offen lds
s_add_u32 m0, s29, 32768
s_nop 0
buffer_load_dwordx4 v6, s[12:15], s31 offen lds
s_add_u32 m0, s29, 40960
s_nop 0
buffer_load_dwordx4 v7, s[12:15], s31 offen lds
s_add_u32 s30, s30, s38
s_add_u32 s31, s31, s43
s_add_u32 s29, s29, s39
s_cmp_eq_u32 s29, 147456
s_cselect_b32 s29, 0, s29
s_cmp_eq_u32 s30, 1280
s_cselect_b32 s30, 0, s30
s_cselect_b32 s31, 0, s31
s_cselect_b32 s38, 0, s38
s_cselect_b32 s43, 0, s43
s_cselect_b32 s39, 0, s39
s_cselect_b32 s29, 0x30000, s29
s_cselect_b32 s10, 0, s10
s_cselect_b32 s14, 0, s14
s_add_u32 s42, s37, 0
s_cmp_ge_u32 s42, 592
s_cbranch_scc1 RLS1
s_mov_b32 s22, 2211840
s_mov_b32 s23, 0x00020000
s_sub_u32 s35, s42, 432
s_cmp_ge_u32 s42, 432
s_cselect_b32 s20, s50, s52
s_cselect_b32 s21, s51, s53
s_cselect_b32 s22, 819200, s22
s_cselect_b32 s35, s35, s42
s_lshr_b32 s33, s35, 3
s_and_b32 s34, s35, 7
s_mul_i32 s33, s33, 40960
s_mul_i32 s34, s34, 160
s_add_u32 s33, s33, s34
v_add_u32 v16, 0, v1
v_mul_u32_u24 v17, 6554, v16
v_lshrrev_b32 v17, 16, v17
v_mul_u32_u24 v18, 10, v17
v_sub_u32 v18, v16, v18
v_lshlrev_b32 v18, 4, v18
v_mul_u32_u24 v17, 1280, v17
v_add_u32 v18, v18, v17
s_mov_b32 m0, 147456
s_nop 0
buffer_load_dwordx4 v18, s[20:23], s33 offen lds
v_add_u32 v16, 64, v1
v_mul_u32_u24 v17, 6554, v16
v_lshrrev_b32 v17, 16, v17
v_mul_u32_u24 v18, 10, v17
v_sub_u32 v18, v16, v18
v_lshlrev_b32 v18, 4, v18
v_mul_u32_u24 v17, 1280, v17
v_add_u32 v18, v18, v17
s_mov_b32 m0, 148480
s_nop 0
buffer_load_dwordx4 v18, s[20:23], s33 offen lds
v_add_u32 v16, 128, v1
v_mul_u32_u24 v17, 6554, v16
v_lshrrev_b32 v17, 16, v17
v_mul_u32_u24 v18, 10, v17
v_sub_u32 v18, v16, v18
v_lshlrev_b32 v18, 4, v18
v_mul_u32_u24 v17, 1280, v17
v_add_u32 v18, v18, v17
s_mov_b32 m0, 149504
s_nop 0
buffer_load_dwordx4 v18, s[20:23], s33 offen lds
v_add_u32 v16, 192, v1
v_mul_u32_u24 v17, 6554, v16
v_lshrrev_b32 v17, 16, v17
v_mul_u32_u24 v18, 10, v17
v_sub_u32 v18, v16, v18
v_lshlrev_b32 v18, 4, v18
v_mul_u32_u24 v17, 1280, v17
v_add_u32 v18, v18, v17
s_mov_b32 m0, 150528
s_nop 0
buffer_load_dwordx4 v18, s[20:23], s33 offen lds
v_add_u32 v16, 256, v1
v_mul_u32_u24 v17, 6554, v16
v_lshrrev_b32 v17, 16, v17
v_mul_u32_u24 v18, 10, v17
v_sub_u32 v18, v16, v18
v_lshlrev_b32 v18, 4, v18
v_mul_u32_u24 v17, 1280, v17
v_add_u32 v18, v18, v17
s_mov_b32 m0, 151552
s_nop 0
buffer_load_dwordx4 v18, s[20:23], s33 offen lds
RLS1:
v_and_b32 v14, 15, v1
v_lshrrev_b32 v15, 4, v1
v_and_b32 v16, 7, v14
v_xor_b32 v16, v16, v15
v_lshlrev_b32 v16, 4, v16
v_lshl_add_u32 v11, v14, 7, v16
v_xor_b32 v12, 64, v11
v_cmp_eq_u32 s[44:45], 0, v14
v_lshrrev_b32 v16, 1, v15
v_lshlrev_b32 v16, 4, v16
v_and_b32 v17, 1, v15
v_lshl_add_u32 v16, v17, 2, v16
v_bfe_u32 v17, v1, 2, 2
v_add_u32 v16, v16, v17
v_mul_u32_u24 v16, 480, v16
v_and_b32 v17, 3, v1
v_lshl_add_u32 v16, v17, 3, v16
v_add_u32 v13, 18432, v16
v_mov_b32 v132, 0
v_mov_b32 v133, 0
v_mov_b32 v134, 0
v_mov_b32 v135, 0
v_mov_b32 v136, 0
v_mov_b32 v137, 0
v_mov_b32 v138, 0
v_mov_b32 v139, 0
v_mov_b32 v140, 0
v_mov_b32 v141, 0
v_mov_b32 v142, 0
v_mov_b32 v143, 0
v_mov_b32 v144, 0
v_mov_b32 v145, 0
v_mov_b32 v146, 0
v_mov_b32 v147, 0
v_mov_b32 v148, 0
v_mov_b32 v149, 0
v_mov_b32 v150, 0
v_mov_b32 v151, 0
v_mov_b32 v152, 0
v_mov_b32 v153, 0
v_mov_b32 v154, 0
v_mov_b32 v155, 0
v_mov_b32 v156, 0
v_mov_b32 v157, 0
v_mov_b32 v158, 0
v_mov_b32 v159, 0
v_mov_b32 v160, 0
v_mov_b32 v161, 0
v_mov_b32 v162, 0
v_mov_b32 v163, 0
v_mov_b32 v164, 0
v_mov_b32 v165, 0
v_mov_b32 v166, 0
v_mov_b32 v167, 0
v_mov_b32 v168, 0
v_mov_b32 v169, 0
v_mov_b32 v170, 0
v_mov_b32 v171, 0
v_mov_b32 v172, 0
v_mov_b32 v173, 0
v_mov_b32 v174, 0
v_mov_b32 v175, 0
v_mov_b32 v176, 0
v_mov_b32 v177, 0
v_mov_b32 v178, 0
v_mov_b32 v179, 0
v_mov_b32 v180, 0
v_mov_b32 v181, 0
v_mov_b32 v182, 0
v_mov_b32 v183, 0
v_mov_b32 v184, 0
v_mov_b32 v185, 0
v_mov_b32 v186, 0
v_mov_b32 v187, 0
v_mov_b32 v188, 0
v_mov_b32 v189, 0
v_mov_b32 v190, 0
v_mov_b32 v191, 0
v_mov_b32 v192, 0
v_mov_b32 v193, 0
v_mov_b32 v194, 0
v_mov_b32 v195, 0
v_mov_b32 v196, 0
v_mov_b32 v197, 0
v_mov_b32 v198, 0
v_mov_b32 v199, 0
v_mov_b32 v200, 0
v_mov_b32 v201, 0
v_mov_b32 v202, 0
v_mov_b32 v203, 0
v_mov_b32 v204, 0
v_mov_b32 v205, 0
v_mov_b32 v206, 0
v_mov_b32 v207, 0
v_mov_b32 v32, 0x3f803f80
v_mov_b32 v33, 0x3f803f80
v_mov_b32 v34, 0x3f803f80
v_mov_b32 v35, 0x3f803f80
s_cmp_ge_u32 s42, 592
s_cbranch_scc1 FW2
s_waitcnt vmcnt(11)
s_branch FW3
FW2:
s_waitcnt vmcnt(6)
FW3:
s_barrier
v_add_u32 v8, s28, v11
v_add_u32 v9, s28, v12
v_add_u32 v10, s28, v13
RX 40,8,2048
RX 44,8,4096
RX 48,8,6144
RX 52,8,8192
TR 56,10,0
TR 58,10,3840
RX 36,8,0
TR 60,10,32
TR 62,10,3872
TR 64,10,64
TR 66,10,3904
TR 68,10,96
TR 70,10,3936
s_add_u32 m0, s29, 0
s_nop 0
buffer_load_dwordx4 v2, s[8:11], s30 offen lds
s_add_u32 m0, s29, 8192
s_nop 0
buffer_load_dwordx4 v3, s[8:11], s30 offen lds
s_add_u32 m0, s29, 16384
s_nop 0
buffer_load_dwordx4 v4, s[8:11], s30 offen lds
s_add_u32 m0, s29, 24576
s_nop 0
buffer_load_dwordx4 v5, s[12:15], s31 offen lds
s_add_u32 m0, s29, 32768
s_nop 0
buffer_load_dwordx4 v6, s[12:15], s31 offen lds
s_add_u32 m0, s29, 40960
s_nop 0
buffer_load_dwordx4 v7, s[12:15], s31 offen lds
s_add_u32 s30, s30, s38
s_add_u32 s31, s31, s43
s_add_u32 s29, s29, s39
s_cmp_eq_u32 s29, 147456
s_cselect_b32 s29, 0, s29
s_cmp_eq_u32 s30, 1280
s_cselect_b32 s30, 0, s30
s_cselect_b32 s31, 0, s31
s_cselect_b32 s38, 0, s38
s_cselect_b32 s43, 0, s43
s_cselect_b32 s39, 0, s39
s_cselect_b32 s29, 0x30000, s29
s_cselect_b32 s10, 0, s10
s_cselect_b32 s14, 0, s14
s_mov_b32 s27, 0
s_waitcnt lgkmcnt(0)
K1Latt0:
M 132,56,40
RX 88,9,2048
M 136,56,44
RX 92,9,4096
M 140,56,48
RX 96,9,6144
M 144,56,52
RX 100,9,8192
M 148,60,40
TR 104,10,15360
M 152,60,44
TR 106,10,19200
M 156,60,48
RX 84,9,0
M 160,60,52
TR 108,10,15392
M 164,64,40
TR 110,10,19232
M 168,64,44
TR 112,10,15424
M 172,64,48
TR 114,10,19264
M 176,64,52
TR 116,10,15456
M 180,68,40
TR 118,10,19296
v_cndmask_b32 v36, v36, v32, s[44:45]
v_cndmask_b32 v37, v37, v32, s[44:45]
v_cndmask_b32 v38, v38, v32, s[44:45]
v_cndmask_b32 v39, v39, v32, s[44:45]
M 184,68,44
M 188,68,48
s_add_u32 s28, s28, 49152
s_cmp_eq_u32 s28, 147456
s_cselect_b32 s28, 0, s28
M 192,68,52
v_add_u32 v8, s28, v11
v_add_u32 v9, s28, v12
v_add_u32 v10, s28, v13
M 196,56,36
s_cmp_eq_u32 s27, 9
M 200,32,40
M 204,40,40
s_cbranch_scc1 K1Eatt0
s_waitcnt vmcnt(6) lgkmcnt(0)
s_barrier
M 132,104,88
s_add_u32 m0, s29, 0
RX 40,8,2048
buffer_load_dwordx4 v2, s[8:11], s30 offen lds
M 136,104,92
s_add_u32 m0, s29, 8192
RX 44,8,4096
buffer_load_dwordx4 v3, s[8:11], s30 offen lds
M 140,104,96
s_add_u32 m0, s29, 16384
RX 48,8,6144
buffer_load_dwordx4 v4, s[8:11], s30 offen lds
M 144,104,100
s_add_u32 m0, s29, 24576
RX 52,8,8192
buffer_load_dwordx4 v5, s[12:15], s31 offen lds
M 148,108,88
s_add_u32 m0, s29, 32768
TR 56,10,0
buffer_load_dwordx4 v6, s[12:15], s31 offen lds
M 152,108,92
s_add_u32 m0, s29, 40960
TR 58,10,3840
buffer_load_dwordx4 v7, s[12:15], s31 offen lds
M 156,108,96
RX 36,8,0
M 160,108,100
TR 60,10,32
M 164,112,88
TR 62,10,3872
M 168,112,92
TR 64,10,64
M 172,112,96
TR 66,10,3904
M 176,112,100
TR 68,10,96
M 180,116,88
TR 70,10,3936
v_cndmask_b32 v84, v84, v32, s[44:45]
v_cndmask_b32 v85, v85, v32, s[44:45]
v_cndmask_b32 v86, v86, v32, s[44:45]
v_cndmask_b32 v87, v87, v32, s[44:45]
M 184,116,92
s_add_u32 s30, s30, s38
s_add_u32 s31, s31, s43
s_add_u32 s29, s29, s39
M 188,116,96
s_cmp_eq_u32 s29, 147456
s_cselect_b32 s29, 0, s29
s_cmp_eq_u32 s30, 1280
M 192,116,100
s_cselect_b32 s30, 0, s30
s_cselect_b32 s31, 0, s31
s_cselect_b32 s38, 0, s38
M 196,104,84
s_cselect_b32 s43, 0, s43
s_cselect_b32 s39, 0, s39
s_cselect_b32 s29, 0x30000, s29
M 200,32,88
s_cselect_b32 s10, 0, s10
s_cselect_b32 s14, 0, s14
s_add_u32 s27, s27, 1
M 204,88,88
s_waitcnt lgkmcnt(0)
s_branch K1Latt0
K1Eatt0:
s_waitcnt lgkmcnt(0)
M 132,104,88
M 136,104,92
M 140,104,96
M 144,104,100
M 148,108,88
M 152,108,92
M 156,108,96
M 160,108,100
M 164,112,88
M 168,112,92
M 172,112,96
M 176,112,100
M 180,116,88
v_cndmask_b32 v84, v84, v32, s[44:45]
v_cndmask_b32 v85, v85, v32, s[44:45]
v_cndmask_b32 v86, v86, v32, s[44:45]
v_cndmask_b32 v87, v87, v32, s[44:45]
M 184,116,92
M 188,116,96
M 192,116,100
M 196,104,84
M 200,32,88
M 204,88,88
s_waitcnt vmcnt(0)
s_cmp_ge_u32 s42, 592
s_cbranch_scc1 RLO4
v_lshrrev_b32 v220, 2, v1
v_mul_u32_u24 v220, 160, v220
v_and_b32 v221, 3, v1
v_lshl_add_u32 v220, v221, 3, v220
v_add_u32 v220, 147456, v220
TR 224,220,0
TR 226,220,2560
TR 228,220,32
TR 230,220,2592
TR 232,220,64
TR 234,220,2624
TR 236,220,96
TR 238,220,2656
TR 240,220,128
TR 242,220,2688
s_sub_u32 s35, s42, 432
s_mov_b32 s33, 10485760
s_cmp_ge_u32 s42, 432
s_cselect_b32 s35, s35, s42
s_cselect_b32 s36, 20, 54
s_cselect_b32 s33, 13631488, s33
s_lshr_b32 s34, s35, 3
s_and_b32 s35, s35, 7
s_mul_i32 s35, s35, s36
s_add_u32 s35, s35, s34
s_mul_i32 s35, s35, 5120
s_add_u32 s33, s33, s35
s_add_u32 s34, s33, 4096
v_lshlrev_b32 v221, 4, v1
s_waitcnt lgkmcnt(0)
buffer_store_dwordx4 v[224:227], v221, s[16:19], s33 offen offset:0
buffer_store_dwordx4 v[228:231], v221, s[16:19], s33 offen offset:1024
buffer_store_dwordx4 v[232:235], v221, s[16:19], s33 offen offset:2048
buffer_store_dwordx4 v[236:239], v221, s[16:19], s33 offen offset:3072
buffer_store_dwordx4 v[240:243], v221, s[16:19], s34 offen
RLO4:
v_and_b32 v14, 15, v1
v_lshrrev_b32 v15, 4, v1
v_lshrrev_b32 v16, 2, v14
v_and_b32 v17, 3, v14
v_cmp_eq_u32 s[46:47], v16, v15
v_cmp_eq_u32 s[48:49], 1, v17
v_cmp_eq_u32 s[54:55], 2, v17
v_cmp_eq_u32 s[56:57], 3, v17
v_lshlrev_b32 v18, 2, v14
v_add_u32 v18, 98304, v18
s_mov_b32 s33, 0x3acccccd
s_mov_b32 s34, 0x3727c5ac
v_cndmask_b32 v204, v204, v205, s[48:49]
v_cndmask_b32 v204, v204, v206, s[54:55]
v_cndmask_b32 v204, v204, v207, s[56:57]
v_mul_f32 v200, s33, v200
v_mul_f32 v204, s33, v204
v_fma_f32 v204, -v200, v200, v204
v_max_f32 v204, 0, v204
v_add_f32 v204, s34, v204
v_rsq_f32 v204, v204
s_mov_b64 exec, s[46:47]
ds_write_b32 v18, v200 offset:64
ds_write_b32 v18, v204 offset:640
s_mov_b64 exec, -1
v_add_u32 v19, 98304, v1
s_mov_b64 exec, s[44:45]
ds_write_b128 v19, v[196:199] offset:1152
s_mov_b64 exec, -1
s_waitcnt lgkmcnt(0)
s_barrier
v_and_b32 v14, 15, v1
v_lshlrev_b32 v14, 2, v14
v_lshrrev_b32 v15, 4, v1
v_lshlrev_b32 v15, 4, v15
v_add_u32 v14, 98304, v14
v_add_u32 v15, 98304, v15
ds_read_b32 v36, v14 offset:64
ds_read_b32 v38, v14 offset:640
ds_read_b32 v42, v14 offset:128
ds_read_b32 v44, v14 offset:704
ds_read_b32 v48, v14 offset:192
ds_read_b32 v50, v14 offset:768
ds_read_b32 v54, v14 offset:256
ds_read_b32 v56, v14 offset:832
ds_read_b128 v[60:63], v15 offset:1152
ds_read_b128 v[64:67], v15 offset:1216
ds_read_b128 v[68:71], v15 offset:1280
ds_read_b128 v[72:75], v15 offset:1344
s_waitcnt lgkmcnt(0)
v_lshlrev_b32 v16, 3, v1
v_and_b32 v17, 15, v1
v_lshrrev_b32 v18, 4, v1
v_lshlrev_b32 v18, 3, v18
v_lshl_add_u32 v17, v17, 5, v18
v_add_u32 v18, 32768, v16
v_add_u32 v19, 32768, v17
PFN 132,36,60
PFN 134,36,62
PMB 132,38,132
PMB 134,38,134
CV 132,132,133
CV 133,134,135
PFN 136,42,60
PFN 138,42,62
PMB 136,44,136
PMB 138,44,138
CV 136,136,137
CV 137,138,139
PFN 140,48,60
PFN 142,48,62
PMB 140,50,140
PMB 142,50,142
CV 140,140,141
CV 141,142,143
PFN 144,54,60
PFN 146,54,62
PMB 144,56,144
PMB 146,56,146
CV 144,144,145
CV 145,146,147
PFN 148,36,64
PFN 150,36,66
PMB 148,38,148
PMB 150,38,150
CV 148,148,149
CV 149,150,151
PFN 152,42,64
PFN 154,42,66
PMB 152,44,152
PMB 154,44,154
CV 152,152,153
CV 153,154,155
PFN 156,48,64
PFN 158,48,66
PMB 156,50,156
PMB 158,50,158
CV 156,156,157
CV 157,158,159
PFN 160,54,64
PFN 162,54,66
PMB 160,56,160
PMB 162,56,162
CV 160,160,161
CV 161,162,163
PFN 164,36,68
PFN 166,36,70
PMB 164,38,164
PMB 166,38,166
CV 164,164,165
CV 165,166,167
PFN 168,42,68
PFN 170,42,70
PMB 168,44,168
PMB 170,44,170
CV 168,168,169
CV 169,170,171
PFN 172,48,68
PFN 174,48,70
PMB 172,50,172
PMB 174,50,174
CV 172,172,173
CV 173,174,175
PFN 176,54,68
PFN 178,54,70
PMB 176,56,176
PMB 178,56,178
CV 176,176,177
CV 177,178,179
PFN 180,36,72
PFN 182,36,74
PMB 180,38,180
PMB 182,38,182
CV 180,180,181
CV 181,182,183
PFN 184,42,72
PFN 186,42,74
PMB 184,44,184
PMB 186,44,186
CV 184,184,185
CV 185,186,187
PFN 188,48,72
PFN 190,48,74
PMB 188,50,188
PMB 190,50,190
CV 188,188,189
CV 189,190,191
PFN 192,54,72
PFN 194,54,74
PMB 192,56,192
PMB 194,56,194
CV 192,192,193
CV 193,194,195
ds_write_b64 v16, v[132:133] offset:7680
ds_write_b64 v16, v[136:137] offset:15360
ds_write_b64 v16, v[140:141] offset:23040
ds_write_b64 v16, v[144:145] offset:30720
ds_write_b64 v16, v[148:149] offset:8192
ds_write_b64 v16, v[152:153] offset:15872
ds_write_b64 v16, v[156:157] offset:23552
ds_write_b64 v16, v[160:161] offset:31232
ds_write_b64 v16, v[164:165] offset:8704
ds_write_b64 v16, v[168:169] offset:16384
ds_write_b64 v16, v[172:173] offset:24064
ds_write_b64 v16, v[176:177] offset:31744
ds_write_b64 v16, v[180:181] offset:9216
ds_write_b64 v16, v[184:185] offset:16896
ds_write_b64 v16, v[188:189] offset:24576
ds_write_b64 v16, v[192:193] offset:32256
s_waitcnt lgkmcnt(0)
s_branch K1_ATTN
K1_ATT1:
v_lshrrev_b32 v14, 3, v1
v_and_b32 v15, 7, v1
v_xor_b32 v15, v15, v14
v_lshlrev_b32 v15, 4, v15
s_mov_b32 s30, 0
s_mov_b32 s31, 0
s_mov_b32 s29, 0
s_mov_b32 s28, 0
s_mov_b32 s43, 245760
s_mov_b32 s38, 128
s_mov_b32 s39, 49152
s_add_i32 s33, s32, 8
v_add_u32 v2, s33, v14
v_max_i32 v2, 0, v2
v_mul_u32_u24 v2, 1280, v2
v_add_u32 v2, v2, v15
s_waitcnt lgkmcnt(0)
s_mov_b32 s8, s4
s_mov_b32 s9, s5
s_mov_b32 s52, s62
s_mov_b32 s53, s63
s_mov_b32 s12, s6
s_mov_b32 s13, s7
s_add_u32 m0, s29, 1024
s_nop 0
buffer_load_dwordx4 v2, s[8:11], s30 offen lds
s_add_i32 s33, s32, 72
v_add_u32 v3, s33, v14
v_max_i32 v3, 0, v3
v_mul_u32_u24 v3, 1280, v3
v_add_u32 v3, v3, v15
s_add_u32 m0, s29, 9216
s_nop 0
buffer_load_dwordx4 v3, s[8:11], s30 offen lds
s_add_i32 s33, s32, 136
v_add_u32 v4, s33, v14
v_max_i32 v4, 0, v4
v_mul_u32_u24 v4, 1280, v4
v_add_u32 v4, v4, v15
s_add_u32 m0, s29, 17408
s_nop 0
buffer_load_dwordx4 v4, s[8:11], s30 offen lds
v_add_u32 v16, 448, v1
v_mul_u32_u24 v17, 2185, v16
v_lshrrev_b32 v17, 16, v17
v_mul_u32_u24 v18, 30, v17
v_sub_u32 v18, v16, v18
v_and_b32 v19, 0x33, v17
v_and_b32 v20, 4, v17
v_lshl_or_b32 v19, v20, 1, v19
v_bfe_u32 v20, v17, 3, 1
v_lshl_or_b32 v19, v20, 2, v19
v_mul_u32_u24 v20, 6554, v18
v_lshrrev_b32 v20, 16, v20
v_mul_u32_u24 v20, 1120, v20
v_lshl_add_u32 v18, v18, 4, v20
v_mul_u32_u24 v5, 3840, v19
v_add3_u32 v5, v5, v18, s36
s_add_u32 m0, s29, 25600
s_nop 0
buffer_load_dwordx4 v5, s[12:15], s31 offen lds
v_add_u32 v16, 960, v1
v_mul_u32_u24 v17, 2185, v16
v_lshrrev_b32 v17, 16, v17
v_mul_u32_u24 v18, 30, v17
v_sub_u32 v18, v16, v18
v_and_b32 v19, 0x33, v17
v_and_b32 v20, 4, v17
v_lshl_or_b32 v19, v20, 1, v19
v_bfe_u32 v20, v17, 3, 1
v_lshl_or_b32 v19, v20, 2, v19
v_mul_u32_u24 v20, 6554, v18
v_lshrrev_b32 v20, 16, v20
v_mul_u32_u24 v20, 1120, v20
v_lshl_add_u32 v18, v18, 4, v20
v_mul_u32_u24 v6, 3840, v19
v_add3_u32 v6, v6, v18, s36
s_add_u32 m0, s29, 33792
s_nop 0
buffer_load_dwordx4 v6, s[12:15], s31 offen lds
v_add_u32 v16, 1472, v1
v_mul_u32_u24 v17, 2185, v16
v_lshrrev_b32 v17, 16, v17
v_mul_u32_u24 v18, 30, v17
v_sub_u32 v18, v16, v18
v_and_b32 v19, 0x33, v17
v_and_b32 v20, 4, v17
v_lshl_or_b32 v19, v20, 1, v19
v_bfe_u32 v20, v17, 3, 1
v_lshl_or_b32 v19, v20, 2, v19
v_mul_u32_u24 v20, 6554, v18
v_lshrrev_b32 v20, 16, v20
v_mul_u32_u24 v20, 1120, v20
v_lshl_add_u32 v18, v18, 4, v20
v_mul_u32_u24 v7, 3840, v19
v_add3_u32 v7, v7, v18, s36
s_add_u32 m0, s29, 41984
s_nop 0
buffer_load_dwordx4 v7, s[12:15], s31 offen lds
s_add_u32 s30, s30, s38
s_add_u32 s31, s31, s43
s_add_u32 s29, s29, s39
s_cmp_eq_u32 s29, 147456
s_cselect_b32 s29, 0, s29
s_cmp_eq_u32 s30, 1280
s_cselect_b32 s30, 0, s30
s_cselect_b32 s31, 0, s31
s_cselect_b32 s38, 0, s38
s_cselect_b32 s43, 0, s43
s_cselect_b32 s39, 0, s39
s_cselect_b32 s29, 0x30000, s29
s_cselect_b32 s10, 0, s10
s_cselect_b32 s14, 0, s14
s_add_u32 m0, s29, 1024
s_nop 0
buffer_load_dwordx4 v2, s[8:11], s30 offen lds
s_add_u32 m0, s29, 9216
s_nop 0
buffer_load_dwordx4 v3, s[8:11], s30 offen lds
s_add_u32 m0, s29, 17408
s_nop 0
buffer_load_dwordx4 v4, s[8:11], s30 offen lds
s_add_u32 m0, s29, 25600
s_nop 0
buffer_load_dwordx4 v5, s[12:15], s31 offen lds
s_add_u32 m0, s29, 33792
s_nop 0
buffer_load_dwordx4 v6, s[12:15], s31 offen lds
s_add_u32 m0, s29, 41984
s_nop 0
buffer_load_dwordx4 v7, s[12:15], s31 offen lds
s_add_u32 s30, s30, s38
s_add_u32 s31, s31, s43
s_add_u32 s29, s29, s39
s_cmp_eq_u32 s29, 147456
s_cselect_b32 s29, 0, s29
s_cmp_eq_u32 s30, 1280
s_cselect_b32 s30, 0, s30
s_cselect_b32 s31, 0, s31
s_cselect_b32 s38, 0, s38
s_cselect_b32 s43, 0, s43
s_cselect_b32 s39, 0, s39
s_cselect_b32 s29, 0x30000, s29
s_cselect_b32 s10, 0, s10
s_cselect_b32 s14, 0, s14
s_add_u32 s42, s37, 256
s_cmp_ge_u32 s42, 592
s_cbranch_scc1 RLS5
s_mov_b32 s22, 2211840
s_mov_b32 s23, 0x00020000
s_sub_u32 s35, s42, 432
s_cmp_ge_u32 s42, 432
s_cselect_b32 s20, s50, s52
s_cselect_b32 s21, s51, s53
s_cselect_b32 s22, 819200, s22
s_cselect_b32 s35, s35, s42
s_lshr_b32 s33, s35, 3
s_and_b32 s34, s35, 7
s_mul_i32 s33, s33, 40960
s_mul_i32 s34, s34, 160
s_add_u32 s33, s33, s34
v_add_u32 v16, 0, v1
v_mul_u32_u24 v17, 6554, v16
v_lshrrev_b32 v17, 16, v17
v_mul_u32_u24 v18, 10, v17
v_sub_u32 v18, v16, v18
v_lshlrev_b32 v18, 4, v18
v_mul_u32_u24 v17, 1280, v17
v_add_u32 v18, v18, v17
s_mov_b32 m0, 152576
s_nop 0
buffer_load_dwordx4 v18, s[20:23], s33 offen lds
v_add_u32 v16, 64, v1
v_mul_u32_u24 v17, 6554, v16
v_lshrrev_b32 v17, 16, v17
v_mul_u32_u24 v18, 10, v17
v_sub_u32 v18, v16, v18
v_lshlrev_b32 v18, 4, v18
v_mul_u32_u24 v17, 1280, v17
v_add_u32 v18, v18, v17
s_mov_b32 m0, 153600
s_nop 0
buffer_load_dwordx4 v18, s[20:23], s33 offen lds
v_add_u32 v16, 128, v1
v_mul_u32_u24 v17, 6554, v16
v_lshrrev_b32 v17, 16, v17
v_mul_u32_u24 v18, 10, v17
v_sub_u32 v18, v16, v18
v_lshlrev_b32 v18, 4, v18
v_mul_u32_u24 v17, 1280, v17
v_add_u32 v18, v18, v17
s_mov_b32 m0, 154624
s_nop 0
buffer_load_dwordx4 v18, s[20:23], s33 offen lds
v_add_u32 v16, 192, v1
v_mul_u32_u24 v17, 6554, v16
v_lshrrev_b32 v17, 16, v17
v_mul_u32_u24 v18, 10, v17
v_sub_u32 v18, v16, v18
v_lshlrev_b32 v18, 4, v18
v_mul_u32_u24 v17, 1280, v17
v_add_u32 v18, v18, v17
s_mov_b32 m0, 155648
s_nop 0
buffer_load_dwordx4 v18, s[20:23], s33 offen lds
v_add_u32 v16, 256, v1
v_mul_u32_u24 v17, 6554, v16
v_lshrrev_b32 v17, 16, v17
v_mul_u32_u24 v18, 10, v17
v_sub_u32 v18, v16, v18
v_lshlrev_b32 v18, 4, v18
v_mul_u32_u24 v17, 1280, v17
v_add_u32 v18, v18, v17
s_mov_b32 m0, 156672
s_nop 0
buffer_load_dwordx4 v18, s[20:23], s33 offen lds
RLS5:
v_and_b32 v14, 15, v1
v_lshrrev_b32 v15, 4, v1
v_and_b32 v16, 7, v14
v_xor_b32 v16, v16, v15
v_lshlrev_b32 v16, 4, v16
v_lshl_add_u32 v11, v14, 7, v16
v_xor_b32 v12, 64, v11
v_cmp_eq_u32 s[44:45], 0, v14
v_lshrrev_b32 v16, 1, v15
v_lshlrev_b32 v16, 4, v16
v_and_b32 v17, 1, v15
v_lshl_add_u32 v16, v17, 2, v16
v_bfe_u32 v17, v1, 2, 2
v_add_u32 v16, v16, v17
v_mul_u32_u24 v16, 480, v16
v_and_b32 v17, 3, v1
v_lshl_add_u32 v16, v17, 3, v16
v_add_u32 v13, 18432, v16
v_mov_b32 v132, 0
v_mov_b32 v133, 0
v_mov_b32 v134, 0
v_mov_b32 v135, 0
v_mov_b32 v136, 0
v_mov_b32 v137, 0
v_mov_b32 v138, 0
v_mov_b32 v139, 0
v_mov_b32 v140, 0
v_mov_b32 v141, 0
v_mov_b32 v142, 0
v_mov_b32 v143, 0
v_mov_b32 v144, 0
v_mov_b32 v145, 0
v_mov_b32 v146, 0
v_mov_b32 v147, 0
v_mov_b32 v148, 0
v_mov_b32 v149, 0
v_mov_b32 v150, 0
v_mov_b32 v151, 0
v_mov_b32 v152, 0
v_mov_b32 v153, 0
v_mov_b32 v154, 0
v_mov_b32 v155, 0
v_mov_b32 v156, 0
v_mov_b32 v157, 0
v_mov_b32 v158, 0
v_mov_b32 v159, 0
v_mov_b32 v160, 0
v_mov_b32 v161, 0
v_mov_b32 v162, 0
v_mov_b32 v163, 0
v_mov_b32 v164, 0
v_mov_b32 v165, 0
v_mov_b32 v166, 0
v_mov_b32 v167, 0
v_mov_b32 v168, 0
v_mov_b32 v169, 0
v_mov_b32 v170, 0
v_mov_b32 v171, 0
v_mov_b32 v172, 0
v_mov_b32 v173, 0
v_mov_b32 v174, 0
v_mov_b32 v175, 0
v_mov_b32 v176, 0
v_mov_b32 v177, 0
v_mov_b32 v178, 0
v_mov_b32 v179, 0
v_mov_b32 v180, 0
v_mov_b32 v181, 0
v_mov_b32 v182, 0
v_mov_b32 v183, 0
v_mov_b32 v184, 0
v_mov_b32 v185, 0
v_mov_b32 v186, 0
v_mov_b32 v187, 0
v_mov_b32 v188, 0
v_mov_b32 v189, 0
v_mov_b32 v190, 0
v_mov_b32 v191, 0
v_mov_b32 v192, 0
v_mov_b32 v193, 0
v_mov_b32 v194, 0
v_mov_b32 v195, 0
v_mov_b32 v196, 0
v_mov_b32 v197, 0
v_mov_b32 v198, 0
v_mov_b32 v199, 0
v_mov_b32 v200, 0
v_mov_b32 v201, 0
v_mov_b32 v202, 0
v_mov_b32 v203, 0
v_mov_b32 v204, 0
v_mov_b32 v205, 0
v_mov_b32 v206, 0
v_mov_b32 v207, 0
v_mov_b32 v32, 0x3f803f80
v_mov_b32 v33, 0x3f803f80
v_mov_b32 v34, 0x3f803f80
v_mov_b32 v35, 0x3f803f80
s_cmp_ge_u32 s42, 592
s_cbranch_scc1 FW6
s_waitcnt vmcnt(11)
s_branch FW7
FW6:
s_waitcnt vmcnt(6)
FW7:
s_barrier
v_add_u32 v8, s28, v11
v_add_u32 v9, s28, v12
v_add_u32 v10, s28, v13
RX 40,8,2048
RX 44,8,4096
RX 48,8,6144
RX 52,8,8192
TR 56,10,128
TR 58,10,3968
RX 36,8,0
TR 60,10,160
TR 62,10,4000
TR 64,10,192
TR 66,10,4032
TR 68,10,224
TR 70,10,4064
s_add_u32 m0, s29, 1024
s_nop 0
buffer_load_dwordx4 v2, s[8:11], s30 offen lds
s_add_u32 m0, s29, 9216
s_nop 0
buffer_load_dwordx4 v3, s[8:11], s30 offen lds
s_add_u32 m0, s29, 17408
s_nop 0
buffer_load_dwordx4 v4, s[8:11], s30 offen lds
s_add_u32 m0, s29, 25600
s_nop 0
buffer_load_dwordx4 v5, s[12:15], s31 offen lds
s_add_u32 m0, s29, 33792
s_nop 0
buffer_load_dwordx4 v6, s[12:15], s31 offen lds
s_add_u32 m0, s29, 41984
s_nop 0
buffer_load_dwordx4 v7, s[12:15], s31 offen lds
s_add_u32 s30, s30, s38
s_add_u32 s31, s31, s43
s_add_u32 s29, s29, s39
s_cmp_eq_u32 s29, 147456
s_cselect_b32 s29, 0, s29
s_cmp_eq_u32 s30, 1280
s_cselect_b32 s30, 0, s30
s_cselect_b32 s31, 0, s31
s_cselect_b32 s38, 0, s38
s_cselect_b32 s43, 0, s43
s_cselect_b32 s39, 0, s39
s_cselect_b32 s29, 0x30000, s29
s_cselect_b32 s10, 0, s10
s_cselect_b32 s14, 0, s14
s_mov_b32 s27, 0
s_waitcnt lgkmcnt(0)
K1Latt1:
M 132,56,40
RX 88,9,2048
M 136,56,44
RX 92,9,4096
M 140,56,48
RX 96,9,6144
M 144,56,52
RX 100,9,8192
M 148,60,40
TR 104,10,15488
M 152,60,44
TR 106,10,19328
M 156,60,48
RX 84,9,0
M 160,60,52
TR 108,10,15520
M 164,64,40
TR 110,10,19360
M 168,64,44
TR 112,10,15552
M 172,64,48
TR 114,10,19392
M 176,64,52
TR 116,10,15584
M 180,68,40
TR 118,10,19424
v_cndmask_b32 v36, v36, v32, s[44:45]
v_cndmask_b32 v37, v37, v32, s[44:45]
v_cndmask_b32 v38, v38, v32, s[44:45]
v_cndmask_b32 v39, v39, v32, s[44:45]
M 184,68,44
M 188,68,48
s_add_u32 s28, s28, 49152
s_cmp_eq_u32 s28, 147456
s_cselect_b32 s28, 0, s28
M 192,68,52
v_add_u32 v8, s28, v11
v_add_u32 v9, s28, v12
v_add_u32 v10, s28, v13
M 196,56,36
s_cmp_eq_u32 s27, 9
M 200,32,44
M 204,44,44
s_cbranch_scc1 K1Eatt1
s_waitcnt vmcnt(6) lgkmcnt(0)
s_barrier
M 132,104,88
s_add_u32 m0, s29, 1024
RX 40,8,2048
buffer_load_dwordx4 v2, s[8:11], s30 offen lds
M 136,104,92
s_add_u32 m0, s29, 9216
RX 44,8,4096
buffer_load_dwordx4 v3, s[8:11], s30 offen lds
M 140,104,96
s_add_u32 m0, s29, 17408
RX 48,8,6144
buffer_load_dwordx4 v4, s[8:11], s30 offen lds
M 144,104,100
s_add_u32 m0, s29, 25600
RX 52,8,8192
buffer_load_dwordx4 v5, s[12:15], s31 offen lds
M 148,108,88
s_add_u32 m0, s29, 33792
TR 56,10,128
buffer_load_dwordx4 v6, s[12:15], s31 offen lds
M 152,108,92
s_add_u32 m0, s29, 41984
TR 58,10,3968
buffer_load_dwordx4 v7, s[12:15], s31 offen lds
M 156,108,96
RX 36,8,0
M 160,108,100
TR 60,10,160
M 164,112,88
TR 62,10,4000
M 168,112,92
TR 64,10,192
M 172,112,96
TR 66,10,4032
M 176,112,100
TR 68,10,224
M 180,116,88
TR 70,10,4064
v_cndmask_b32 v84, v84, v32, s[44:45]
v_cndmask_b32 v85, v85, v32, s[44:45]
v_cndmask_b32 v86, v86, v32, s[44:45]
v_cndmask_b32 v87, v87, v32, s[44:45]
M 184,116,92
s_add_u32 s30, s30, s38
s_add_u32 s31, s31, s43
s_add_u32 s29, s29, s39
M 188,116,96
s_cmp_eq_u32 s29, 147456
s_cselect_b32 s29, 0, s29
s_cmp_eq_u32 s30, 1280
M 192,116,100
s_cselect_b32 s30, 0, s30
s_cselect_b32 s31, 0, s31
s_cselect_b32 s38, 0, s38
M 196,104,84
s_cselect_b32 s43, 0, s43
s_cselect_b32 s39, 0, s39
s_cselect_b32 s29, 0x30000, s29
M 200,32,92
s_cselect_b32 s10, 0, s10
s_cselect_b32 s14, 0, s14
s_add_u32 s27, s27, 1
M 204,92,92
s_waitcnt lgkmcnt(0)
s_branch K1Latt1
K1Eatt1:
s_waitcnt lgkmcnt(0)
M 132,104,88
M 136,104,92
M 140,104,96
M 144,104,100
M 148,108,88
M 152,108,92
M 156,108,96
M 160,108,100
M 164,112,88
M 168,112,92
M 172,112,96
M 176,112,100
M 180,116,88
v_cndmask_b32 v84, v84, v32, s[44:45]
v_cndmask_b32 v85, v85, v32, s[44:45]
v_cndmask_b32 v86, v86, v32, s[44:45]
v_cndmask_b32 v87, v87, v32, s[44:45]
M 184,116,92
M 188,116,96
M 192,116,100
M 196,104,84
M 200,32,92
M 204,92,92
s_waitcnt vmcnt(0)
s_cmp_ge_u32 s42, 592
s_cbranch_scc1 RLO8
v_lshrrev_b32 v220, 2, v1
v_mul_u32_u24 v220, 160, v220
v_and_b32 v221, 3, v1
v_lshl_add_u32 v220, v221, 3, v220
v_add_u32 v220, 152576, v220
TR 224,220,0
TR 226,220,2560
TR 228,220,32
TR 230,220,2592
TR 232,220,64
TR 234,220,2624
TR 236,220,96
TR 238,220,2656
TR 240,220,128
TR 242,220,2688
s_sub_u32 s35, s42, 432
s_mov_b32 s33, 10485760
s_cmp_ge_u32 s42, 432
s_cselect_b32 s35, s35, s42
s_cselect_b32 s36, 20, 54
s_cselect_b32 s33, 13631488, s33
s_lshr_b32 s34, s35, 3
s_and_b32 s35, s35, 7
s_mul_i32 s35, s35, s36
s_add_u32 s35, s35, s34
s_mul_i32 s35, s35, 5120
s_add_u32 s33, s33, s35
s_add_u32 s34, s33, 4096
v_lshlrev_b32 v221, 4, v1
s_waitcnt lgkmcnt(0)
buffer_store_dwordx4 v[224:227], v221, s[16:19], s33 offen offset:0
buffer_store_dwordx4 v[228:231], v221, s[16:19], s33 offen offset:1024
buffer_store_dwordx4 v[232:235], v221, s[16:19], s33 offen offset:2048
buffer_store_dwordx4 v[236:239], v221, s[16:19], s33 offen offset:3072
buffer_store_dwordx4 v[240:243], v221, s[16:19], s34 offen
RLO8:
v_and_b32 v14, 15, v1
v_lshrrev_b32 v15, 4, v1
v_lshrrev_b32 v16, 2, v14
v_and_b32 v17, 3, v14
v_cmp_eq_u32 s[46:47], v16, v15
v_cmp_eq_u32 s[48:49], 1, v17
v_cmp_eq_u32 s[54:55], 2, v17
v_cmp_eq_u32 s[56:57], 3, v17
v_lshlrev_b32 v18, 2, v14
v_add_u32 v18, 98304, v18
s_mov_b32 s33, 0x3acccccd
s_mov_b32 s34, 0x3727c5ac
v_cndmask_b32 v204, v204, v205, s[48:49]
v_cndmask_b32 v204, v204, v206, s[54:55]
v_cndmask_b32 v204, v204, v207, s[56:57]
v_mul_f32 v200, s33, v200
v_mul_f32 v204, s33, v204
v_fma_f32 v204, -v200, v200, v204
v_max_f32 v204, 0, v204
v_add_f32 v204, s34, v204
v_rsq_f32 v204, v204
s_mov_b64 exec, s[46:47]
ds_write_b32 v18, v200 offset:128
ds_write_b32 v18, v204 offset:704
s_mov_b64 exec, -1
v_add_u32 v19, 98304, v1
s_mov_b64 exec, s[44:45]
ds_write_b128 v19, v[196:199] offset:1408
s_mov_b64 exec, -1
s_waitcnt lgkmcnt(0)
s_barrier
v_and_b32 v14, 15, v1
v_lshlrev_b32 v14, 2, v14
v_lshrrev_b32 v15, 4, v1
v_lshlrev_b32 v15, 4, v15
v_add_u32 v14, 98304, v14
v_add_u32 v15, 98304, v15
ds_read_b32 v36, v14 offset:64
ds_read_b32 v38, v14 offset:640
ds_read_b32 v42, v14 offset:128
ds_read_b32 v44, v14 offset:704
ds_read_b32 v48, v14 offset:192
ds_read_b32 v50, v14 offset:768
ds_read_b32 v54, v14 offset:256
ds_read_b32 v56, v14 offset:832
ds_read_b128 v[60:63], v15 offset:1408
ds_read_b128 v[64:67], v15 offset:1472
ds_read_b128 v[68:71], v15 offset:1536
ds_read_b128 v[72:75], v15 offset:1600
s_waitcnt lgkmcnt(0)
v_lshlrev_b32 v16, 3, v1
v_and_b32 v17, 15, v1
v_lshrrev_b32 v18, 4, v1
v_lshlrev_b32 v18, 3, v18
v_lshl_add_u32 v17, v17, 5, v18
v_add_u32 v18, 32768, v16
v_add_u32 v19, 32768, v17
PFN 132,36,60
PFN 134,36,62
PMB 132,38,132
PMB 134,38,134
CV 132,132,133
CV 133,134,135
PFN 136,42,60
PFN 138,42,62
PMB 136,44,136
PMB 138,44,138
CV 136,136,137
CV 137,138,139
PFN 140,48,60
PFN 142,48,62
PMB 140,50,140
PMB 142,50,142
CV 140,140,141
CV 141,142,143
PFN 144,54,60
PFN 146,54,62
PMB 144,56,144
PMB 146,56,146
CV 144,144,145
CV 145,146,147
PFN 148,36,64
PFN 150,36,66
PMB 148,38,148
PMB 150,38,150
CV 148,148,149
CV 149,150,151
PFN 152,42,64
PFN 154,42,66
PMB 152,44,152
PMB 154,44,154
CV 152,152,153
CV 153,154,155
PFN 156,48,64
PFN 158,48,66
PMB 156,50,156
PMB 158,50,158
CV 156,156,157
CV 157,158,159
PFN 160,54,64
PFN 162,54,66
PMB 160,56,160
PMB 162,56,162
CV 160,160,161
CV 161,162,163
PFN 164,36,68
PFN 166,36,70
PMB 164,38,164
PMB 166,38,166
CV 164,164,165
CV 165,166,167
PFN 168,42,68
PFN 170,42,70
PMB 168,44,168
PMB 170,44,170
CV 168,168,169
CV 169,170,171
PFN 172,48,68
PFN 174,48,70
PMB 172,50,172
PMB 174,50,174
CV 172,172,173
CV 173,174,175
PFN 176,54,68
PFN 178,54,70
PMB 176,56,176
PMB 178,56,178
CV 176,176,177
CV 177,178,179
PFN 180,36,72
PFN 182,36,74
PMB 180,38,180
PMB 182,38,182
CV 180,180,181
CV 181,182,183
PFN 184,42,72
PFN 186,42,74
PMB 184,44,184
PMB 186,44,186
CV 184,184,185
CV 185,186,187
PFN 188,48,72
PFN 190,48,74
PMB 188,50,188
PMB 190,50,190
CV 188,188,189
CV 189,190,191
PFN 192,54,72
PFN 194,54,74
PMB 192,56,192
PMB 194,56,194
CV 192,192,193
CV 193,194,195
ds_write_b64 v16, v[132:133] offset:9728
ds_write_b64 v16, v[136:137] offset:17408
ds_write_b64 v16, v[140:141] offset:25088
ds_write_b64 v18, v[144:145] offset:0
ds_write_b64 v16, v[148:149] offset:10240
ds_write_b64 v16, v[152:153] offset:17920
ds_write_b64 v16, v[156:157] offset:25600
ds_write_b64 v18, v[160:161] offset:512
ds_write_b64 v16, v[164:165] offset:10752
ds_write_b64 v16, v[168:169] offset:18432
ds_write_b64 v16, v[172:173] offset:26112
ds_write_b64 v18, v[176:177] offset:1024
ds_write_b64 v16, v[180:181] offset:11264
ds_write_b64 v16, v[184:185] offset:18944
ds_write_b64 v16, v[188:189] offset:26624
ds_write_b64 v18, v[192:193] offset:1536
s_waitcnt lgkmcnt(0)
s_branch K1_ATTN
K1_ATT2:
v_lshrrev_b32 v14, 3, v1
v_and_b32 v15, 7, v1
v_xor_b32 v15, v15, v14
v_lshlrev_b32 v15, 4, v15
s_mov_b32 s30, 0
s_mov_b32 s31, 0
s_mov_b32 s29, 0
s_mov_b32 s28, 0
s_mov_b32 s43, 245760
s_mov_b32 s38, 128
s_mov_b32 s39, 49152
s_add_i32 s33, s32, 16
v_add_u32 v2, s33, v14
v_max_i32 v2, 0, v2
v_mul_u32_u24 v2, 1280, v2
v_add_u32 v2, v2, v15
s_waitcnt lgkmcnt(0)
s_mov_b32 s8, s4
s_mov_b32 s9, s5
s_mov_b32 s52, s62
s_mov_b32 s53, s63
s_mov_b32 s12, s6
s_mov_b32 s13, s7
s_add_u32 m0, s29, 2048
s_nop 0
buffer_load_dwordx4 v2, s[8:11], s30 offen lds
s_add_i32 s33, s32, 80
v_add_u32 v3, s33, v14
v_max_i32 v3, 0, v3
v_mul_u32_u24 v3, 1280, v3
v_add_u32 v3, v3, v15
s_add_u32 m0, s29, 10240
s_nop 0
buffer_load_dwordx4 v3, s[8:11], s30 offen lds
v_add_u32 v16, 0, v1
v_mul_u32_u24 v17, 2185, v16
v_lshrrev_b32 v17, 16, v17
v_mul_u32_u24 v18, 30, v17
v_sub_u32 v18, v16, v18
v_and_b32 v19, 0x33, v17
v_and_b32 v20, 4, v17
v_lshl_or_b32 v19, v20, 1, v19
v_bfe_u32 v20, v17, 3, 1
v_lshl_or_b32 v19, v20, 2, v19
v_mul_u32_u24 v20, 6554, v18
v_lshrrev_b32 v20, 16, v20
v_mul_u32_u24 v20, 1120, v20
v_lshl_add_u32 v18, v18, 4, v20
v_mul_u32_u24 v4, 3840, v19
v_add3_u32 v4, v4, v18, s36
s_add_u32 m0, s29, 18432
s_nop 0
buffer_load_dwordx4 v4, s[12:15], s31 offen lds
v_add_u32 v16, 512, v1
v_mul_u32_u24 v17, 2185, v16
v_lshrrev_b32 v17, 16, v17
v_mul_u32_u24 v18, 30, v17
v_sub_u32 v18, v16, v18
v_and_b32 v19, 0x33, v17
v_and_b32 v20, 4, v17
v_lshl_or_b32 v19, v20, 1, v19
v_bfe_u32 v20, v17, 3, 1
v_lshl_or_b32 v19, v20, 2, v19
v_mul_u32_u24 v20, 6554, v18
v_lshrrev_b32 v20, 16, v20
v_mul_u32_u24 v20, 1120, v20
v_lshl_add_u32 v18, v18, 4, v20
v_mul_u32_u24 v5, 3840, v19
v_add3_u32 v5, v5, v18, s36
s_add_u32 m0, s29, 26624
s_nop 0
buffer_load_dwordx4 v5, s[12:15], s31 offen lds
v_add_u32 v16, 1024, v1
v_mul_u32_u24 v17, 2185, v16
v_lshrrev_b32 v17, 16, v17
v_mul_u32_u24 v18, 30, v17
v_sub_u32 v18, v16, v18
v_and_b32 v19, 0x33, v17
v_and_b32 v20, 4, v17
v_lshl_or_b32 v19, v20, 1, v19
v_bfe_u32 v20, v17, 3, 1
v_lshl_or_b32 v19, v20, 2, v19
v_mul_u32_u24 v20, 6554, v18
v_lshrrev_b32 v20, 16, v20
v_mul_u32_u24 v20, 1120, v20
v_lshl_add_u32 v18, v18, 4, v20
v_mul_u32_u24 v6, 3840, v19
v_add3_u32 v6, v6, v18, s36
s_add_u32 m0, s29, 34816
s_nop 0
buffer_load_dwordx4 v6, s[12:15], s31 offen lds
v_add_u32 v16, 1536, v1
v_mul_u32_u24 v17, 2185, v16
v_lshrrev_b32 v17, 16, v17
v_mul_u32_u24 v18, 30, v17
v_sub_u32 v18, v16, v18
v_and_b32 v19, 0x33, v17
v_and_b32 v20, 4, v17
v_lshl_or_b32 v19, v20, 1, v19
v_bfe_u32 v20, v17, 3, 1
v_lshl_or_b32 v19, v20, 2, v19
v_mul_u32_u24 v20, 6554, v18
v_lshrrev_b32 v20, 16, v20
v_mul_u32_u24 v20, 1120, v20
v_lshl_add_u32 v18, v18, 4, v20
v_mul_u32_u24 v7, 3840, v19
v_add3_u32 v7, v7, v18, s36
s_add_u32 m0, s29, 43008
s_nop 0
buffer_load_dwordx4 v7, s[12:15], s31 offen lds
s_add_u32 s30, s30, s38
s_add_u32 s31, s31, s43
s_add_u32 s29, s29, s39
s_cmp_eq_u32 s29, 147456
s_cselect_b32 s29, 0, s29
s_cmp_eq_u32 s30, 1280
s_cselect_b32 s30, 0, s30
s_cselect_b32 s31, 0, s31
s_cselect_b32 s38, 0, s38
s_cselect_b32 s43, 0, s43
s_cselect_b32 s39, 0, s39
s_cselect_b32 s29, 0x30000, s29
s_cselect_b32 s10, 0, s10
s_cselect_b32 s14, 0, s14
s_add_u32 m0, s29, 2048
s_nop 0
buffer_load_dwordx4 v2, s[8:11], s30 offen lds
s_add_u32 m0, s29, 10240
s_nop 0
buffer_load_dwordx4 v3, s[8:11], s30 offen lds
s_add_u32 m0, s29, 18432
s_nop 0
buffer_load_dwordx4 v4, s[12:15], s31 offen lds
s_add_u32 m0, s29, 26624
s_nop 0
buffer_load_dwordx4 v5, s[12:15], s31 offen lds
s_add_u32 m0, s29, 34816
s_nop 0
buffer_load_dwordx4 v6, s[12:15], s31 offen lds
s_add_u32 m0, s29, 43008
s_nop 0
buffer_load_dwordx4 v7, s[12:15], s31 offen lds
s_add_u32 s30, s30, s38
s_add_u32 s31, s31, s43
s_add_u32 s29, s29, s39
s_cmp_eq_u32 s29, 147456
s_cselect_b32 s29, 0, s29
s_cmp_eq_u32 s30, 1280
s_cselect_b32 s30, 0, s30
s_cselect_b32 s31, 0, s31
s_cselect_b32 s38, 0, s38
s_cselect_b32 s43, 0, s43
s_cselect_b32 s39, 0, s39
s_cselect_b32 s29, 0x30000, s29
s_cselect_b32 s10, 0, s10
s_cselect_b32 s14, 0, s14
s_add_u32 s42, s37, 512
s_cmp_ge_u32 s42, 592
s_cbranch_scc1 RLS9
s_mov_b32 s22, 2211840
s_mov_b32 s23, 0x00020000
s_sub_u32 s35, s42, 432
s_cmp_ge_u32 s42, 432
s_cselect_b32 s20, s50, s52
s_cselect_b32 s21, s51, s53
s_cselect_b32 s22, 819200, s22
s_cselect_b32 s35, s35, s42
s_lshr_b32 s33, s35, 3
s_and_b32 s34, s35, 7
s_mul_i32 s33, s33, 40960
s_mul_i32 s34, s34, 160
s_add_u32 s33, s33, s34
v_add_u32 v16, 0, v1
v_mul_u32_u24 v17, 6554, v16
v_lshrrev_b32 v17, 16, v17
v_mul_u32_u24 v18, 10, v17
v_sub_u32 v18, v16, v18
v_lshlrev_b32 v18, 4, v18
v_mul_u32_u24 v17, 1280, v17
v_add_u32 v18, v18, v17
s_mov_b32 m0, 157696
s_nop 0
buffer_load_dwordx4 v18, s[20:23], s33 offen lds
v_add_u32 v16, 64, v1
v_mul_u32_u24 v17, 6554, v16
v_lshrrev_b32 v17, 16, v17
v_mul_u32_u24 v18, 10, v17
v_sub_u32 v18, v16, v18
v_lshlrev_b32 v18, 4, v18
v_mul_u32_u24 v17, 1280, v17
v_add_u32 v18, v18, v17
s_mov_b32 m0, 158720
s_nop 0
buffer_load_dwordx4 v18, s[20:23], s33 offen lds
v_add_u32 v16, 128, v1
v_mul_u32_u24 v17, 6554, v16
v_lshrrev_b32 v17, 16, v17
v_mul_u32_u24 v18, 10, v17
v_sub_u32 v18, v16, v18
v_lshlrev_b32 v18, 4, v18
v_mul_u32_u24 v17, 1280, v17
v_add_u32 v18, v18, v17
s_mov_b32 m0, 159744
s_nop 0
buffer_load_dwordx4 v18, s[20:23], s33 offen lds
v_add_u32 v16, 192, v1
v_mul_u32_u24 v17, 6554, v16
v_lshrrev_b32 v17, 16, v17
v_mul_u32_u24 v18, 10, v17
v_sub_u32 v18, v16, v18
v_lshlrev_b32 v18, 4, v18
v_mul_u32_u24 v17, 1280, v17
v_add_u32 v18, v18, v17
s_mov_b32 m0, 160768
s_nop 0
buffer_load_dwordx4 v18, s[20:23], s33 offen lds
v_add_u32 v16, 256, v1
v_mul_u32_u24 v17, 6554, v16
v_lshrrev_b32 v17, 16, v17
v_mul_u32_u24 v18, 10, v17
v_sub_u32 v18, v16, v18
v_lshlrev_b32 v18, 4, v18
v_mul_u32_u24 v17, 1280, v17
v_add_u32 v18, v18, v17
s_mov_b32 m0, 161792
s_nop 0
buffer_load_dwordx4 v18, s[20:23], s33 offen lds
RLS9:
v_and_b32 v14, 15, v1
v_lshrrev_b32 v15, 4, v1
v_and_b32 v16, 7, v14
v_xor_b32 v16, v16, v15
v_lshlrev_b32 v16, 4, v16
v_lshl_add_u32 v11, v14, 7, v16
v_xor_b32 v12, 64, v11
v_cmp_eq_u32 s[44:45], 0, v14
v_lshrrev_b32 v16, 1, v15
v_lshlrev_b32 v16, 4, v16
v_and_b32 v17, 1, v15
v_lshl_add_u32 v16, v17, 2, v16
v_bfe_u32 v17, v1, 2, 2
v_add_u32 v16, v16, v17
v_mul_u32_u24 v16, 480, v16
v_and_b32 v17, 3, v1
v_lshl_add_u32 v16, v17, 3, v16
v_add_u32 v13, 18432, v16
v_mov_b32 v132, 0
v_mov_b32 v133, 0
v_mov_b32 v134, 0
v_mov_b32 v135, 0
v_mov_b32 v136, 0
v_mov_b32 v137, 0
v_mov_b32 v138, 0
v_mov_b32 v139, 0
v_mov_b32 v140, 0
v_mov_b32 v141, 0
v_mov_b32 v142, 0
v_mov_b32 v143, 0
v_mov_b32 v144, 0
v_mov_b32 v145, 0
v_mov_b32 v146, 0
v_mov_b32 v147, 0
v_mov_b32 v148, 0
v_mov_b32 v149, 0
v_mov_b32 v150, 0
v_mov_b32 v151, 0
v_mov_b32 v152, 0
v_mov_b32 v153, 0
v_mov_b32 v154, 0
v_mov_b32 v155, 0
v_mov_b32 v156, 0
v_mov_b32 v157, 0
v_mov_b32 v158, 0
v_mov_b32 v159, 0
v_mov_b32 v160, 0
v_mov_b32 v161, 0
v_mov_b32 v162, 0
v_mov_b32 v163, 0
v_mov_b32 v164, 0
v_mov_b32 v165, 0
v_mov_b32 v166, 0
v_mov_b32 v167, 0
v_mov_b32 v168, 0
v_mov_b32 v169, 0
v_mov_b32 v170, 0
v_mov_b32 v171, 0
v_mov_b32 v172, 0
v_mov_b32 v173, 0
v_mov_b32 v174, 0
v_mov_b32 v175, 0
v_mov_b32 v176, 0
v_mov_b32 v177, 0
v_mov_b32 v178, 0
v_mov_b32 v179, 0
v_mov_b32 v180, 0
v_mov_b32 v181, 0
v_mov_b32 v182, 0
v_mov_b32 v183, 0
v_mov_b32 v184, 0
v_mov_b32 v185, 0
v_mov_b32 v186, 0
v_mov_b32 v187, 0
v_mov_b32 v188, 0
v_mov_b32 v189, 0
v_mov_b32 v190, 0
v_mov_b32 v191, 0
v_mov_b32 v192, 0
v_mov_b32 v193, 0
v_mov_b32 v194, 0
v_mov_b32 v195, 0
v_mov_b32 v196, 0
v_mov_b32 v197, 0
v_mov_b32 v198, 0
v_mov_b32 v199, 0
v_mov_b32 v200, 0
v_mov_b32 v201, 0
v_mov_b32 v202, 0
v_mov_b32 v203, 0
v_mov_b32 v204, 0
v_mov_b32 v205, 0
v_mov_b32 v206, 0
v_mov_b32 v207, 0
v_mov_b32 v32, 0x3f803f80
v_mov_b32 v33, 0x3f803f80
v_mov_b32 v34, 0x3f803f80
v_mov_b32 v35, 0x3f803f80
s_cmp_ge_u32 s42, 592
s_cbranch_scc1 FW10
s_waitcnt vmcnt(11)
s_branch FW11
FW10:
s_waitcnt vmcnt(6)
FW11:
s_barrier
v_add_u32 v8, s28, v11
v_add_u32 v9, s28, v12
v_add_u32 v10, s28, v13
RX 40,8,2048
RX 44,8,4096
RX 48,8,6144
RX 52,8,8192
TR 56,10,256
TR 58,10,4096
RX 36,8,0
TR 60,10,288
TR 62,10,4128
TR 64,10,320
TR 66,10,4160
TR 68,10,352
TR 70,10,4192
s_add_u32 m0, s29, 2048
s_nop 0
buffer_load_dwordx4 v2, s[8:11], s30 offen lds
s_add_u32 m0, s29, 10240
s_nop 0
buffer_load_dwordx4 v3, s[8:11], s30 offen lds
s_add_u32 m0, s29, 18432
s_nop 0
buffer_load_dwordx4 v4, s[12:15], s31 offen lds
s_add_u32 m0, s29, 26624
s_nop 0
buffer_load_dwordx4 v5, s[12:15], s31 offen lds
s_add_u32 m0, s29, 34816
s_nop 0
buffer_load_dwordx4 v6, s[12:15], s31 offen lds
s_add_u32 m0, s29, 43008
s_nop 0
buffer_load_dwordx4 v7, s[12:15], s31 offen lds
s_add_u32 s30, s30, s38
s_add_u32 s31, s31, s43
s_add_u32 s29, s29, s39
s_cmp_eq_u32 s29, 147456
s_cselect_b32 s29, 0, s29
s_cmp_eq_u32 s30, 1280
s_cselect_b32 s30, 0, s30
s_cselect_b32 s31, 0, s31
s_cselect_b32 s38, 0, s38
s_cselect_b32 s43, 0, s43
s_cselect_b32 s39, 0, s39
s_cselect_b32 s29, 0x30000, s29
s_cselect_b32 s10, 0, s10
s_cselect_b32 s14, 0, s14
s_mov_b32 s27, 0
s_waitcnt lgkmcnt(0)
K1Latt2:
M 132,56,40
RX 88,9,2048
M 136,56,44
RX 92,9,4096
M 140,56,48
RX 96,9,6144
M 144,56,52
RX 100,9,8192
M 148,60,40
TR 104,10,15616
M 152,60,44
TR 106,10,19456
M 156,60,48
RX 84,9,0
M 160,60,52
TR 108,10,15648
M 164,64,40
TR 110,10,19488
M 168,64,44
TR 112,10,15680
M 172,64,48
TR 114,10,19520
M 176,64,52
TR 116,10,15712
M 180,68,40
TR 118,10,19552
v_cndmask_b32 v36, v36, v32, s[44:45]
v_cndmask_b32 v37, v37, v32, s[44:45]
v_cndmask_b32 v38, v38, v32, s[44:45]
v_cndmask_b32 v39, v39, v32, s[44:45]
M 184,68,44
M 188,68,48
s_add_u32 s28, s28, 49152
s_cmp_eq_u32 s28, 147456
s_cselect_b32 s28, 0, s28
M 192,68,52
v_add_u32 v8, s28, v11
v_add_u32 v9, s28, v12
v_add_u32 v10, s28, v13
M 196,56,36
s_cmp_eq_u32 s27, 9
M 200,32,48
M 204,48,48
s_cbranch_scc1 K1Eatt2
s_waitcnt vmcnt(6) lgkmcnt(0)
s_barrier
M 132,104,88
s_add_u32 m0, s29, 2048
RX 40,8,2048
buffer_load_dwordx4 v2, s[8:11], s30 offen lds
M 136,104,92
s_add_u32 m0, s29, 10240
RX 44,8,4096
buffer_load_dwordx4 v3, s[8:11], s30 offen lds
M 140,104,96
s_add_u32 m0, s29, 18432
RX 48,8,6144
buffer_load_dwordx4 v4, s[12:15], s31 offen lds
M 144,104,100
s_add_u32 m0, s29, 26624
RX 52,8,8192
buffer_load_dwordx4 v5, s[12:15], s31 offen lds
M 148,108,88
s_add_u32 m0, s29, 34816
TR 56,10,256
buffer_load_dwordx4 v6, s[12:15], s31 offen lds
M 152,108,92
s_add_u32 m0, s29, 43008
TR 58,10,4096
buffer_load_dwordx4 v7, s[12:15], s31 offen lds
M 156,108,96
RX 36,8,0
M 160,108,100
TR 60,10,288
M 164,112,88
TR 62,10,4128
M 168,112,92
TR 64,10,320
M 172,112,96
TR 66,10,4160
M 176,112,100
TR 68,10,352
M 180,116,88
TR 70,10,4192
v_cndmask_b32 v84, v84, v32, s[44:45]
v_cndmask_b32 v85, v85, v32, s[44:45]
v_cndmask_b32 v86, v86, v32, s[44:45]
v_cndmask_b32 v87, v87, v32, s[44:45]
M 184,116,92
s_add_u32 s30, s30, s38
s_add_u32 s31, s31, s43
s_add_u32 s29, s29, s39
M 188,116,96
s_cmp_eq_u32 s29, 147456
s_cselect_b32 s29, 0, s29
s_cmp_eq_u32 s30, 1280
M 192,116,100
s_cselect_b32 s30, 0, s30
s_cselect_b32 s31, 0, s31
s_cselect_b32 s38, 0, s38
M 196,104,84
s_cselect_b32 s43, 0, s43
s_cselect_b32 s39, 0, s39
s_cselect_b32 s29, 0x30000, s29
M 200,32,96
s_cselect_b32 s10, 0, s10
s_cselect_b32 s14, 0, s14
s_add_u32 s27, s27, 1
M 204,96,96
s_waitcnt lgkmcnt(0)
s_branch K1Latt2
K1Eatt2:
s_waitcnt lgkmcnt(0)
M 132,104,88
M 136,104,92
M 140,104,96
M 144,104,100
M 148,108,88
M 152,108,92
M 156,108,96
M 160,108,100
M 164,112,88
M 168,112,92
M 172,112,96
M 176,112,100
M 180,116,88
v_cndmask_b32 v84, v84, v32, s[44:45]
v_cndmask_b32 v85, v85, v32, s[44:45]
v_cndmask_b32 v86, v86, v32, s[44:45]
v_cndmask_b32 v87, v87, v32, s[44:45]
M 184,116,92
M 188,116,96
M 192,116,100
M 196,104,84
M 200,32,96
M 204,96,96
s_waitcnt vmcnt(0)
s_cmp_ge_u32 s42, 592
s_cbranch_scc1 RLO12
v_lshrrev_b32 v220, 2, v1
v_mul_u32_u24 v220, 160, v220
v_and_b32 v221, 3, v1
v_lshl_add_u32 v220, v221, 3, v220
v_add_u32 v220, 157696, v220
TR 224,220,0
TR 226,220,2560
TR 228,220,32
TR 230,220,2592
TR 232,220,64
TR 234,220,2624
TR 236,220,96
TR 238,220,2656
TR 240,220,128
TR 242,220,2688
s_sub_u32 s35, s42, 432
s_mov_b32 s33, 10485760
s_cmp_ge_u32 s42, 432
s_cselect_b32 s35, s35, s42
s_cselect_b32 s36, 20, 54
s_cselect_b32 s33, 13631488, s33
s_lshr_b32 s34, s35, 3
s_and_b32 s35, s35, 7
s_mul_i32 s35, s35, s36
s_add_u32 s35, s35, s34
s_mul_i32 s35, s35, 5120
s_add_u32 s33, s33, s35
s_add_u32 s34, s33, 4096
v_lshlrev_b32 v221, 4, v1
s_waitcnt lgkmcnt(0)
buffer_store_dwordx4 v[224:227], v221, s[16:19], s33 offen offset:0
buffer_store_dwordx4 v[228:231], v221, s[16:19], s33 offen offset:1024
buffer_store_dwordx4 v[232:235], v221, s[16:19], s33 offen offset:2048
buffer_store_dwordx4 v[236:239], v221, s[16:19], s33 offen offset:3072
buffer_store_dwordx4 v[240:243], v221, s[16:19], s34 offen
RLO12:
v_and_b32 v14, 15, v1
v_lshrrev_b32 v15, 4, v1
v_lshrrev_b32 v16, 2, v14
v_and_b32 v17, 3, v14
v_cmp_eq_u32 s[46:47], v16, v15
v_cmp_eq_u32 s[48:49], 1, v17
v_cmp_eq_u32 s[54:55], 2, v17
v_cmp_eq_u32 s[56:57], 3, v17
v_lshlrev_b32 v18, 2, v14
v_add_u32 v18, 98304, v18
s_mov_b32 s33, 0x3acccccd
s_mov_b32 s34, 0x3727c5ac
v_cndmask_b32 v204, v204, v205, s[48:49]
v_cndmask_b32 v204, v204, v206, s[54:55]
v_cndmask_b32 v204, v204, v207, s[56:57]
v_mul_f32 v200, s33, v200
v_mul_f32 v204, s33, v204
v_fma_f32 v204, -v200, v200, v204
v_max_f32 v204, 0, v204
v_add_f32 v204, s34, v204
v_rsq_f32 v204, v204
s_mov_b64 exec, s[46:47]
ds_write_b32 v18, v200 offset:192
ds_write_b32 v18, v204 offset:768
s_mov_b64 exec, -1
v_add_u32 v19, 98304, v1
s_mov_b64 exec, s[44:45]
ds_write_b128 v19, v[196:199] offset:1664
s_mov_b64 exec, -1
s_waitcnt lgkmcnt(0)
s_barrier
v_and_b32 v14, 15, v1
v_lshlrev_b32 v14, 2, v14
v_lshrrev_b32 v15, 4, v1
v_lshlrev_b32 v15, 4, v15
v_add_u32 v14, 98304, v14
v_add_u32 v15, 98304, v15
ds_read_b32 v36, v14 offset:0
ds_read_b32 v38, v14 offset:576
ds_read_b32 v42, v14 offset:64
ds_read_b32 v44, v14 offset:640
ds_read_b32 v48, v14 offset:128
ds_read_b32 v50, v14 offset:704
ds_read_b32 v54, v14 offset:192
ds_read_b32 v56, v14 offset:768
ds_read_b32 v60, v14 offset:256
ds_read_b32 v62, v14 offset:832
ds_read_b128 v[68:71], v15 offset:1664
ds_read_b128 v[72:75], v15 offset:1728
ds_read_b128 v[76:79], v15 offset:1792
ds_read_b128 v[80:83], v15 offset:1856
s_waitcnt lgkmcnt(0)
v_lshlrev_b32 v16, 3, v1
v_and_b32 v17, 15, v1
v_lshrrev_b32 v18, 4, v1
v_lshlrev_b32 v18, 3, v18
v_lshl_add_u32 v17, v17, 5, v18
v_add_u32 v18, 32768, v16
v_add_u32 v19, 32768, v17
PFN 132,42,68
PFN 134,42,70
PMB 132,44,132
PMB 134,44,134
CV 132,132,133
CV 133,134,135
PFN 136,48,68
PFN 138,48,70
PMB 136,50,136
PMB 138,50,138
CV 136,136,137
CV 137,138,139
PFN 140,54,68
PFN 142,54,70
PMB 140,56,140
PMB 142,56,142
CV 140,140,141
CV 141,142,143
PFN 144,60,68
PFN 146,60,70
PMB 144,62,144
PMB 146,62,146
CV 144,144,145
CV 145,146,147
PFN 148,42,72
PFN 150,42,74
PMB 148,44,148
PMB 150,44,150
CV 148,148,149
CV 149,150,151
PFN 152,48,72
PFN 154,48,74
PMB 152,50,152
PMB 154,50,154
CV 152,152,153
CV 153,154,155
PFN 156,54,72
PFN 158,54,74
PMB 156,56,156
PMB 158,56,158
CV 156,156,157
CV 157,158,159
PFN 160,60,72
PFN 162,60,74
PMB 160,62,160
PMB 162,62,162
CV 160,160,161
CV 161,162,163
PFN 164,42,76
PFN 166,42,78
PMB 164,44,164
PMB 166,44,166
CV 164,164,165
CV 165,166,167
PFN 168,48,76
PFN 170,48,78
PMB 168,50,168
PMB 170,50,170
CV 168,168,169
CV 169,170,171
PFN 172,54,76
PFN 174,54,78
PMB 172,56,172
PMB 174,56,174
CV 172,172,173
CV 173,174,175
PFN 176,60,76
PFN 178,60,78
PMB 176,62,176
PMB 178,62,178
CV 176,176,177
CV 177,178,179
PFN 180,42,80
PFN 182,42,82
PMB 180,44,180
PMB 182,44,182
CV 180,180,181
CV 181,182,183
PFN 184,48,80
PFN 186,48,82
PMB 184,50,184
PMB 186,50,186
CV 184,184,185
CV 185,186,187
PFN 188,54,80
PFN 190,54,82
PMB 188,56,188
PMB 190,56,190
CV 188,188,189
CV 189,190,191
PFN 192,60,80
PFN 194,60,82
PMB 192,62,192
PMB 194,62,194
CV 192,192,193
CV 193,194,195
PFN 196,36,68
PFN 198,36,70
PMB 196,38,196
PMB 198,38,198
CV 196,196,197
CV 197,198,199
ds_write_b64 v16, v[132:133] offset:11776
ds_write_b64 v16, v[136:137] offset:19456
ds_write_b64 v16, v[140:141] offset:27136
ds_write_b64 v18, v[144:145] offset:2048
ds_write_b64 v16, v[148:149] offset:12288
ds_write_b64 v16, v[152:153] offset:19968
ds_write_b64 v16, v[156:157] offset:27648
ds_write_b64 v18, v[160:161] offset:2560
ds_write_b64 v17, v[164:165] offset:12800
ds_write_b64 v17, v[168:169] offset:20480
ds_write_b64 v17, v[172:173] offset:28160
ds_write_b64 v19, v[176:177] offset:3072
ds_write_b64 v17, v[180:181] offset:13312
ds_write_b64 v17, v[184:185] offset:20992
ds_write_b64 v17, v[188:189] offset:28672
ds_write_b64 v19, v[192:193] offset:3584
ds_write_b64 v16, v[196:197] offset:4096
s_waitcnt lgkmcnt(0)
s_branch K1_ATTN
K1_ATT3:
v_lshrrev_b32 v14, 3, v1
v_and_b32 v15, 7, v1
v_xor_b32 v15, v15, v14
v_lshlrev_b32 v15, 4, v15
s_mov_b32 s30, 0
s_mov_b32 s31, 0
s_mov_b32 s29, 0
s_mov_b32 s28, 0
s_mov_b32 s43, 245760
s_mov_b32 s38, 128
s_mov_b32 s39, 49152
s_add_i32 s33, s32, 24
v_add_u32 v2, s33, v14
v_max_i32 v2, 0, v2
v_mul_u32_u24 v2, 1280, v2
v_add_u32 v2, v2, v15
s_waitcnt lgkmcnt(0)
s_mov_b32 s8, s4
s_mov_b32 s9, s5
s_mov_b32 s52, s62
s_mov_b32 s53, s63
s_mov_b32 s12, s6
s_mov_b32 s13, s7
s_add_u32 m0, s29, 3072
s_nop 0
buffer_load_dwordx4 v2, s[8:11], s30 offen lds
s_add_i32 s33, s32, 88
v_add_u32 v3, s33, v14
v_max_i32 v3, 0, v3
v_mul_u32_u24 v3, 1280, v3
v_add_u32 v3, v3, v15
s_add_u32 m0, s29, 11264
s_nop 0
buffer_load_dwordx4 v3, s[8:11], s30 offen lds
v_add_u32 v16, 64, v1
v_mul_u32_u24 v17, 2185, v16
v_lshrrev_b32 v17, 16, v17
v_mul_u32_u24 v18, 30, v17
v_sub_u32 v18, v16, v18
v_and_b32 v19, 0x33, v17
v_and_b32 v20, 4, v17
v_lshl_or_b32 v19, v20, 1, v19
v_bfe_u32 v20, v17, 3, 1
v_lshl_or_b32 v19, v20, 2, v19
v_mul_u32_u24 v20, 6554, v18
v_lshrrev_b32 v20, 16, v20
v_mul_u32_u24 v20, 1120, v20
v_lshl_add_u32 v18, v18, 4, v20
v_mul_u32_u24 v4, 3840, v19
v_add3_u32 v4, v4, v18, s36
s_add_u32 m0, s29, 19456
s_nop 0
buffer_load_dwordx4 v4, s[12:15], s31 offen lds
v_add_u32 v16, 576, v1
v_mul_u32_u24 v17, 2185, v16
v_lshrrev_b32 v17, 16, v17
v_mul_u32_u24 v18, 30, v17
v_sub_u32 v18, v16, v18
v_and_b32 v19, 0x33, v17
v_and_b32 v20, 4, v17
v_lshl_or_b32 v19, v20, 1, v19
v_bfe_u32 v20, v17, 3, 1
v_lshl_or_b32 v19, v20, 2, v19
v_mul_u32_u24 v20, 6554, v18
v_lshrrev_b32 v20, 16, v20
v_mul_u32_u24 v20, 1120, v20
v_lshl_add_u32 v18, v18, 4, v20
v_mul_u32_u24 v5, 3840, v19
v_add3_u32 v5, v5, v18, s36
s_add_u32 m0, s29, 27648
s_nop 0
buffer_load_dwordx4 v5, s[12:15], s31 offen lds
v_add_u32 v16, 1088, v1
v_mul_u32_u24 v17, 2185, v16
v_lshrrev_b32 v17, 16, v17
v_mul_u32_u24 v18, 30, v17
v_sub_u32 v18, v16, v18
v_and_b32 v19, 0x33, v17
v_and_b32 v20, 4, v17
v_lshl_or_b32 v19, v20, 1, v19
v_bfe_u32 v20, v17, 3, 1
v_lshl_or_b32 v19, v20, 2, v19
v_mul_u32_u24 v20, 6554, v18
v_lshrrev_b32 v20, 16, v20
v_mul_u32_u24 v20, 1120, v20
v_lshl_add_u32 v18, v18, 4, v20
v_mul_u32_u24 v6, 3840, v19
v_add3_u32 v6, v6, v18, s36
s_add_u32 m0, s29, 35840
s_nop 0
buffer_load_dwordx4 v6, s[12:15], s31 offen lds
v_add_u32 v16, 1600, v1
v_mul_u32_u24 v17, 2185, v16
v_lshrrev_b32 v17, 16, v17
v_mul_u32_u24 v18, 30, v17
v_sub_u32 v18, v16, v18
v_and_b32 v19, 0x33, v17
v_and_b32 v20, 4, v17
v_lshl_or_b32 v19, v20, 1, v19
v_bfe_u32 v20, v17, 3, 1
v_lshl_or_b32 v19, v20, 2, v19
v_mul_u32_u24 v20, 6554, v18
v_lshrrev_b32 v20, 16, v20
v_mul_u32_u24 v20, 1120, v20
v_lshl_add_u32 v18, v18, 4, v20
v_mul_u32_u24 v7, 3840, v19
v_add3_u32 v7, v7, v18, s36
s_add_u32 m0, s29, 44032
s_nop 0
buffer_load_dwordx4 v7, s[12:15], s31 offen lds
s_add_u32 s30, s30, s38
s_add_u32 s31, s31, s43
s_add_u32 s29, s29, s39
s_cmp_eq_u32 s29, 147456
s_cselect_b32 s29, 0, s29
s_cmp_eq_u32 s30, 1280
s_cselect_b32 s30, 0, s30
s_cselect_b32 s31, 0, s31
s_cselect_b32 s38, 0, s38
s_cselect_b32 s43, 0, s43
s_cselect_b32 s39, 0, s39
s_cselect_b32 s29, 0x30000, s29
s_cselect_b32 s10, 0, s10
s_cselect_b32 s14, 0, s14
s_add_u32 m0, s29, 3072
s_nop 0
buffer_load_dwordx4 v2, s[8:11], s30 offen lds
s_add_u32 m0, s29, 11264
s_nop 0
buffer_load_dwordx4 v3, s[8:11], s30 offen lds
s_add_u32 m0, s29, 19456
s_nop 0
buffer_load_dwordx4 v4, s[12:15], s31 offen lds
s_add_u32 m0, s29, 27648
s_nop 0
buffer_load_dwordx4 v5, s[12:15], s31 offen lds
s_add_u32 m0, s29, 35840
s_nop 0
buffer_load_dwordx4 v6, s[12:15], s31 offen lds
s_add_u32 m0, s29, 44032
s_nop 0
buffer_load_dwordx4 v7, s[12:15], s31 offen lds
s_add_u32 s30, s30, s38
s_add_u32 s31, s31, s43
s_add_u32 s29, s29, s39
s_cmp_eq_u32 s29, 147456
s_cselect_b32 s29, 0, s29
s_cmp_eq_u32 s30, 1280
s_cselect_b32 s30, 0, s30
s_cselect_b32 s31, 0, s31
s_cselect_b32 s38, 0, s38
s_cselect_b32 s43, 0, s43
s_cselect_b32 s39, 0, s39
s_cselect_b32 s29, 0x30000, s29
s_cselect_b32 s10, 0, s10
s_cselect_b32 s14, 0, s14
v_and_b32 v14, 15, v1
v_lshrrev_b32 v15, 4, v1
v_and_b32 v16, 7, v14
v_xor_b32 v16, v16, v15
v_lshlrev_b32 v16, 4, v16
v_lshl_add_u32 v11, v14, 7, v16
v_xor_b32 v12, 64, v11
v_cmp_eq_u32 s[44:45], 0, v14
v_lshrrev_b32 v16, 1, v15
v_lshlrev_b32 v16, 4, v16
v_and_b32 v17, 1, v15
v_lshl_add_u32 v16, v17, 2, v16
v_bfe_u32 v17, v1, 2, 2
v_add_u32 v16, v16, v17
v_mul_u32_u24 v16, 480, v16
v_and_b32 v17, 3, v1
v_lshl_add_u32 v16, v17, 3, v16
v_add_u32 v13, 18432, v16
v_mov_b32 v132, 0
v_mov_b32 v133, 0
v_mov_b32 v134, 0
v_mov_b32 v135, 0
v_mov_b32 v136, 0
v_mov_b32 v137, 0
v_mov_b32 v138, 0
v_mov_b32 v139, 0
v_mov_b32 v140, 0
v_mov_b32 v141, 0
v_mov_b32 v142, 0
v_mov_b32 v143, 0
v_mov_b32 v144, 0
v_mov_b32 v145, 0
v_mov_b32 v146, 0
v_mov_b32 v147, 0
v_mov_b32 v148, 0
v_mov_b32 v149, 0
v_mov_b32 v150, 0
v_mov_b32 v151, 0
v_mov_b32 v152, 0
v_mov_b32 v153, 0
v_mov_b32 v154, 0
v_mov_b32 v155, 0
v_mov_b32 v156, 0
v_mov_b32 v157, 0
v_mov_b32 v158, 0
v_mov_b32 v159, 0
v_mov_b32 v160, 0
v_mov_b32 v161, 0
v_mov_b32 v162, 0
v_mov_b32 v163, 0
v_mov_b32 v164, 0
v_mov_b32 v165, 0
v_mov_b32 v166, 0
v_mov_b32 v167, 0
v_mov_b32 v168, 0
v_mov_b32 v169, 0
v_mov_b32 v170, 0
v_mov_b32 v171, 0
v_mov_b32 v172, 0
v_mov_b32 v173, 0
v_mov_b32 v174, 0
v_mov_b32 v175, 0
v_mov_b32 v176, 0
v_mov_b32 v177, 0
v_mov_b32 v178, 0
v_mov_b32 v179, 0
v_mov_b32 v180, 0
v_mov_b32 v181, 0
v_mov_b32 v182, 0
v_mov_b32 v183, 0
v_mov_b32 v184, 0
v_mov_b32 v185, 0
v_mov_b32 v186, 0
v_mov_b32 v187, 0
v_mov_b32 v188, 0
v_mov_b32 v189, 0
v_mov_b32 v190, 0
v_mov_b32 v191, 0
v_mov_b32 v192, 0
v_mov_b32 v193, 0
v_mov_b32 v194, 0
v_mov_b32 v195, 0
v_mov_b32 v196, 0
v_mov_b32 v197, 0
v_mov_b32 v198, 0
v_mov_b32 v199, 0
v_mov_b32 v200, 0
v_mov_b32 v201, 0
v_mov_b32 v202, 0
v_mov_b32 v203, 0
v_mov_b32 v204, 0
v_mov_b32 v205, 0
v_mov_b32 v206, 0
v_mov_b32 v207, 0
v_mov_b32 v32, 0x3f803f80
v_mov_b32 v33, 0x3f803f80
v_mov_b32 v34, 0x3f803f80
v_mov_b32 v35, 0x3f803f80
s_waitcnt vmcnt(6)
s_barrier
v_add_u32 v8, s28, v11
v_add_u32 v9, s28, v12
v_add_u32 v10, s28, v13
RX 40,8,2048
RX 44,8,4096
RX 48,8,6144
RX 52,8,8192
TR 56,10,384
TR 58,10,4224
RX 36,8,0
TR 60,10,416
TR 62,10,4256
TR 64,10,448
TR 66,10,4288
TR 68,10,64
TR 70,10,3904
TR 72,10,96
TR 74,10,3936
s_add_u32 m0, s29, 3072
s_nop 0
buffer_load_dwordx4 v2, s[8:11], s30 offen lds
s_add_u32 m0, s29, 11264
s_nop 0
buffer_load_dwordx4 v3, s[8:11], s30 offen lds
s_add_u32 m0, s29, 19456
s_nop 0
buffer_load_dwordx4 v4, s[12:15], s31 offen lds
s_add_u32 m0, s29, 27648
s_nop 0
buffer_load_dwordx4 v5, s[12:15], s31 offen lds
s_add_u32 m0, s29, 35840
s_nop 0
buffer_load_dwordx4 v6, s[12:15], s31 offen lds
s_add_u32 m0, s29, 44032
s_nop 0
buffer_load_dwordx4 v7, s[12:15], s31 offen lds
s_add_u32 s30, s30, s38
s_add_u32 s31, s31, s43
s_add_u32 s29, s29, s39
s_cmp_eq_u32 s29, 147456
s_cselect_b32 s29, 0, s29
s_cmp_eq_u32 s30, 1280
s_cselect_b32 s30, 0, s30
s_cselect_b32 s31, 0, s31
s_cselect_b32 s38, 0, s38
s_cselect_b32 s43, 0, s43
s_cselect_b32 s39, 0, s39
s_cselect_b32 s29, 0x30000, s29
s_cselect_b32 s10, 0, s10
s_cselect_b32 s14, 0, s14
s_mov_b32 s27, 0
s_waitcnt lgkmcnt(0)
K1Latt3:
M 132,56,40
RX 88,9,2048
M 136,56,44
RX 92,9,4096
M 140,56,48
RX 96,9,6144
M 144,56,52
RX 100,9,8192
M 148,60,40
TR 104,10,15744
M 152,60,44
TR 106,10,19584
M 156,60,48
RX 84,9,0
M 160,60,52
TR 108,10,15776
M 164,64,40
TR 110,10,19616
v_cndmask_b32 v36, v36, v32, s[44:45]
v_cndmask_b32 v37, v37, v32, s[44:45]
v_cndmask_b32 v38, v38, v32, s[44:45]
v_cndmask_b32 v39, v39, v32, s[44:45]
M 168,64,44
TR 112,10,15808
M 172,64,48
TR 114,10,19648
M 176,64,52
TR 116,10,15424
M 180,56,36
TR 118,10,19264
M 184,60,36
TR 120,10,15456
M 188,64,36
TR 122,10,19296
M 192,68,36
s_add_u32 s28, s28, 49152
s_cmp_eq_u32 s28, 147456
s_cselect_b32 s28, 0, s28
M 196,72,36
v_add_u32 v8, s28, v11
v_add_u32 v9, s28, v12
v_add_u32 v10, s28, v13
M 200,32,52
s_cmp_eq_u32 s27, 9
M 204,52,52
s_cbranch_scc1 K1Eatt3
s_waitcnt vmcnt(6) lgkmcnt(0)
s_barrier
M 132,104,88
s_add_u32 m0, s29, 3072
RX 40,8,2048
buffer_load_dwordx4 v2, s[8:11], s30 offen lds
M 136,104,92
s_add_u32 m0, s29, 11264
RX 44,8,4096
buffer_load_dwordx4 v3, s[8:11], s30 offen lds
M 140,104,96
s_add_u32 m0, s29, 19456
RX 48,8,6144
buffer_load_dwordx4 v4, s[12:15], s31 offen lds
M 144,104,100
s_add_u32 m0, s29, 27648
RX 52,8,8192
buffer_load_dwordx4 v5, s[12:15], s31 offen lds
M 148,108,88
s_add_u32 m0, s29, 35840
TR 56,10,384
buffer_load_dwordx4 v6, s[12:15], s31 offen lds
M 152,108,92
s_add_u32 m0, s29, 44032
TR 58,10,4224
buffer_load_dwordx4 v7, s[12:15], s31 offen lds
M 156,108,96
RX 36,8,0
M 160,108,100
TR 60,10,416
M 164,112,88
TR 62,10,4256
v_cndmask_b32 v84, v84, v32, s[44:45]
v_cndmask_b32 v85, v85, v32, s[44:45]
v_cndmask_b32 v86, v86, v32, s[44:45]
v_cndmask_b32 v87, v87, v32, s[44:45]
M 168,112,92
TR 64,10,448
M 172,112,96
TR 66,10,4288
M 176,112,100
TR 68,10,64
M 180,104,84
TR 70,10,3904
M 184,108,84
TR 72,10,96
M 188,112,84
TR 74,10,3936
M 192,116,84
s_add_u32 s30, s30, s38
s_add_u32 s31, s31, s43
s_add_u32 s29, s29, s39
M 196,120,84
s_cmp_eq_u32 s29, 147456
s_cselect_b32 s29, 0, s29
s_cmp_eq_u32 s30, 1280
M 200,32,100
s_cselect_b32 s30, 0, s30
s_cselect_b32 s31, 0, s31
s_cselect_b32 s38, 0, s38
M 204,100,100
s_cselect_b32 s43, 0, s43
s_cselect_b32 s39, 0, s39
s_cselect_b32 s29, 0x30000, s29
s_cselect_b32 s10, 0, s10
s_cselect_b32 s14, 0, s14
s_add_u32 s27, s27, 1
s_waitcnt lgkmcnt(0)
s_branch K1Latt3
K1Eatt3:
s_waitcnt lgkmcnt(0)
M 132,104,88
M 136,104,92
M 140,104,96
M 144,104,100
M 148,108,88
M 152,108,92
M 156,108,96
M 160,108,100
M 164,112,88
v_cndmask_b32 v84, v84, v32, s[44:45]
v_cndmask_b32 v85, v85, v32, s[44:45]
v_cndmask_b32 v86, v86, v32, s[44:45]
v_cndmask_b32 v87, v87, v32, s[44:45]
M 168,112,92
M 172,112,96
M 176,112,100
M 180,104,84
M 184,108,84
M 188,112,84
M 192,116,84
M 196,120,84
M 200,32,100
M 204,100,100
s_waitcnt vmcnt(0)
s_nop 7
s_nop 3
v_and_b32 v14, 15, v1
v_lshrrev_b32 v15, 4, v1
v_lshrrev_b32 v16, 2, v14
v_and_b32 v17, 3, v14
v_cmp_eq_u32 s[46:47], v16, v15
v_cmp_eq_u32 s[48:49], 1, v17
v_cmp_eq_u32 s[54:55], 2, v17
v_cmp_eq_u32 s[56:57], 3, v17
v_lshlrev_b32 v18, 2, v14
v_add_u32 v18, 98304, v18
s_mov_b32 s33, 0x3acccccd
s_mov_b32 s34, 0x3727c5ac
v_cndmask_b32 v204, v204, v205, s[48:49]
v_cndmask_b32 v204, v204, v206, s[54:55]
v_cndmask_b32 v204, v204, v207, s[56:57]
v_mul_f32 v200, s33, v200
v_mul_f32 v204, s33, v204
v_fma_f32 v204, -v200, v200, v204
v_max_f32 v204, 0, v204
v_add_f32 v204, s34, v204
v_rsq_f32 v204, v204
s_mov_b64 exec, s[46:47]
ds_write_b32 v18, v200 offset:256
ds_write_b32 v18, v204 offset:832
s_mov_b64 exec, -1
v_add_u32 v19, 98304, v1
s_mov_b64 exec, s[44:45]
ds_write_b128 v19, v[180:183] offset:1920
ds_write_b128 v19, v[184:187] offset:1984
ds_write_b128 v19, v[188:191] offset:2048
ds_write_b128 v19, v[192:195] offset:1280
ds_write_b128 v19, v[196:199] offset:1344
s_mov_b64 exec, -1
s_waitcnt lgkmcnt(0)
s_barrier
v_and_b32 v14, 15, v1
v_lshlrev_b32 v14, 2, v14
v_lshrrev_b32 v15, 4, v1
v_lshlrev_b32 v15, 4, v15
v_add_u32 v14, 98304, v14
v_add_u32 v15, 98304, v15
ds_read_b32 v36, v14 offset:0
ds_read_b32 v38, v14 offset:576
ds_read_b32 v42, v14 offset:64
ds_read_b32 v44, v14 offset:640
ds_read_b32 v48, v14 offset:128
ds_read_b32 v50, v14 offset:704
ds_read_b32 v54, v14 offset:192
ds_read_b32 v56, v14 offset:768
ds_read_b32 v60, v14 offset:256
ds_read_b32 v62, v14 offset:832
ds_read_b128 v[68:71], v15 offset:1920
ds_read_b128 v[72:75], v15 offset:1984
ds_read_b128 v[76:79], v15 offset:2048
s_waitcnt lgkmcnt(0)
v_lshlrev_b32 v16, 3, v1
v_and_b32 v17, 15, v1
v_lshrrev_b32 v18, 4, v1
v_lshlrev_b32 v18, 3, v18
v_lshl_add_u32 v17, v17, 5, v18
v_add_u32 v18, 32768, v16
v_add_u32 v19, 32768, v17
PFN 132,42,68
PFN 134,42,70
PMB 132,44,132
PMB 134,44,134
CV 132,132,133
CV 133,134,135
PFN 136,48,68
PFN 138,48,70
PMB 136,50,136
PMB 138,50,138
CV 136,136,137
CV 137,138,139
PFN 140,54,68
PFN 142,54,70
PMB 140,56,140
PMB 142,56,142
CV 140,140,141
CV 141,142,143
PFN 144,60,68
PFN 146,60,70
PMB 144,62,144
PMB 146,62,146
CV 144,144,145
CV 145,146,147
PFN 148,42,72
PFN 150,42,74
PMB 148,44,148
PMB 150,44,150
CV 148,148,149
CV 149,150,151
PFN 152,48,72
PFN 154,48,74
PMB 152,50,152
PMB 154,50,154
CV 152,152,153
CV 153,154,155
PFN 156,54,72
PFN 158,54,74
PMB 156,56,156
PMB 158,56,158
CV 156,156,157
CV 157,158,159
PFN 160,60,72
PFN 162,60,74
PMB 160,62,160
PMB 162,62,162
CV 160,160,161
CV 161,162,163
PFN 164,42,76
PFN 166,42,78
PMB 164,44,164
PMB 166,44,166
CV 164,164,165
CV 165,166,167
PFN 168,48,76
PFN 170,48,78
PMB 168,50,168
PMB 170,50,170
CV 168,168,169
CV 169,170,171
PFN 172,54,76
PFN 174,54,78
PMB 172,56,172
PMB 174,56,174
CV 172,172,173
CV 173,174,175
PFN 176,60,76
PFN 178,60,78
PMB 176,62,176
PMB 178,62,178
CV 176,176,177
CV 177,178,179
PFN 180,36,68
PFN 182,36,70
PMB 180,38,180
PMB 182,38,182
CV 180,180,181
CV 181,182,183
PFN 184,36,72
PFN 186,36,74
PMB 184,38,184
PMB 186,38,186
CV 184,184,185
CV 185,186,187
PFN 188,36,76
PFN 190,36,78
PMB 188,38,188
PMB 190,38,190
CV 188,188,189
CV 189,190,191
ds_write_b64 v17, v[132:133] offset:13824
ds_write_b64 v17, v[136:137] offset:21504
ds_write_b64 v17, v[140:141] offset:29184
ds_write_b64 v19, v[144:145] offset:4096
ds_write_b64 v17, v[148:149] offset:14336
ds_write_b64 v17, v[152:153] offset:22016
ds_write_b64 v17, v[156:157] offset:29696
ds_write_b64 v19, v[160:161] offset:4608
ds_write_b64 v17, v[164:165] offset:14848
ds_write_b64 v17, v[168:169] offset:22528
ds_write_b64 v17, v[172:173] offset:30208
ds_write_b64 v19, v[176:177] offset:5120
ds_write_b64 v17, v[180:181] offset:6144
ds_write_b64 v17, v[184:185] offset:6656
ds_write_b64 v17, v[188:189] offset:7168
s_waitcnt lgkmcnt(0)
s_branch K1_ATTN
K1_ATT4:
v_lshrrev_b32 v14, 3, v1
v_and_b32 v15, 7, v1
v_xor_b32 v15, v15, v14
v_lshlrev_b32 v15, 4, v15
s_mov_b32 s30, 0
s_mov_b32 s31, 0
s_mov_b32 s29, 0
s_mov_b32 s28, 0
s_mov_b32 s43, 245760
s_mov_b32 s38, 128
s_mov_b32 s39, 49152
s_add_i32 s33, s32, 32
v_add_u32 v2, s33, v14
v_max_i32 v2, 0, v2
v_mul_u32_u24 v2, 1280, v2
v_add_u32 v2, v2, v15
s_waitcnt lgkmcnt(0)
s_mov_b32 s8, s4
s_mov_b32 s9, s5
s_mov_b32 s52, s62
s_mov_b32 s53, s63
s_mov_b32 s12, s6
s_mov_b32 s13, s7
s_add_u32 m0, s29, 4096
s_nop 0
buffer_load_dwordx4 v2, s[8:11], s30 offen lds
s_add_i32 s33, s32, 96
v_add_u32 v3, s33, v14
v_max_i32 v3, 0, v3
v_mul_u32_u24 v3, 1280, v3
v_add_u32 v3, v3, v15
s_add_u32 m0, s29, 12288
s_nop 0
buffer_load_dwordx4 v3, s[8:11], s30 offen lds
v_add_u32 v16, 128, v1
v_mul_u32_u24 v17, 2185, v16
v_lshrrev_b32 v17, 16, v17
v_mul_u32_u24 v18, 30, v17
v_sub_u32 v18, v16, v18
v_and_b32 v19, 0x33, v17
v_and_b32 v20, 4, v17
v_lshl_or_b32 v19, v20, 1, v19
v_bfe_u32 v20, v17, 3, 1
v_lshl_or_b32 v19, v20, 2, v19
v_mul_u32_u24 v20, 6554, v18
v_lshrrev_b32 v20, 16, v20
v_mul_u32_u24 v20, 1120, v20
v_lshl_add_u32 v18, v18, 4, v20
v_mul_u32_u24 v4, 3840, v19
v_add3_u32 v4, v4, v18, s36
s_add_u32 m0, s29, 20480
s_nop 0
buffer_load_dwordx4 v4, s[12:15], s31 offen lds
v_add_u32 v16, 640, v1
v_mul_u32_u24 v17, 2185, v16
v_lshrrev_b32 v17, 16, v17
v_mul_u32_u24 v18, 30, v17
v_sub_u32 v18, v16, v18
v_and_b32 v19, 0x33, v17
v_and_b32 v20, 4, v17
v_lshl_or_b32 v19, v20, 1, v19
v_bfe_u32 v20, v17, 3, 1
v_lshl_or_b32 v19, v20, 2, v19
v_mul_u32_u24 v20, 6554, v18
v_lshrrev_b32 v20, 16, v20
v_mul_u32_u24 v20, 1120, v20
v_lshl_add_u32 v18, v18, 4, v20
v_mul_u32_u24 v5, 3840, v19
v_add3_u32 v5, v5, v18, s36
s_add_u32 m0, s29, 28672
s_nop 0
buffer_load_dwordx4 v5, s[12:15], s31 offen lds
v_add_u32 v16, 1152, v1
v_mul_u32_u24 v17, 2185, v16
v_lshrrev_b32 v17, 16, v17
v_mul_u32_u24 v18, 30, v17
v_sub_u32 v18, v16, v18
v_and_b32 v19, 0x33, v17
v_and_b32 v20, 4, v17
v_lshl_or_b32 v19, v20, 1, v19
v_bfe_u32 v20, v17, 3, 1
v_lshl_or_b32 v19, v20, 2, v19
v_mul_u32_u24 v20, 6554, v18
v_lshrrev_b32 v20, 16, v20
v_mul_u32_u24 v20, 1120, v20
v_lshl_add_u32 v18, v18, 4, v20
v_mul_u32_u24 v6, 3840, v19
v_add3_u32 v6, v6, v18, s36
s_add_u32 m0, s29, 36864
s_nop 0
buffer_load_dwordx4 v6, s[12:15], s31 offen lds
v_add_u32 v16, 1664, v1
v_mul_u32_u24 v17, 2185, v16
v_lshrrev_b32 v17, 16, v17
v_mul_u32_u24 v18, 30, v17
v_sub_u32 v18, v16, v18
v_and_b32 v19, 0x33, v17
v_and_b32 v20, 4, v17
v_lshl_or_b32 v19, v20, 1, v19
v_bfe_u32 v20, v17, 3, 1
v_lshl_or_b32 v19, v20, 2, v19
v_mul_u32_u24 v20, 6554, v18
v_lshrrev_b32 v20, 16, v20
v_mul_u32_u24 v20, 1120, v20
v_lshl_add_u32 v18, v18, 4, v20
v_mul_u32_u24 v7, 3840, v19
v_add3_u32 v7, v7, v18, s36
s_add_u32 m0, s29, 45056
s_nop 0
buffer_load_dwordx4 v7, s[12:15], s31 offen lds
s_add_u32 s30, s30, s38
s_add_u32 s31, s31, s43
s_add_u32 s29, s29, s39
s_cmp_eq_u32 s29, 147456
s_cselect_b32 s29, 0, s29
s_cmp_eq_u32 s30, 1280
s_cselect_b32 s30, 0, s30
s_cselect_b32 s31, 0, s31
s_cselect_b32 s38, 0, s38
s_cselect_b32 s43, 0, s43
s_cselect_b32 s39, 0, s39
s_cselect_b32 s29, 0x30000, s29
s_cselect_b32 s10, 0, s10
s_cselect_b32 s14, 0, s14
s_add_u32 m0, s29, 4096
s_nop 0
buffer_load_dwordx4 v2, s[8:11], s30 offen lds
s_add_u32 m0, s29, 12288
s_nop 0
buffer_load_dwordx4 v3, s[8:11], s30 offen lds
s_add_u32 m0, s29, 20480
s_nop 0
buffer_load_dwordx4 v4, s[12:15], s31 offen lds
s_add_u32 m0, s29, 28672
s_nop 0
buffer_load_dwordx4 v5, s[12:15], s31 offen lds
s_add_u32 m0, s29, 36864
s_nop 0
buffer_load_dwordx4 v6, s[12:15], s31 offen lds
s_add_u32 m0, s29, 45056
s_nop 0
buffer_load_dwordx4 v7, s[12:15], s31 offen lds
s_add_u32 s30, s30, s38
s_add_u32 s31, s31, s43
s_add_u32 s29, s29, s39
s_cmp_eq_u32 s29, 147456
s_cselect_b32 s29, 0, s29
s_cmp_eq_u32 s30, 1280
s_cselect_b32 s30, 0, s30
s_cselect_b32 s31, 0, s31
s_cselect_b32 s38, 0, s38
s_cselect_b32 s43, 0, s43
s_cselect_b32 s39, 0, s39
s_cselect_b32 s29, 0x30000, s29
s_cselect_b32 s10, 0, s10
s_cselect_b32 s14, 0, s14
v_and_b32 v14, 15, v1
v_lshrrev_b32 v15, 4, v1
v_and_b32 v16, 7, v14
v_xor_b32 v16, v16, v15
v_lshlrev_b32 v16, 4, v16
v_lshl_add_u32 v11, v14, 7, v16
v_xor_b32 v12, 64, v11
v_cmp_eq_u32 s[44:45], 0, v14
v_lshrrev_b32 v16, 1, v15
v_lshlrev_b32 v16, 4, v16
v_and_b32 v17, 1, v15
v_lshl_add_u32 v16, v17, 2, v16
v_bfe_u32 v17, v1, 2, 2
v_add_u32 v16, v16, v17
v_mul_u32_u24 v16, 480, v16
v_and_b32 v17, 3, v1
v_lshl_add_u32 v16, v17, 3, v16
v_add_u32 v13, 18432, v16
v_mov_b32 v132, 0
v_mov_b32 v133, 0
v_mov_b32 v134, 0
v_mov_b32 v135, 0
v_mov_b32 v136, 0
v_mov_b32 v137, 0
v_mov_b32 v138, 0
v_mov_b32 v139, 0
v_mov_b32 v140, 0
v_mov_b32 v141, 0
v_mov_b32 v142, 0
v_mov_b32 v143, 0
v_mov_b32 v144, 0
v_mov_b32 v145, 0
v_mov_b32 v146, 0
v_mov_b32 v147, 0
v_mov_b32 v148, 0
v_mov_b32 v149, 0
v_mov_b32 v150, 0
v_mov_b32 v151, 0
v_mov_b32 v152, 0
v_mov_b32 v153, 0
v_mov_b32 v154, 0
v_mov_b32 v155, 0
v_mov_b32 v156, 0
v_mov_b32 v157, 0
v_mov_b32 v158, 0
v_mov_b32 v159, 0
v_mov_b32 v160, 0
v_mov_b32 v161, 0
v_mov_b32 v162, 0
v_mov_b32 v163, 0
v_mov_b32 v164, 0
v_mov_b32 v165, 0
v_mov_b32 v166, 0
v_mov_b32 v167, 0
v_mov_b32 v168, 0
v_mov_b32 v169, 0
v_mov_b32 v170, 0
v_mov_b32 v171, 0
v_mov_b32 v172, 0
v_mov_b32 v173, 0
v_mov_b32 v174, 0
v_mov_b32 v175, 0
v_mov_b32 v176, 0
v_mov_b32 v177, 0
v_mov_b32 v178, 0
v_mov_b32 v179, 0
v_mov_b32 v180, 0
v_mov_b32 v181, 0
v_mov_b32 v182, 0
v_mov_b32 v183, 0
v_mov_b32 v184, 0
v_mov_b32 v185, 0
v_mov_b32 v186, 0
v_mov_b32 v187, 0
v_mov_b32 v188, 0
v_mov_b32 v189, 0
v_mov_b32 v190, 0
v_mov_b32 v191, 0
v_mov_b32 v192, 0
v_mov_b32 v193, 0
v_mov_b32 v194, 0
v_mov_b32 v195, 0
v_mov_b32 v196, 0
v_mov_b32 v197, 0
v_mov_b32 v198, 0
v_mov_b32 v199, 0
v_mov_b32 v200, 0
v_mov_b32 v201, 0
v_mov_b32 v202, 0
v_mov_b32 v203, 0
v_mov_b32 v204, 0
v_mov_b32 v205, 0
v_mov_b32 v206, 0
v_mov_b32 v207, 0
v_mov_b32 v32, 0x3f803f80
v_mov_b32 v33, 0x3f803f80
v_mov_b32 v34, 0x3f803f80
v_mov_b32 v35, 0x3f803f80
s_waitcnt vmcnt(6)
s_barrier
v_add_u32 v8, s28, v11
v_add_u32 v9, s28, v12
v_add_u32 v10, s28, v13
RX 40,8,10240
RX 44,8,12288
RX 48,8,14336
RX 52,8,16384
TR 56,10,0
TR 58,10,3840
RX 36,8,0
TR 60,10,32
TR 62,10,3872
TR 64,10,64
TR 66,10,3904
TR 68,10,96
TR 70,10,3936
s_add_u32 m0, s29, 4096
s_nop 0
buffer_load_dwordx4 v2, s[8:11], s30 offen lds
s_add_u32 m0, s29, 12288
s_nop 0
buffer_load_dwordx4 v3, s[8:11], s30 offen lds
s_add_u32 m0, s29, 20480
s_nop 0
buffer_load_dwordx4 v4, s[12:15], s31 offen lds
s_add_u32 m0, s29, 28672
s_nop 0
buffer_load_dwordx4 v5, s[12:15], s31 offen lds
s_add_u32 m0, s29, 36864
s_nop 0
buffer_load_dwordx4 v6, s[12:15], s31 offen lds
s_add_u32 m0, s29, 45056
s_nop 0
buffer_load_dwordx4 v7, s[12:15], s31 offen lds
s_add_u32 s30, s30, s38
s_add_u32 s31, s31, s43
s_add_u32 s29, s29, s39
s_cmp_eq_u32 s29, 147456
s_cselect_b32 s29, 0, s29
s_cmp_eq_u32 s30, 1280
s_cselect_b32 s30, 0, s30
s_cselect_b32 s31, 0, s31
s_cselect_b32 s38, 0, s38
s_cselect_b32 s43, 0, s43
s_cselect_b32 s39, 0, s39
s_cselect_b32 s29, 0x30000, s29
s_cselect_b32 s10, 0, s10
s_cselect_b32 s14, 0, s14
s_mov_b32 s27, 0
s_waitcnt lgkmcnt(0)
K1Latt4:
M 132,56,40
RX 88,9,10240
M 136,56,44
RX 92,9,12288
M 140,56,48
RX 96,9,14336
M 144,56,52
RX 100,9,16384
M 148,60,40
TR 104,10,15360
M 152,60,44
TR 106,10,19200
M 156,60,48
RX 84,9,0
M 160,60,52
TR 108,10,15392
M 164,64,40
TR 110,10,19232
M 168,64,44
TR 112,10,15424
M 172,64,48
TR 114,10,19264
M 176,64,52
TR 116,10,15456
M 180,68,40
TR 118,10,19296
v_cndmask_b32 v36, v36, v32, s[44:45]
v_cndmask_b32 v37, v37, v32, s[44:45]
v_cndmask_b32 v38, v38, v32, s[44:45]
v_cndmask_b32 v39, v39, v32, s[44:45]
M 184,68,44
M 188,68,48
s_add_u32 s28, s28, 49152
s_cmp_eq_u32 s28, 147456
s_cselect_b32 s28, 0, s28
M 192,68,52
v_add_u32 v8, s28, v11
v_add_u32 v9, s28, v12
v_add_u32 v10, s28, v13
M 196,60,36
s_cmp_eq_u32 s27, 9
M 200,32,40
M 204,40,40
s_cbranch_scc1 K1Eatt4
s_waitcnt vmcnt(6) lgkmcnt(0)
s_barrier
M 132,104,88
s_add_u32 m0, s29, 4096
RX 40,8,10240
buffer_load_dwordx4 v2, s[8:11], s30 offen lds
M 136,104,92
s_add_u32 m0, s29, 12288
RX 44,8,12288
buffer_load_dwordx4 v3, s[8:11], s30 offen lds
M 140,104,96
s_add_u32 m0, s29, 20480
RX 48,8,14336
buffer_load_dwordx4 v4, s[12:15], s31 offen lds
M 144,104,100
s_add_u32 m0, s29, 28672
RX 52,8,16384
buffer_load_dwordx4 v5, s[12:15], s31 offen lds
M 148,108,88
s_add_u32 m0, s29, 36864
TR 56,10,0
buffer_load_dwordx4 v6, s[12:15], s31 offen lds
M 152,108,92
s_add_u32 m0, s29, 45056
TR 58,10,3840
buffer_load_dwordx4 v7, s[12:15], s31 offen lds
M 156,108,96
RX 36,8,0
M 160,108,100
TR 60,10,32
M 164,112,88
TR 62,10,3872
M 168,112,92
TR 64,10,64
M 172,112,96
TR 66,10,3904
M 176,112,100
TR 68,10,96
M 180,116,88
TR 70,10,3936
v_cndmask_b32 v84, v84, v32, s[44:45]
v_cndmask_b32 v85, v85, v32, s[44:45]
v_cndmask_b32 v86, v86, v32, s[44:45]
v_cndmask_b32 v87, v87, v32, s[44:45]
M 184,116,92
s_add_u32 s30, s30, s38
s_add_u32 s31, s31, s43
s_add_u32 s29, s29, s39
M 188,116,96
s_cmp_eq_u32 s29, 147456
s_cselect_b32 s29, 0, s29
s_cmp_eq_u32 s30, 1280
M 192,116,100
s_cselect_b32 s30, 0, s30
s_cselect_b32 s31, 0, s31
s_cselect_b32 s38, 0, s38
M 196,108,84
s_cselect_b32 s43, 0, s43
s_cselect_b32 s39, 0, s39
s_cselect_b32 s29, 0x30000, s29
M 200,32,88
s_cselect_b32 s10, 0, s10
s_cselect_b32 s14, 0, s14
s_add_u32 s27, s27, 1
M 204,88,88
s_waitcnt lgkmcnt(0)
s_branch K1Latt4
K1Eatt4:
s_waitcnt lgkmcnt(0)
M 132,104,88
M 136,104,92
M 140,104,96
M 144,104,100
M 148,108,88
M 152,108,92
M 156,108,96
M 160,108,100
M 164,112,88
M 168,112,92
M 172,112,96
M 176,112,100
M 180,116,88
v_cndmask_b32 v84, v84, v32, s[44:45]
v_cndmask_b32 v85, v85, v32, s[44:45]
v_cndmask_b32 v86, v86, v32, s[44:45]
v_cndmask_b32 v87, v87, v32, s[44:45]
M 184,116,92
M 188,116,96
M 192,116,100
M 196,108,84
M 200,32,88
M 204,88,88
s_waitcnt vmcnt(0)
s_nop 7
s_nop 3
v_and_b32 v14, 15, v1
v_lshrrev_b32 v15, 4, v1
v_lshrrev_b32 v16, 2, v14
v_and_b32 v17, 3, v14
v_cmp_eq_u32 s[46:47], v16, v15
v_cmp_eq_u32 s[48:49], 1, v17
v_cmp_eq_u32 s[54:55], 2, v17
v_cmp_eq_u32 s[56:57], 3, v17
v_lshlrev_b32 v18, 2, v14
v_add_u32 v18, 98304, v18
s_mov_b32 s33, 0x3acccccd
s_mov_b32 s34, 0x3727c5ac
v_cndmask_b32 v204, v204, v205, s[48:49]
v_cndmask_b32 v204, v204, v206, s[54:55]
v_cndmask_b32 v204, v204, v207, s[56:57]
v_mul_f32 v200, s33, v200
v_mul_f32 v204, s33, v204
v_fma_f32 v204, -v200, v200, v204
v_max_f32 v204, 0, v204
v_add_f32 v204, s34, v204
v_rsq_f32 v204, v204
s_mov_b64 exec, s[46:47]
ds_write_b32 v18, v200 offset:320
ds_write_b32 v18, v204 offset:896
s_mov_b64 exec, -1
v_add_u32 v19, 98304, v1
s_mov_b64 exec, s[44:45]
ds_write_b128 v19, v[196:199] offset:1216
s_mov_b64 exec, -1
s_waitcnt lgkmcnt(0)
s_barrier
v_and_b32 v14, 15, v1
v_lshlrev_b32 v14, 2, v14
v_lshrrev_b32 v15, 4, v1
v_lshlrev_b32 v15, 4, v15
v_add_u32 v14, 98304, v14
v_add_u32 v15, 98304, v15
ds_read_b32 v36, v14 offset:320
ds_read_b32 v38, v14 offset:896
ds_read_b32 v42, v14 offset:384
ds_read_b32 v44, v14 offset:960
ds_read_b32 v48, v14 offset:448
ds_read_b32 v50, v14 offset:1024
ds_read_b32 v54, v14 offset:512
ds_read_b32 v56, v14 offset:1088
ds_read_b128 v[60:63], v15 offset:1152
ds_read_b128 v[64:67], v15 offset:1216
ds_read_b128 v[68:71], v15 offset:1280
ds_read_b128 v[72:75], v15 offset:1344
s_waitcnt lgkmcnt(0)
v_lshlrev_b32 v16, 3, v1
v_and_b32 v17, 15, v1
v_lshrrev_b32 v18, 4, v1
v_lshlrev_b32 v18, 3, v18
v_lshl_add_u32 v17, v17, 5, v18
v_add_u32 v18, 32768, v16
v_add_u32 v19, 32768, v17
PFN 132,36,60
PFN 134,36,62
PMB 132,38,132
PMB 134,38,134
CV 132,132,133
CV 133,134,135
PFN 136,42,60
PFN 138,42,62
PMB 136,44,136
PMB 138,44,138
CV 136,136,137
CV 137,138,139
PFN 140,48,60
PFN 142,48,62
PMB 140,50,140
PMB 142,50,142
CV 140,140,141
CV 141,142,143
PFN 144,54,60
PFN 146,54,62
PMB 144,56,144
PMB 146,56,146
CV 144,144,145
CV 145,146,147
PFN 148,36,64
PFN 150,36,66
PMB 148,38,148
PMB 150,38,150
CV 148,148,149
CV 149,150,151
PFN 152,42,64
PFN 154,42,66
PMB 152,44,152
PMB 154,44,154
CV 152,152,153
CV 153,154,155
PFN 156,48,64
PFN 158,48,66
PMB 156,50,156
PMB 158,50,158
CV 156,156,157
CV 157,158,159
PFN 160,54,64
PFN 162,54,66
PMB 160,56,160
PMB 162,56,162
CV 160,160,161
CV 161,162,163
PFN 164,36,68
PFN 166,36,70
PMB 164,38,164
PMB 166,38,166
CV 164,164,165
CV 165,166,167
PFN 168,42,68
PFN 170,42,70
PMB 168,44,168
PMB 170,44,170
CV 168,168,169
CV 169,170,171
PFN 172,48,68
PFN 174,48,70
PMB 172,50,172
PMB 174,50,174
CV 172,172,173
CV 173,174,175
PFN 176,54,68
PFN 178,54,70
PMB 176,56,176
PMB 178,56,178
CV 176,176,177
CV 177,178,179
PFN 180,36,72
PFN 182,36,74
PMB 180,38,180
PMB 182,38,182
CV 180,180,181
CV 181,182,183
PFN 184,42,72
PFN 186,42,74
PMB 184,44,184
PMB 186,44,186
CV 184,184,185
CV 185,186,187
PFN 188,48,72
PFN 190,48,74
PMB 188,50,188
PMB 190,50,190
CV 188,188,189
CV 189,190,191
PFN 192,54,72
PFN 194,54,74
PMB 192,56,192
PMB 194,56,194
CV 192,192,193
CV 193,194,195
ds_write_b64 v18, v[132:133] offset:5632
ds_write_b64 v18, v[136:137] offset:13312
ds_write_b64 v18, v[140:141] offset:20992
ds_write_b64 v18, v[144:145] offset:28672
ds_write_b64 v18, v[148:149] offset:6144
ds_write_b64 v18, v[152:153] offset:13824
ds_write_b64 v18, v[156:157] offset:21504
ds_write_b64 v18, v[160:161] offset:29184
ds_write_b64 v18, v[164:165] offset:6656
ds_write_b64 v18, v[168:169] offset:14336
ds_write_b64 v18, v[172:173] offset:22016
ds_write_b64 v18, v[176:177] offset:29696
ds_write_b64 v18, v[180:181] offset:7168
ds_write_b64 v18, v[184:185] offset:14848
ds_write_b64 v18, v[188:189] offset:22528
ds_write_b64 v18, v[192:193] offset:30208
s_waitcnt lgkmcnt(0)
s_branch K1_ATTN
K1_ATT5:
v_lshrrev_b32 v14, 3, v1
v_and_b32 v15, 7, v1
v_xor_b32 v15, v15, v14
v_lshlrev_b32 v15, 4, v15
s_mov_b32 s30, 0
s_mov_b32 s31, 0
s_mov_b32 s29, 0
s_mov_b32 s28, 0
s_mov_b32 s43, 245760
s_mov_b32 s38, 128
s_mov_b32 s39, 49152
s_add_i32 s33, s32, 40
v_add_u32 v2, s33, v14
v_max_i32 v2, 0, v2
v_mul_u32_u24 v2, 1280, v2
v_add_u32 v2, v2, v15
s_waitcnt lgkmcnt(0)
s_mov_b32 s8, s4
s_mov_b32 s9, s5
s_mov_b32 s52, s62
s_mov_b32 s53, s63
s_mov_b32 s12, s6
s_mov_b32 s13, s7
s_add_u32 m0, s29, 5120
s_nop 0
buffer_load_dwordx4 v2, s[8:11], s30 offen lds
s_add_i32 s33, s32, 104
v_add_u32 v3, s33, v14
v_max_i32 v3, 0, v3
v_mul_u32_u24 v3, 1280, v3
v_add_u32 v3, v3, v15
s_add_u32 m0, s29, 13312
s_nop 0
buffer_load_dwordx4 v3, s[8:11], s30 offen lds
v_add_u32 v16, 192, v1
v_mul_u32_u24 v17, 2185, v16
v_lshrrev_b32 v17, 16, v17
v_mul_u32_u24 v18, 30, v17
v_sub_u32 v18, v16, v18
v_and_b32 v19, 0x33, v17
v_and_b32 v20, 4, v17
v_lshl_or_b32 v19, v20, 1, v19
v_bfe_u32 v20, v17, 3, 1
v_lshl_or_b32 v19, v20, 2, v19
v_mul_u32_u24 v20, 6554, v18
v_lshrrev_b32 v20, 16, v20
v_mul_u32_u24 v20, 1120, v20
v_lshl_add_u32 v18, v18, 4, v20
v_mul_u32_u24 v4, 3840, v19
v_add3_u32 v4, v4, v18, s36
s_add_u32 m0, s29, 21504
s_nop 0
buffer_load_dwordx4 v4, s[12:15], s31 offen lds
v_add_u32 v16, 704, v1
v_mul_u32_u24 v17, 2185, v16
v_lshrrev_b32 v17, 16, v17
v_mul_u32_u24 v18, 30, v17
v_sub_u32 v18, v16, v18
v_and_b32 v19, 0x33, v17
v_and_b32 v20, 4, v17
v_lshl_or_b32 v19, v20, 1, v19
v_bfe_u32 v20, v17, 3, 1
v_lshl_or_b32 v19, v20, 2, v19
v_mul_u32_u24 v20, 6554, v18
v_lshrrev_b32 v20, 16, v20
v_mul_u32_u24 v20, 1120, v20
v_lshl_add_u32 v18, v18, 4, v20
v_mul_u32_u24 v5, 3840, v19
v_add3_u32 v5, v5, v18, s36
s_add_u32 m0, s29, 29696
s_nop 0
buffer_load_dwordx4 v5, s[12:15], s31 offen lds
v_add_u32 v16, 1216, v1
v_mul_u32_u24 v17, 2185, v16
v_lshrrev_b32 v17, 16, v17
v_mul_u32_u24 v18, 30, v17
v_sub_u32 v18, v16, v18
v_and_b32 v19, 0x33, v17
v_and_b32 v20, 4, v17
v_lshl_or_b32 v19, v20, 1, v19
v_bfe_u32 v20, v17, 3, 1
v_lshl_or_b32 v19, v20, 2, v19
v_mul_u32_u24 v20, 6554, v18
v_lshrrev_b32 v20, 16, v20
v_mul_u32_u24 v20, 1120, v20
v_lshl_add_u32 v18, v18, 4, v20
v_mul_u32_u24 v6, 3840, v19
v_add3_u32 v6, v6, v18, s36
s_add_u32 m0, s29, 37888
s_nop 0
buffer_load_dwordx4 v6, s[12:15], s31 offen lds
v_add_u32 v16, 1728, v1
v_mul_u32_u24 v17, 2185, v16
v_lshrrev_b32 v17, 16, v17
v_mul_u32_u24 v18, 30, v17
v_sub_u32 v18, v16, v18
v_and_b32 v19, 0x33, v17
v_and_b32 v20, 4, v17
v_lshl_or_b32 v19, v20, 1, v19
v_bfe_u32 v20, v17, 3, 1
v_lshl_or_b32 v19, v20, 2, v19
v_mul_u32_u24 v20, 6554, v18
v_lshrrev_b32 v20, 16, v20
v_mul_u32_u24 v20, 1120, v20
v_lshl_add_u32 v18, v18, 4, v20
v_mul_u32_u24 v7, 3840, v19
v_add3_u32 v7, v7, v18, s36
s_add_u32 m0, s29, 46080
s_nop 0
buffer_load_dwordx4 v7, s[12:15], s31 offen lds
s_add_u32 s30, s30, s38
s_add_u32 s31, s31, s43
s_add_u32 s29, s29, s39
s_cmp_eq_u32 s29, 147456
s_cselect_b32 s29, 0, s29
s_cmp_eq_u32 s30, 1280
s_cselect_b32 s30, 0, s30
s_cselect_b32 s31, 0, s31
s_cselect_b32 s38, 0, s38
s_cselect_b32 s43, 0, s43
s_cselect_b32 s39, 0, s39
s_cselect_b32 s29, 0x30000, s29
s_cselect_b32 s10, 0, s10
s_cselect_b32 s14, 0, s14
s_add_u32 m0, s29, 5120
s_nop 0
buffer_load_dwordx4 v2, s[8:11], s30 offen lds
s_add_u32 m0, s29, 13312
s_nop 0
buffer_load_dwordx4 v3, s[8:11], s30 offen lds
s_add_u32 m0, s29, 21504
s_nop 0
buffer_load_dwordx4 v4, s[12:15], s31 offen lds
s_add_u32 m0, s29, 29696
s_nop 0
buffer_load_dwordx4 v5, s[12:15], s31 offen lds
s_add_u32 m0, s29, 37888
s_nop 0
buffer_load_dwordx4 v6, s[12:15], s31 offen lds
s_add_u32 m0, s29, 46080
s_nop 0
buffer_load_dwordx4 v7, s[12:15], s31 offen lds
s_add_u32 s30, s30, s38
s_add_u32 s31, s31, s43
s_add_u32 s29, s29, s39
s_cmp_eq_u32 s29, 147456
s_cselect_b32 s29, 0, s29
s_cmp_eq_u32 s30, 1280
s_cselect_b32 s30, 0, s30
s_cselect_b32 s31, 0, s31
s_cselect_b32 s38, 0, s38
s_cselect_b32 s43, 0, s43
s_cselect_b32 s39, 0, s39
s_cselect_b32 s29, 0x30000, s29
s_cselect_b32 s10, 0, s10
s_cselect_b32 s14, 0, s14
v_and_b32 v14, 15, v1
v_lshrrev_b32 v15, 4, v1
v_and_b32 v16, 7, v14
v_xor_b32 v16, v16, v15
v_lshlrev_b32 v16, 4, v16
v_lshl_add_u32 v11, v14, 7, v16
v_xor_b32 v12, 64, v11
v_cmp_eq_u32 s[44:45], 0, v14
v_lshrrev_b32 v16, 1, v15
v_lshlrev_b32 v16, 4, v16
v_and_b32 v17, 1, v15
v_lshl_add_u32 v16, v17, 2, v16
v_bfe_u32 v17, v1, 2, 2
v_add_u32 v16, v16, v17
v_mul_u32_u24 v16, 480, v16
v_and_b32 v17, 3, v1
v_lshl_add_u32 v16, v17, 3, v16
v_add_u32 v13, 18432, v16
v_mov_b32 v132, 0
v_mov_b32 v133, 0
v_mov_b32 v134, 0
v_mov_b32 v135, 0
v_mov_b32 v136, 0
v_mov_b32 v137, 0
v_mov_b32 v138, 0
v_mov_b32 v139, 0
v_mov_b32 v140, 0
v_mov_b32 v141, 0
v_mov_b32 v142, 0
v_mov_b32 v143, 0
v_mov_b32 v144, 0
v_mov_b32 v145, 0
v_mov_b32 v146, 0
v_mov_b32 v147, 0
v_mov_b32 v148, 0
v_mov_b32 v149, 0
v_mov_b32 v150, 0
v_mov_b32 v151, 0
v_mov_b32 v152, 0
v_mov_b32 v153, 0
v_mov_b32 v154, 0
v_mov_b32 v155, 0
v_mov_b32 v156, 0
v_mov_b32 v157, 0
v_mov_b32 v158, 0
v_mov_b32 v159, 0
v_mov_b32 v160, 0
v_mov_b32 v161, 0
v_mov_b32 v162, 0
v_mov_b32 v163, 0
v_mov_b32 v164, 0
v_mov_b32 v165, 0
v_mov_b32 v166, 0
v_mov_b32 v167, 0
v_mov_b32 v168, 0
v_mov_b32 v169, 0
v_mov_b32 v170, 0
v_mov_b32 v171, 0
v_mov_b32 v172, 0
v_mov_b32 v173, 0
v_mov_b32 v174, 0
v_mov_b32 v175, 0
v_mov_b32 v176, 0
v_mov_b32 v177, 0
v_mov_b32 v178, 0
v_mov_b32 v179, 0
v_mov_b32 v180, 0
v_mov_b32 v181, 0
v_mov_b32 v182, 0
v_mov_b32 v183, 0
v_mov_b32 v184, 0
v_mov_b32 v185, 0
v_mov_b32 v186, 0
v_mov_b32 v187, 0
v_mov_b32 v188, 0
v_mov_b32 v189, 0
v_mov_b32 v190, 0
v_mov_b32 v191, 0
v_mov_b32 v192, 0
v_mov_b32 v193, 0
v_mov_b32 v194, 0
v_mov_b32 v195, 0
v_mov_b32 v196, 0
v_mov_b32 v197, 0
v_mov_b32 v198, 0
v_mov_b32 v199, 0
v_mov_b32 v200, 0
v_mov_b32 v201, 0
v_mov_b32 v202, 0
v_mov_b32 v203, 0
v_mov_b32 v204, 0
v_mov_b32 v205, 0
v_mov_b32 v206, 0
v_mov_b32 v207, 0
v_mov_b32 v32, 0x3f803f80
v_mov_b32 v33, 0x3f803f80
v_mov_b32 v34, 0x3f803f80
v_mov_b32 v35, 0x3f803f80
s_waitcnt vmcnt(6)
s_barrier
v_add_u32 v8, s28, v11
v_add_u32 v9, s28, v12
v_add_u32 v10, s28, v13
RX 40,8,10240
RX 44,8,12288
RX 48,8,14336
RX 52,8,16384
TR 56,10,128
TR 58,10,3968
RX 36,8,0
TR 60,10,160
TR 62,10,4000
TR 64,10,192
TR 66,10,4032
TR 68,10,224
TR 70,10,4064
s_add_u32 m0, s29, 5120
s_nop 0
buffer_load_dwordx4 v2, s[8:11], s30 offen lds
s_add_u32 m0, s29, 13312
s_nop 0
buffer_load_dwordx4 v3, s[8:11], s30 offen lds
s_add_u32 m0, s29, 21504
s_nop 0
buffer_load_dwordx4 v4, s[12:15], s31 offen lds
s_add_u32 m0, s29, 29696
s_nop 0
buffer_load_dwordx4 v5, s[12:15], s31 offen lds
s_add_u32 m0, s29, 37888
s_nop 0
buffer_load_dwordx4 v6, s[12:15], s31 offen lds
s_add_u32 m0, s29, 46080
s_nop 0
buffer_load_dwordx4 v7, s[12:15], s31 offen lds
s_add_u32 s30, s30, s38
s_add_u32 s31, s31, s43
s_add_u32 s29, s29, s39
s_cmp_eq_u32 s29, 147456
s_cselect_b32 s29, 0, s29
s_cmp_eq_u32 s30, 1280
s_cselect_b32 s30, 0, s30
s_cselect_b32 s31, 0, s31
s_cselect_b32 s38, 0, s38
s_cselect_b32 s43, 0, s43
s_cselect_b32 s39, 0, s39
s_cselect_b32 s29, 0x30000, s29
s_cselect_b32 s10, 0, s10
s_cselect_b32 s14, 0, s14
s_mov_b32 s27, 0
s_waitcnt lgkmcnt(0)
K1Latt5:
M 132,56,40
RX 88,9,10240
M 136,56,44
RX 92,9,12288
M 140,56,48
RX 96,9,14336
M 144,56,52
RX 100,9,16384
M 148,60,40
TR 104,10,15488
M 152,60,44
TR 106,10,19328
M 156,60,48
RX 84,9,0
M 160,60,52
TR 108,10,15520
M 164,64,40
TR 110,10,19360
M 168,64,44
TR 112,10,15552
M 172,64,48
TR 114,10,19392
M 176,64,52
TR 116,10,15584
M 180,68,40
TR 118,10,19424
v_cndmask_b32 v36, v36, v32, s[44:45]
v_cndmask_b32 v37, v37, v32, s[44:45]
v_cndmask_b32 v38, v38, v32, s[44:45]
v_cndmask_b32 v39, v39, v32, s[44:45]
M 184,68,44
M 188,68,48
s_add_u32 s28, s28, 49152
s_cmp_eq_u32 s28, 147456
s_cselect_b32 s28, 0, s28
M 192,68,52
v_add_u32 v8, s28, v11
v_add_u32 v9, s28, v12
v_add_u32 v10, s28, v13
M 196,60,36
s_cmp_eq_u32 s27, 9
M 200,32,44
M 204,44,44
s_cbranch_scc1 K1Eatt5
s_waitcnt vmcnt(6) lgkmcnt(0)
s_barrier
M 132,104,88
s_add_u32 m0, s29, 5120
RX 40,8,10240
buffer_load_dwordx4 v2, s[8:11], s30 offen lds
M 136,104,92
s_add_u32 m0, s29, 13312
RX 44,8,12288
buffer_load_dwordx4 v3, s[8:11], s30 offen lds
M 140,104,96
s_add_u32 m0, s29, 21504
RX 48,8,14336
buffer_load_dwordx4 v4, s[12:15], s31 offen lds
M 144,104,100
s_add_u32 m0, s29, 29696
RX 52,8,16384
buffer_load_dwordx4 v5, s[12:15], s31 offen lds
M 148,108,88
s_add_u32 m0, s29, 37888
TR 56,10,128
buffer_load_dwordx4 v6, s[12:15], s31 offen lds
M 152,108,92
s_add_u32 m0, s29, 46080
TR 58,10,3968
buffer_load_dwordx4 v7, s[12:15], s31 offen lds
M 156,108,96
RX 36,8,0
M 160,108,100
TR 60,10,160
M 164,112,88
TR 62,10,4000
M 168,112,92
TR 64,10,192
M 172,112,96
TR 66,10,4032
M 176,112,100
TR 68,10,224
M 180,116,88
TR 70,10,4064
v_cndmask_b32 v84, v84, v32, s[44:45]
v_cndmask_b32 v85, v85, v32, s[44:45]
v_cndmask_b32 v86, v86, v32, s[44:45]
v_cndmask_b32 v87, v87, v32, s[44:45]
M 184,116,92
s_add_u32 s30, s30, s38
s_add_u32 s31, s31, s43
s_add_u32 s29, s29, s39
M 188,116,96
s_cmp_eq_u32 s29, 147456
s_cselect_b32 s29, 0, s29
s_cmp_eq_u32 s30, 1280
M 192,116,100
s_cselect_b32 s30, 0, s30
s_cselect_b32 s31, 0, s31
s_cselect_b32 s38, 0, s38
M 196,108,84
s_cselect_b32 s43, 0, s43
s_cselect_b32 s39, 0, s39
s_cselect_b32 s29, 0x30000, s29
M 200,32,92
s_cselect_b32 s10, 0, s10
s_cselect_b32 s14, 0, s14
s_add_u32 s27, s27, 1
M 204,92,92
s_waitcnt lgkmcnt(0)
s_branch K1Latt5
K1Eatt5:
s_waitcnt lgkmcnt(0)
M 132,104,88
M 136,104,92
M 140,104,96
M 144,104,100
M 148,108,88
M 152,108,92
M 156,108,96
M 160,108,100
M 164,112,88
M 168,112,92
M 172,112,96
M 176,112,100
M 180,116,88
v_cndmask_b32 v84, v84, v32, s[44:45]
v_cndmask_b32 v85, v85, v32, s[44:45]
v_cndmask_b32 v86, v86, v32, s[44:45]
v_cndmask_b32 v87, v87, v32, s[44:45]
M 184,116,92
M 188,116,96
M 192,116,100
M 196,108,84
M 200,32,92
M 204,92,92
s_waitcnt vmcnt(0)
s_nop 7
s_nop 3
v_and_b32 v14, 15, v1
v_lshrrev_b32 v15, 4, v1
v_lshrrev_b32 v16, 2, v14
v_and_b32 v17, 3, v14
v_cmp_eq_u32 s[46:47], v16, v15
v_cmp_eq_u32 s[48:49], 1, v17
v_cmp_eq_u32 s[54:55], 2, v17
v_cmp_eq_u32 s[56:57], 3, v17
v_lshlrev_b32 v18, 2, v14
v_add_u32 v18, 98304, v18
s_mov_b32 s33, 0x3acccccd
s_mov_b32 s34, 0x3727c5ac
v_cndmask_b32 v204, v204, v205, s[48:49]
v_cndmask_b32 v204, v204, v206, s[54:55]
v_cndmask_b32 v204, v204, v207, s[56:57]
v_mul_f32 v200, s33, v200
v_mul_f32 v204, s33, v204
v_fma_f32 v204, -v200, v200, v204
v_max_f32 v204, 0, v204
v_add_f32 v204, s34, v204
v_rsq_f32 v204, v204
s_mov_b64 exec, s[46:47]
ds_write_b32 v18, v200 offset:384
ds_write_b32 v18, v204 offset:960
s_mov_b64 exec, -1
v_add_u32 v19, 98304, v1
s_mov_b64 exec, s[44:45]
ds_write_b128 v19, v[196:199] offset:1472
s_mov_b64 exec, -1
s_waitcnt lgkmcnt(0)
s_barrier
v_and_b32 v14, 15, v1
v_lshlrev_b32 v14, 2, v14
v_lshrrev_b32 v15, 4, v1
v_lshlrev_b32 v15, 4, v15
v_add_u32 v14, 98304, v14
v_add_u32 v15, 98304, v15
ds_read_b32 v36, v14 offset:0
ds_read_b32 v38, v14 offset:576
ds_read_b32 v42, v14 offset:320
ds_read_b32 v44, v14 offset:896
ds_read_b32 v48, v14 offset:384
ds_read_b32 v50, v14 offset:960
ds_read_b32 v54, v14 offset:448
ds_read_b32 v56, v14 offset:1024
ds_read_b32 v60, v14 offset:512
ds_read_b32 v62, v14 offset:1088
ds_read_b128 v[68:71], v15 offset:1408
ds_read_b128 v[72:75], v15 offset:1472
ds_read_b128 v[76:79], v15 offset:1536
ds_read_b128 v[80:83], v15 offset:1600
s_waitcnt lgkmcnt(0)
v_lshlrev_b32 v16, 3, v1
v_and_b32 v17, 15, v1
v_lshrrev_b32 v18, 4, v1
v_lshlrev_b32 v18, 3, v18
v_lshl_add_u32 v17, v17, 5, v18
v_add_u32 v18, 32768, v16
v_add_u32 v19, 32768, v17
PFN 132,42,68
PFN 134,42,70
PMB 132,44,132
PMB 134,44,134
CV 132,132,133
CV 133,134,135
PFN 136,48,68
PFN 138,48,70
PMB 136,50,136
PMB 138,50,138
CV 136,136,137
CV 137,138,139
PFN 140,54,68
PFN 142,54,70
PMB 140,56,140
PMB 142,56,142
CV 140,140,141
CV 141,142,143
PFN 144,60,68
PFN 146,60,70
PMB 144,62,144
PMB 146,62,146
CV 144,144,145
CV 145,146,147
PFN 148,42,72
PFN 150,42,74
PMB 148,44,148
PMB 150,44,150
CV 148,148,149
CV 149,150,151
PFN 152,48,72
PFN 154,48,74
PMB 152,50,152
PMB 154,50,154
CV 152,152,153
CV 153,154,155
PFN 156,54,72
PFN 158,54,74
PMB 156,56,156
PMB 158,56,158
CV 156,156,157
CV 157,158,159
PFN 160,60,72
PFN 162,60,74
PMB 160,62,160
PMB 162,62,162
CV 160,160,161
CV 161,162,163
PFN 164,42,76
PFN 166,42,78
PMB 164,44,164
PMB 166,44,166
CV 164,164,165
CV 165,166,167
PFN 168,48,76
PFN 170,48,78
PMB 168,50,168
PMB 170,50,170
CV 168,168,169
CV 169,170,171
PFN 172,54,76
PFN 174,54,78
PMB 172,56,172
PMB 174,56,174
CV 172,172,173
CV 173,174,175
PFN 176,60,76
PFN 178,60,78
PMB 176,62,176
PMB 178,62,178
CV 176,176,177
CV 177,178,179
PFN 180,42,80
PFN 182,42,82
PMB 180,44,180
PMB 182,44,182
CV 180,180,181
CV 181,182,183
PFN 184,48,80
PFN 186,48,82
PMB 184,50,184
PMB 186,50,186
CV 184,184,185
CV 185,186,187
PFN 188,54,80
PFN 190,54,82
PMB 188,56,188
PMB 190,56,190
CV 188,188,189
CV 189,190,191
PFN 192,60,80
PFN 194,60,82
PMB 192,62,192
PMB 194,62,194
CV 192,192,193
CV 193,194,195
PFN 196,36,72
PFN 198,36,74
PMB 196,38,196
PMB 198,38,198
CV 196,196,197
CV 197,198,199
ds_write_b64 v18, v[132:133] offset:7680
ds_write_b64 v18, v[136:137] offset:15360
ds_write_b64 v18, v[140:141] offset:23040
ds_write_b64 v18, v[144:145] offset:30720
ds_write_b64 v18, v[148:149] offset:8192
ds_write_b64 v18, v[152:153] offset:15872
ds_write_b64 v18, v[156:157] offset:23552
ds_write_b64 v18, v[160:161] offset:31232
ds_write_b64 v18, v[164:165] offset:8704
ds_write_b64 v18, v[168:169] offset:16384
ds_write_b64 v18, v[172:173] offset:24064
ds_write_b64 v18, v[176:177] offset:31744
ds_write_b64 v18, v[180:181] offset:9216
ds_write_b64 v18, v[184:185] offset:16896
ds_write_b64 v18, v[188:189] offset:24576
ds_write_b64 v18, v[192:193] offset:32256
ds_write_b64 v16, v[196:197] offset:2560
s_waitcnt lgkmcnt(0)
s_branch K1_ATTN
K1_ATT6:
v_lshrrev_b32 v14, 3, v1
v_and_b32 v15, 7, v1
v_xor_b32 v15, v15, v14
v_lshlrev_b32 v15, 4, v15
s_mov_b32 s30, 0
s_mov_b32 s31, 0
s_mov_b32 s29, 0
s_mov_b32 s28, 0
s_mov_b32 s43, 245760
s_mov_b32 s38, 128
s_mov_b32 s39, 49152
s_add_i32 s33, s32, 48
v_add_u32 v2, s33, v14
v_max_i32 v2, 0, v2
v_mul_u32_u24 v2, 1280, v2
v_add_u32 v2, v2, v15
s_waitcnt lgkmcnt(0)
s_mov_b32 s8, s4
s_mov_b32 s9, s5
s_mov_b32 s52, s62
s_mov_b32 s53, s63
s_mov_b32 s12, s6
s_mov_b32 s13, s7
s_add_u32 m0, s29, 6144
s_nop 0
buffer_load_dwordx4 v2, s[8:11], s30 offen lds
s_add_i32 s33, s32, 112
v_add_u32 v3, s33, v14
v_max_i32 v3, 0, v3
v_mul_u32_u24 v3, 1280, v3
v_add_u32 v3, v3, v15
s_add_u32 m0, s29, 14336
s_nop 0
buffer_load_dwordx4 v3, s[8:11], s30 offen lds
v_add_u32 v16, 256, v1
v_mul_u32_u24 v17, 2185, v16
v_lshrrev_b32 v17, 16, v17
v_mul_u32_u24 v18, 30, v17
v_sub_u32 v18, v16, v18
v_and_b32 v19, 0x33, v17
v_and_b32 v20, 4, v17
v_lshl_or_b32 v19, v20, 1, v19
v_bfe_u32 v20, v17, 3, 1
v_lshl_or_b32 v19, v20, 2, v19
v_mul_u32_u24 v20, 6554, v18
v_lshrrev_b32 v20, 16, v20
v_mul_u32_u24 v20, 1120, v20
v_lshl_add_u32 v18, v18, 4, v20
v_mul_u32_u24 v4, 3840, v19
v_add3_u32 v4, v4, v18, s36
s_add_u32 m0, s29, 22528
s_nop 0
buffer_load_dwordx4 v4, s[12:15], s31 offen lds
v_add_u32 v16, 768, v1
v_mul_u32_u24 v17, 2185, v16
v_lshrrev_b32 v17, 16, v17
v_mul_u32_u24 v18, 30, v17
v_sub_u32 v18, v16, v18
v_and_b32 v19, 0x33, v17
v_and_b32 v20, 4, v17
v_lshl_or_b32 v19, v20, 1, v19
v_bfe_u32 v20, v17, 3, 1
v_lshl_or_b32 v19, v20, 2, v19
v_mul_u32_u24 v20, 6554, v18
v_lshrrev_b32 v20, 16, v20
v_mul_u32_u24 v20, 1120, v20
v_lshl_add_u32 v18, v18, 4, v20
v_mul_u32_u24 v5, 3840, v19
v_add3_u32 v5, v5, v18, s36
s_add_u32 m0, s29, 30720
s_nop 0
buffer_load_dwordx4 v5, s[12:15], s31 offen lds
v_add_u32 v16, 1280, v1
v_mul_u32_u24 v17, 2185, v16
v_lshrrev_b32 v17, 16, v17
v_mul_u32_u24 v18, 30, v17
v_sub_u32 v18, v16, v18
v_and_b32 v19, 0x33, v17
v_and_b32 v20, 4, v17
v_lshl_or_b32 v19, v20, 1, v19
v_bfe_u32 v20, v17, 3, 1
v_lshl_or_b32 v19, v20, 2, v19
v_mul_u32_u24 v20, 6554, v18
v_lshrrev_b32 v20, 16, v20
v_mul_u32_u24 v20, 1120, v20
v_lshl_add_u32 v18, v18, 4, v20
v_mul_u32_u24 v6, 3840, v19
v_add3_u32 v6, v6, v18, s36
s_add_u32 m0, s29, 38912
s_nop 0
buffer_load_dwordx4 v6, s[12:15], s31 offen lds
v_add_u32 v16, 1792, v1
v_mul_u32_u24 v17, 2185, v16
v_lshrrev_b32 v17, 16, v17
v_mul_u32_u24 v18, 30, v17
v_sub_u32 v18, v16, v18
v_and_b32 v19, 0x33, v17
v_and_b32 v20, 4, v17
v_lshl_or_b32 v19, v20, 1, v19
v_bfe_u32 v20, v17, 3, 1
v_lshl_or_b32 v19, v20, 2, v19
v_mul_u32_u24 v20, 6554, v18
v_lshrrev_b32 v20, 16, v20
v_mul_u32_u24 v20, 1120, v20
v_lshl_add_u32 v18, v18, 4, v20
v_mul_u32_u24 v7, 3840, v19
v_add3_u32 v7, v7, v18, s36
s_add_u32 m0, s29, 47104
s_nop 0
buffer_load_dwordx4 v7, s[12:15], s31 offen lds
s_add_u32 s30, s30, s38
s_add_u32 s31, s31, s43
s_add_u32 s29, s29, s39
s_cmp_eq_u32 s29, 147456
s_cselect_b32 s29, 0, s29
s_cmp_eq_u32 s30, 1280
s_cselect_b32 s30, 0, s30
s_cselect_b32 s31, 0, s31
s_cselect_b32 s38, 0, s38
s_cselect_b32 s43, 0, s43
s_cselect_b32 s39, 0, s39
s_cselect_b32 s29, 0x30000, s29
s_cselect_b32 s10, 0, s10
s_cselect_b32 s14, 0, s14
s_add_u32 m0, s29, 6144
s_nop 0
buffer_load_dwordx4 v2, s[8:11], s30 offen lds
s_add_u32 m0, s29, 14336
s_nop 0
buffer_load_dwordx4 v3, s[8:11], s30 offen lds
s_add_u32 m0, s29, 22528
s_nop 0
buffer_load_dwordx4 v4, s[12:15], s31 offen lds
s_add_u32 m0, s29, 30720
s_nop 0
buffer_load_dwordx4 v5, s[12:15], s31 offen lds
s_add_u32 m0, s29, 38912
s_nop 0
buffer_load_dwordx4 v6, s[12:15], s31 offen lds
s_add_u32 m0, s29, 47104
s_nop 0
buffer_load_dwordx4 v7, s[12:15], s31 offen lds
s_add_u32 s30, s30, s38
s_add_u32 s31, s31, s43
s_add_u32 s29, s29, s39
s_cmp_eq_u32 s29, 147456
s_cselect_b32 s29, 0, s29
s_cmp_eq_u32 s30, 1280
s_cselect_b32 s30, 0, s30
s_cselect_b32 s31, 0, s31
s_cselect_b32 s38, 0, s38
s_cselect_b32 s43, 0, s43
s_cselect_b32 s39, 0, s39
s_cselect_b32 s29, 0x30000, s29
s_cselect_b32 s10, 0, s10
s_cselect_b32 s14, 0, s14
s_lshr_b32 s33, s37, 3
s_and_b32 s34, s37, 3
s_bfe_u32 s35, s37, 0x10002
s_mov_b32 s67, 0x00020000
s_mov_b32 s74, 2
s_cmp_ge_u32 s33, 16
s_cbranch_scc1 TC13
s_mov_b32 s64, s4
s_mov_b32 s65, s5
s_mov_b32 s66, 2621440
s_mov_b32 s69, 128
s_lshl_b32 s35, s35, 10
s_lshl_b32 s33, s33, 6
s_add_u32 s33, s33, s35
v_add_u32 v220, s33, v1
v_mul_u32_u24 v220, 1280, v220
s_branch TC15
TC13:
s_cmp_ge_u32 s33, 25
s_cbranch_scc1 TC14
s_mov_b32 s64, s6
s_mov_b32 s65, s7
s_mov_b32 s66, 2457600
s_mov_b32 s69, 245760
s_sub_u32 s33, s33, 16
s_lshl_b32 s33, s33, 6
v_add_u32 v16, s33, v1
v_mul_u32_u24 v17, 7282, v16
v_lshrrev_b32 v17, 16, v17
v_mul_u32_u24 v18, 9, v17
v_sub_u32 v18, v16, v18
v_mul_u32_u24 v19, 21846, v18
v_lshrrev_b32 v19, 16, v19
v_mul_u32_u24 v20, 3, v19
v_sub_u32 v20, v18, v20
v_mul_u32_u24 v220, 3840, v17
v_mul_u32_u24 v19, 1280, v19
v_lshlrev_b32 v20, 7, v20
v_add3_u32 v220, v220, v19, v20
s_mul_i32 s34, s34, 320
s_and_b32 s34, s34, 0xffffff80
v_add_u32 v220, s34, v220
s_branch TC15
TC14:
s_mov_b32 s64, s60
s_mov_b32 s65, s61
s_mov_b32 s66, 2211840
s_mov_b32 s69, 221184
s_sub_u32 s33, s33, 25
s_lshl_b32 s33, s33, 6
v_add_u32 v16, s33, v1
v_mul_u32_u24 v17, 9363, v16
v_lshrrev_b32 v17, 16, v17
v_mul_u32_u24 v18, 7, v17
v_sub_u32 v18, v16, v18
v_mul_u32_u24 v220, 3456, v17
v_lshl_add_u32 v220, v18, 7, v220
s_mul_i32 s34, s34, 896
v_add_u32 v220, s34, v220
TC15:
s_lshl_b32 s68, s69, 1
buffer_load_dword v221, v220, s[64:67], s68 offen
s_add_u32 s68, s68, s69
s_add_u32 s74, s74, 1
s_cmp_ge_u32 s74, 10
s_cselect_b32 s66, 0, s66
s_cselect_b32 s68, 0, s68
s_cselect_b32 s69, 0, s69
buffer_load_dword v221, v220, s[64:67], s68 offen
s_add_u32 s68, s68, s69
s_add_u32 s74, s74, 1
s_cmp_ge_u32 s74, 10
s_cselect_b32 s66, 0, s66
s_cselect_b32 s68, 0, s68
s_cselect_b32 s69, 0, s69
v_and_b32 v14, 15, v1
v_lshrrev_b32 v15, 4, v1
v_and_b32 v16, 7, v14
v_xor_b32 v16, v16, v15
v_lshlrev_b32 v16, 4, v16
v_lshl_add_u32 v11, v14, 7, v16
v_xor_b32 v12, 64, v11
v_cmp_eq_u32 s[44:45], 0, v14
v_lshrrev_b32 v16, 1, v15
v_lshlrev_b32 v16, 4, v16
v_and_b32 v17, 1, v15
v_lshl_add_u32 v16, v17, 2, v16
v_bfe_u32 v17, v1, 2, 2
v_add_u32 v16, v16, v17
v_mul_u32_u24 v16, 480, v16
v_and_b32 v17, 3, v1
v_lshl_add_u32 v16, v17, 3, v16
v_add_u32 v13, 18432, v16
v_mov_b32 v132, 0
v_mov_b32 v133, 0
v_mov_b32 v134, 0
v_mov_b32 v135, 0
v_mov_b32 v136, 0
v_mov_b32 v137, 0
v_mov_b32 v138, 0
v_mov_b32 v139, 0
v_mov_b32 v140, 0
v_mov_b32 v141, 0
v_mov_b32 v142, 0
v_mov_b32 v143, 0
v_mov_b32 v144, 0
v_mov_b32 v145, 0
v_mov_b32 v146, 0
v_mov_b32 v147, 0
v_mov_b32 v148, 0
v_mov_b32 v149, 0
v_mov_b32 v150, 0
v_mov_b32 v151, 0
v_mov_b32 v152, 0
v_mov_b32 v153, 0
v_mov_b32 v154, 0
v_mov_b32 v155, 0
v_mov_b32 v156, 0
v_mov_b32 v157, 0
v_mov_b32 v158, 0
v_mov_b32 v159, 0
v_mov_b32 v160, 0
v_mov_b32 v161, 0
v_mov_b32 v162, 0
v_mov_b32 v163, 0
v_mov_b32 v164, 0
v_mov_b32 v165, 0
v_mov_b32 v166, 0
v_mov_b32 v167, 0
v_mov_b32 v168, 0
v_mov_b32 v169, 0
v_mov_b32 v170, 0
v_mov_b32 v171, 0
v_mov_b32 v172, 0
v_mov_b32 v173, 0
v_mov_b32 v174, 0
v_mov_b32 v175, 0
v_mov_b32 v176, 0
v_mov_b32 v177, 0
v_mov_b32 v178, 0
v_mov_b32 v179, 0
v_mov_b32 v180, 0
v_mov_b32 v181, 0
v_mov_b32 v182, 0
v_mov_b32 v183, 0
v_mov_b32 v184, 0
v_mov_b32 v185, 0
v_mov_b32 v186, 0
v_mov_b32 v187, 0
v_mov_b32 v188, 0
v_mov_b32 v189, 0
v_mov_b32 v190, 0
v_mov_b32 v191, 0
v_mov_b32 v192, 0
v_mov_b32 v193, 0
v_mov_b32 v194, 0
v_mov_b32 v195, 0
v_mov_b32 v196, 0
v_mov_b32 v197, 0
v_mov_b32 v198, 0
v_mov_b32 v199, 0
v_mov_b32 v200, 0
v_mov_b32 v201, 0
v_mov_b32 v202, 0
v_mov_b32 v203, 0
v_mov_b32 v204, 0
v_mov_b32 v205, 0
v_mov_b32 v206, 0
v_mov_b32 v207, 0
v_mov_b32 v32, 0x3f803f80
v_mov_b32 v33, 0x3f803f80
v_mov_b32 v34, 0x3f803f80
v_mov_b32 v35, 0x3f803f80
s_waitcnt vmcnt(8)
s_barrier
v_add_u32 v8, s28, v11
v_add_u32 v9, s28, v12
v_add_u32 v10, s28, v13
RX 40,8,10240
RX 44,8,12288
RX 48,8,14336
RX 52,8,16384
TR 56,10,256
TR 58,10,4096
RX 36,8,0
TR 60,10,288
TR 62,10,4128
TR 64,10,320
TR 66,10,4160
TR 68,10,352
TR 70,10,4192
s_add_u32 m0, s29, 6144
s_nop 0
buffer_load_dwordx4 v2, s[8:11], s30 offen lds
s_add_u32 m0, s29, 14336
s_nop 0
buffer_load_dwordx4 v3, s[8:11], s30 offen lds
s_add_u32 m0, s29, 22528
s_nop 0
buffer_load_dwordx4 v4, s[12:15], s31 offen lds
s_add_u32 m0, s29, 30720
s_nop 0
buffer_load_dwordx4 v5, s[12:15], s31 offen lds
s_add_u32 m0, s29, 38912
s_nop 0
buffer_load_dwordx4 v6, s[12:15], s31 offen lds
s_add_u32 m0, s29, 47104
s_nop 0
buffer_load_dwordx4 v7, s[12:15], s31 offen lds
s_add_u32 s30, s30, s38
s_add_u32 s31, s31, s43
s_add_u32 s29, s29, s39
s_cmp_eq_u32 s29, 147456
s_cselect_b32 s29, 0, s29
s_cmp_eq_u32 s30, 1280
s_cselect_b32 s30, 0, s30
s_cselect_b32 s31, 0, s31
s_cselect_b32 s38, 0, s38
s_cselect_b32 s43, 0, s43
s_cselect_b32 s39, 0, s39
s_cselect_b32 s29, 0x30000, s29
s_cselect_b32 s10, 0, s10
s_cselect_b32 s14, 0, s14
buffer_load_dword v221, v220, s[64:67], s68 offen
s_add_u32 s68, s68, s69
s_add_u32 s74, s74, 1
s_cmp_ge_u32 s74, 10
s_cselect_b32 s66, 0, s66
s_cselect_b32 s68, 0, s68
s_cselect_b32 s69, 0, s69
buffer_load_dword v221, v220, s[64:67], s68 offen
s_add_u32 s68, s68, s69
s_add_u32 s74, s74, 1
s_cmp_ge_u32 s74, 10
s_cselect_b32 s66, 0, s66
s_cselect_b32 s68, 0, s68
s_cselect_b32 s69, 0, s69
s_mov_b32 s27, 0
s_waitcnt lgkmcnt(0)
K1Latt6:
M 132,56,40
RX 88,9,10240
M 136,56,44
RX 92,9,12288
M 140,56,48
RX 96,9,14336
M 144,56,52
RX 100,9,16384
M 148,60,40
TR 104,10,15616
M 152,60,44
TR 106,10,19456
M 156,60,48
RX 84,9,0
M 160,60,52
TR 108,10,15648
M 164,64,40
TR 110,10,19488
M 168,64,44
TR 112,10,15680
M 172,64,48
TR 114,10,19520
M 176,64,52
TR 116,10,15712
M 180,68,40
TR 118,10,19552
v_cndmask_b32 v36, v36, v32, s[44:45]
v_cndmask_b32 v37, v37, v32, s[44:45]
v_cndmask_b32 v38, v38, v32, s[44:45]
v_cndmask_b32 v39, v39, v32, s[44:45]
M 184,68,44
M 188,68,48
s_add_u32 s28, s28, 49152
s_cmp_eq_u32 s28, 147456
s_cselect_b32 s28, 0, s28
M 192,68,52
v_add_u32 v8, s28, v11
v_add_u32 v9, s28, v12
v_add_u32 v10, s28, v13
M 196,60,36
s_cmp_eq_u32 s27, 9
M 200,32,48
M 204,48,48
s_cbranch_scc1 K1Eatt6
s_waitcnt vmcnt(10) lgkmcnt(0)
s_barrier
M 132,104,88
s_add_u32 m0, s29, 6144
RX 40,8,10240
buffer_load_dwordx4 v2, s[8:11], s30 offen lds
M 136,104,92
s_add_u32 m0, s29, 14336
RX 44,8,12288
buffer_load_dwordx4 v3, s[8:11], s30 offen lds
M 140,104,96
s_add_u32 m0, s29, 22528
RX 48,8,14336
buffer_load_dwordx4 v4, s[12:15], s31 offen lds
M 144,104,100
s_add_u32 m0, s29, 30720
RX 52,8,16384
buffer_load_dwordx4 v5, s[12:15], s31 offen lds
M 148,108,88
s_add_u32 m0, s29, 38912
TR 56,10,256
buffer_load_dwordx4 v6, s[12:15], s31 offen lds
M 152,108,92
s_add_u32 m0, s29, 47104
TR 58,10,4096
buffer_load_dwordx4 v7, s[12:15], s31 offen lds
M 156,108,96
RX 36,8,0
M 160,108,100
TR 60,10,288
M 164,112,88
TR 62,10,4128
M 168,112,92
TR 64,10,320
M 172,112,96
TR 66,10,4160
M 176,112,100
TR 68,10,352
M 180,116,88
TR 70,10,4192
v_cndmask_b32 v84, v84, v32, s[44:45]
v_cndmask_b32 v85, v85, v32, s[44:45]
v_cndmask_b32 v86, v86, v32, s[44:45]
v_cndmask_b32 v87, v87, v32, s[44:45]
M 184,116,92
buffer_load_dword v221, v220, s[64:67], s68 offen
s_add_u32 s68, s68, s69
s_add_u32 s74, s74, 1
M 188,116,96
s_cmp_ge_u32 s74, 10
s_cselect_b32 s66, 0, s66
s_cselect_b32 s68, 0, s68
M 192,116,100
s_cselect_b32 s69, 0, s69
buffer_load_dword v221, v220, s[64:67], s68 offen
s_add_u32 s68, s68, s69
M 196,108,84
s_add_u32 s74, s74, 1
s_cmp_ge_u32 s74, 10
s_cselect_b32 s66, 0, s66
M 200,32,96
s_cselect_b32 s68, 0, s68
s_cselect_b32 s69, 0, s69
s_add_u32 s30, s30, s38
M 204,96,96
s_add_u32 s31, s31, s43
s_add_u32 s29, s29, s39
s_cmp_eq_u32 s29, 147456
s_cselect_b32 s29, 0, s29
s_cmp_eq_u32 s30, 1280
s_cselect_b32 s30, 0, s30
s_cselect_b32 s31, 0, s31
s_cselect_b32 s38, 0, s38
s_cselect_b32 s43, 0, s43
s_cselect_b32 s39, 0, s39
s_cselect_b32 s29, 0x30000, s29
s_cselect_b32 s10, 0, s10
s_cselect_b32 s14, 0, s14
s_add_u32 s27, s27, 1
s_waitcnt lgkmcnt(0)
s_branch K1Latt6
K1Eatt6:
s_waitcnt lgkmcnt(0)
M 132,104,88
M 136,104,92
M 140,104,96
M 144,104,100
M 148,108,88
M 152,108,92
M 156,108,96
M 160,108,100
M 164,112,88
M 168,112,92
M 172,112,96
M 176,112,100
M 180,116,88
v_cndmask_b32 v84, v84, v32, s[44:45]
v_cndmask_b32 v85, v85, v32, s[44:45]
v_cndmask_b32 v86, v86, v32, s[44:45]
v_cndmask_b32 v87, v87, v32, s[44:45]
M 184,116,92
M 188,116,96
M 192,116,100
M 196,108,84
M 200,32,96
M 204,96,96
s_waitcnt vmcnt(0)
s_nop 7
s_nop 3
v_and_b32 v14, 15, v1
v_lshrrev_b32 v15, 4, v1
v_lshrrev_b32 v16, 2, v14
v_and_b32 v17, 3, v14
v_cmp_eq_u32 s[46:47], v16, v15
v_cmp_eq_u32 s[48:49], 1, v17
v_cmp_eq_u32 s[54:55], 2, v17
v_cmp_eq_u32 s[56:57], 3, v17
v_lshlrev_b32 v18, 2, v14
v_add_u32 v18, 98304, v18
s_mov_b32 s33, 0x3acccccd
s_mov_b32 s34, 0x3727c5ac
v_cndmask_b32 v204, v204, v205, s[48:49]
v_cndmask_b32 v204, v204, v206, s[54:55]
v_cndmask_b32 v204, v204, v207, s[56:57]
v_mul_f32 v200, s33, v200
v_mul_f32 v204, s33, v204
v_fma_f32 v204, -v200, v200, v204
v_max_f32 v204, 0, v204
v_add_f32 v204, s34, v204
v_rsq_f32 v204, v204
s_mov_b64 exec, s[46:47]
ds_write_b32 v18, v200 offset:448
ds_write_b32 v18, v204 offset:1024
s_mov_b64 exec, -1
v_add_u32 v19, 98304, v1
s_mov_b64 exec, s[44:45]
ds_write_b128 v19, v[196:199] offset:1728
s_mov_b64 exec, -1
s_waitcnt lgkmcnt(0)
s_barrier
v_and_b32 v14, 15, v1
v_lshlrev_b32 v14, 2, v14
v_lshrrev_b32 v15, 4, v1
v_lshlrev_b32 v15, 4, v15
v_add_u32 v14, 98304, v14
v_add_u32 v15, 98304, v15
ds_read_b32 v36, v14 offset:0
ds_read_b32 v38, v14 offset:576
ds_read_b32 v42, v14 offset:320
ds_read_b32 v44, v14 offset:896
ds_read_b32 v48, v14 offset:384
ds_read_b32 v50, v14 offset:960
ds_read_b32 v54, v14 offset:448
ds_read_b32 v56, v14 offset:1024
ds_read_b32 v60, v14 offset:512
ds_read_b32 v62, v14 offset:1088
ds_read_b128 v[68:71], v15 offset:1664
ds_read_b128 v[72:75], v15 offset:1728
ds_read_b128 v[76:79], v15 offset:1792
ds_read_b128 v[80:83], v15 offset:1856
s_waitcnt lgkmcnt(0)
v_lshlrev_b32 v16, 3, v1
v_and_b32 v17, 15, v1
v_lshrrev_b32 v18, 4, v1
v_lshlrev_b32 v18, 3, v18
v_lshl_add_u32 v17, v17, 5, v18
v_add_u32 v18, 32768, v16
v_add_u32 v19, 32768, v17
PFN 132,42,68
PFN 134,42,70
PMB 132,44,132
PMB 134,44,134
CV 132,132,133
CV 133,134,135
PFN 136,48,68
PFN 138,48,70
PMB 136,50,136
PMB 138,50,138
CV 136,136,137
CV 137,138,139
PFN 140,54,68
PFN 142,54,70
PMB 140,56,140
PMB 142,56,142
CV 140,140,141
CV 141,142,143
PFN 144,60,68
PFN 146,60,70
PMB 144,62,144
PMB 146,62,146
CV 144,144,145
CV 145,146,147
PFN 148,42,72
PFN 150,42,74
PMB 148,44,148
PMB 150,44,150
CV 148,148,149
CV 149,150,151
PFN 152,48,72
PFN 154,48,74
PMB 152,50,152
PMB 154,50,154
CV 152,152,153
CV 153,154,155
PFN 156,54,72
PFN 158,54,74
PMB 156,56,156
PMB 158,56,158
CV 156,156,157
CV 157,158,159
PFN 160,60,72
PFN 162,60,74
PMB 160,62,160
PMB 162,62,162
CV 160,160,161
CV 161,162,163
PFN 164,42,76
PFN 166,42,78
PMB 164,44,164
PMB 166,44,166
CV 164,164,165
CV 165,166,167
PFN 168,48,76
PFN 170,48,78
PMB 168,50,168
PMB 170,50,170
CV 168,168,169
CV 169,170,171
PFN 172,54,76
PFN 174,54,78
PMB 172,56,172
PMB 174,56,174
CV 172,172,173
CV 173,174,175
PFN 176,60,76
PFN 178,60,78
PMB 176,62,176
PMB 178,62,178
CV 176,176,177
CV 177,178,179
PFN 180,42,80
PFN 182,42,82
PMB 180,44,180
PMB 182,44,182
CV 180,180,181
CV 181,182,183
PFN 184,48,80
PFN 186,48,82
PMB 184,50,184
PMB 186,50,186
CV 184,184,185
CV 185,186,187
PFN 188,54,80
PFN 190,54,82
PMB 188,56,188
PMB 190,56,190
CV 188,188,189
CV 189,190,191
PFN 192,60,80
PFN 194,60,82
PMB 192,62,192
PMB 194,62,194
CV 192,192,193
CV 193,194,195
PFN 196,36,72
PFN 198,36,74
PMB 196,38,196
PMB 198,38,198
CV 196,196,197
CV 197,198,199
ds_write_b64 v18, v[132:133] offset:9728
ds_write_b64 v18, v[136:137] offset:17408
ds_write_b64 v18, v[140:141] offset:25088
ds_write_b64 v18, v[144:145] offset:32768
ds_write_b64 v18, v[148:149] offset:10240
ds_write_b64 v18, v[152:153] offset:17920
ds_write_b64 v18, v[156:157] offset:25600
ds_write_b64 v18, v[160:161] offset:33280
ds_write_b64 v19, v[164:165] offset:10752
ds_write_b64 v19, v[168:169] offset:18432
ds_write_b64 v19, v[172:173] offset:26112
ds_write_b64 v19, v[176:177] offset:33792
ds_write_b64 v19, v[180:181] offset:11264
ds_write_b64 v19, v[184:185] offset:18944
ds_write_b64 v19, v[188:189] offset:26624
ds_write_b64 v19, v[192:193] offset:34304
ds_write_b64 v16, v[196:197] offset:4608
s_waitcnt lgkmcnt(0)
s_branch K1_ATTN
K1_ATT7:
v_lshrrev_b32 v14, 3, v1
v_and_b32 v15, 7, v1
v_xor_b32 v15, v15, v14
v_lshlrev_b32 v15, 4, v15
s_mov_b32 s30, 0
s_mov_b32 s31, 0
s_mov_b32 s29, 0
s_mov_b32 s28, 0
s_mov_b32 s43, 245760
s_mov_b32 s38, 128
s_mov_b32 s39, 49152
s_add_i32 s33, s32, 56
v_add_u32 v2, s33, v14
v_max_i32 v2, 0, v2
v_mul_u32_u24 v2, 1280, v2
v_add_u32 v2, v2, v15
s_waitcnt lgkmcnt(0)
s_mov_b32 s8, s4
s_mov_b32 s9, s5
s_mov_b32 s52, s62
s_mov_b32 s53, s63
s_mov_b32 s12, s6
s_mov_b32 s13, s7
s_add_u32 m0, s29, 7168
s_nop 0
buffer_load_dwordx4 v2, s[8:11], s30 offen lds
s_add_i32 s33, s32, 120
v_add_u32 v3, s33, v14
v_max_i32 v3, 0, v3
v_mul_u32_u24 v3, 1280, v3
v_add_u32 v3, v3, v15
s_add_u32 m0, s29, 15360
s_nop 0
buffer_load_dwordx4 v3, s[8:11], s30 offen lds
v_add_u32 v16, 320, v1
v_mul_u32_u24 v17, 2185, v16
v_lshrrev_b32 v17, 16, v17
v_mul_u32_u24 v18, 30, v17
v_sub_u32 v18, v16, v18
v_and_b32 v19, 0x33, v17
v_and_b32 v20, 4, v17
v_lshl_or_b32 v19, v20, 1, v19
v_bfe_u32 v20, v17, 3, 1
v_lshl_or_b32 v19, v20, 2, v19
v_mul_u32_u24 v20, 6554, v18
v_lshrrev_b32 v20, 16, v20
v_mul_u32_u24 v20, 1120, v20
v_lshl_add_u32 v18, v18, 4, v20
v_mul_u32_u24 v4, 3840, v19
v_add3_u32 v4, v4, v18, s36
s_add_u32 m0, s29, 23552
s_nop 0
buffer_load_dwordx4 v4, s[12:15], s31 offen lds
v_add_u32 v16, 832, v1
v_mul_u32_u24 v17, 2185, v16
v_lshrrev_b32 v17, 16, v17
v_mul_u32_u24 v18, 30, v17
v_sub_u32 v18, v16, v18
v_and_b32 v19, 0x33, v17
v_and_b32 v20, 4, v17
v_lshl_or_b32 v19, v20, 1, v19
v_bfe_u32 v20, v17, 3, 1
v_lshl_or_b32 v19, v20, 2, v19
v_mul_u32_u24 v20, 6554, v18
v_lshrrev_b32 v20, 16, v20
v_mul_u32_u24 v20, 1120, v20
v_lshl_add_u32 v18, v18, 4, v20
v_mul_u32_u24 v5, 3840, v19
v_add3_u32 v5, v5, v18, s36
s_add_u32 m0, s29, 31744
s_nop 0
buffer_load_dwordx4 v5, s[12:15], s31 offen lds
v_add_u32 v16, 1344, v1
v_mul_u32_u24 v17, 2185, v16
v_lshrrev_b32 v17, 16, v17
v_mul_u32_u24 v18, 30, v17
v_sub_u32 v18, v16, v18
v_and_b32 v19, 0x33, v17
v_and_b32 v20, 4, v17
v_lshl_or_b32 v19, v20, 1, v19
v_bfe_u32 v20, v17, 3, 1
v_lshl_or_b32 v19, v20, 2, v19
v_mul_u32_u24 v20, 6554, v18
v_lshrrev_b32 v20, 16, v20
v_mul_u32_u24 v20, 1120, v20
v_lshl_add_u32 v18, v18, 4, v20
v_mul_u32_u24 v6, 3840, v19
v_add3_u32 v6, v6, v18, s36
s_add_u32 m0, s29, 39936
s_nop 0
buffer_load_dwordx4 v6, s[12:15], s31 offen lds
v_add_u32 v16, 1856, v1
v_mul_u32_u24 v17, 2185, v16
v_lshrrev_b32 v17, 16, v17
v_mul_u32_u24 v18, 30, v17
v_sub_u32 v18, v16, v18
v_and_b32 v19, 0x33, v17
v_and_b32 v20, 4, v17
v_lshl_or_b32 v19, v20, 1, v19
v_bfe_u32 v20, v17, 3, 1
v_lshl_or_b32 v19, v20, 2, v19
v_mul_u32_u24 v20, 6554, v18
v_lshrrev_b32 v20, 16, v20
v_mul_u32_u24 v20, 1120, v20
v_lshl_add_u32 v18, v18, 4, v20
v_mul_u32_u24 v7, 3840, v19
v_add3_u32 v7, v7, v18, s36
s_add_u32 m0, s29, 48128
s_nop 0
buffer_load_dwordx4 v7, s[12:15], s31 offen lds
s_add_u32 s30, s30, s38
s_add_u32 s31, s31, s43
s_add_u32 s29, s29, s39
s_cmp_eq_u32 s29, 147456
s_cselect_b32 s29, 0, s29
s_cmp_eq_u32 s30, 1280
s_cselect_b32 s30, 0, s30
s_cselect_b32 s31, 0, s31
s_cselect_b32 s38, 0, s38
s_cselect_b32 s43, 0, s43
s_cselect_b32 s39, 0, s39
s_cselect_b32 s29, 0x30000, s29
s_cselect_b32 s10, 0, s10
s_cselect_b32 s14, 0, s14
s_add_u32 m0, s29, 7168
s_nop 0
buffer_load_dwordx4 v2, s[8:11], s30 offen lds
s_add_u32 m0, s29, 15360
s_nop 0
buffer_load_dwordx4 v3, s[8:11], s30 offen lds
s_add_u32 m0, s29, 23552
s_nop 0
buffer_load_dwordx4 v4, s[12:15], s31 offen lds
s_add_u32 m0, s29, 31744
s_nop 0
buffer_load_dwordx4 v5, s[12:15], s31 offen lds
s_add_u32 m0, s29, 39936
s_nop 0
buffer_load_dwordx4 v6, s[12:15], s31 offen lds
s_add_u32 m0, s29, 48128
s_nop 0
buffer_load_dwordx4 v7, s[12:15], s31 offen lds
s_add_u32 s30, s30, s38
s_add_u32 s31, s31, s43
s_add_u32 s29, s29, s39
s_cmp_eq_u32 s29, 147456
s_cselect_b32 s29, 0, s29
s_cmp_eq_u32 s30, 1280
s_cselect_b32 s30, 0, s30
s_cselect_b32 s31, 0, s31
s_cselect_b32 s38, 0, s38
s_cselect_b32 s43, 0, s43
s_cselect_b32 s39, 0, s39
s_cselect_b32 s29, 0x30000, s29
s_cselect_b32 s10, 0, s10
s_cselect_b32 s14, 0, s14
v_and_b32 v14, 15, v1
v_lshrrev_b32 v15, 4, v1
v_and_b32 v16, 7, v14
v_xor_b32 v16, v16, v15
v_lshlrev_b32 v16, 4, v16
v_lshl_add_u32 v11, v14, 7, v16
v_xor_b32 v12, 64, v11
v_cmp_eq_u32 s[44:45], 0, v14
v_lshrrev_b32 v16, 1, v15
v_lshlrev_b32 v16, 4, v16
v_and_b32 v17, 1, v15
v_lshl_add_u32 v16, v17, 2, v16
v_bfe_u32 v17, v1, 2, 2
v_add_u32 v16, v16, v17
v_mul_u32_u24 v16, 480, v16
v_and_b32 v17, 3, v1
v_lshl_add_u32 v16, v17, 3, v16
v_add_u32 v13, 18432, v16
v_mov_b32 v132, 0
v_mov_b32 v133, 0
v_mov_b32 v134, 0
v_mov_b32 v135, 0
v_mov_b32 v136, 0
v_mov_b32 v137, 0
v_mov_b32 v138, 0
v_mov_b32 v139, 0
v_mov_b32 v140, 0
v_mov_b32 v141, 0
v_mov_b32 v142, 0
v_mov_b32 v143, 0
v_mov_b32 v144, 0
v_mov_b32 v145, 0
v_mov_b32 v146, 0
v_mov_b32 v147, 0
v_mov_b32 v148, 0
v_mov_b32 v149, 0
v_mov_b32 v150, 0
v_mov_b32 v151, 0
v_mov_b32 v152, 0
v_mov_b32 v153, 0
v_mov_b32 v154, 0
v_mov_b32 v155, 0
v_mov_b32 v156, 0
v_mov_b32 v157, 0
v_mov_b32 v158, 0
v_mov_b32 v159, 0
v_mov_b32 v160, 0
v_mov_b32 v161, 0
v_mov_b32 v162, 0
v_mov_b32 v163, 0
v_mov_b32 v164, 0
v_mov_b32 v165, 0
v_mov_b32 v166, 0
v_mov_b32 v167, 0
v_mov_b32 v168, 0
v_mov_b32 v169, 0
v_mov_b32 v170, 0
v_mov_b32 v171, 0
v_mov_b32 v172, 0
v_mov_b32 v173, 0
v_mov_b32 v174, 0
v_mov_b32 v175, 0
v_mov_b32 v176, 0
v_mov_b32 v177, 0
v_mov_b32 v178, 0
v_mov_b32 v179, 0
v_mov_b32 v180, 0
v_mov_b32 v181, 0
v_mov_b32 v182, 0
v_mov_b32 v183, 0
v_mov_b32 v184, 0
v_mov_b32 v185, 0
v_mov_b32 v186, 0
v_mov_b32 v187, 0
v_mov_b32 v188, 0
v_mov_b32 v189, 0
v_mov_b32 v190, 0
v_mov_b32 v191, 0
v_mov_b32 v192, 0
v_mov_b32 v193, 0
v_mov_b32 v194, 0
v_mov_b32 v195, 0
v_mov_b32 v196, 0
v_mov_b32 v197, 0
v_mov_b32 v198, 0
v_mov_b32 v199, 0
v_mov_b32 v200, 0
v_mov_b32 v201, 0
v_mov_b32 v202, 0
v_mov_b32 v203, 0
v_mov_b32 v204, 0
v_mov_b32 v205, 0
v_mov_b32 v206, 0
v_mov_b32 v207, 0
v_mov_b32 v208, 0
v_mov_b32 v209, 0
v_mov_b32 v210, 0
v_mov_b32 v211, 0
v_mov_b32 v32, 0x3f803f80
v_mov_b32 v33, 0x3f803f80
v_mov_b32 v34, 0x3f803f80
v_mov_b32 v35, 0x3f803f80
s_waitcnt vmcnt(6)
s_barrier
v_add_u32 v8, s28, v11
v_add_u32 v9, s28, v12
v_add_u32 v10, s28, v13
RX 40,8,10240
RX 44,8,12288
RX 48,8,14336
RX 52,8,16384
TR 56,10,384
TR 58,10,4224
RX 36,8,0
TR 60,10,416
TR 62,10,4256
TR 64,10,448
TR 66,10,4288
TR 68,10,192
TR 70,10,4032
TR 72,10,224
TR 74,10,4064
TR 76,10,320
TR 78,10,4160
TR 80,10,352
TR 82,10,4192
s_add_u32 m0, s29, 7168
s_nop 0
buffer_load_dwordx4 v2, s[8:11], s30 offen lds
s_add_u32 m0, s29, 15360
s_nop 0
buffer_load_dwordx4 v3, s[8:11], s30 offen lds
s_add_u32 m0, s29, 23552
s_nop 0
buffer_load_dwordx4 v4, s[12:15], s31 offen lds
s_add_u32 m0, s29, 31744
s_nop 0
buffer_load_dwordx4 v5, s[12:15], s31 offen lds
s_add_u32 m0, s29, 39936
s_nop 0
buffer_load_dwordx4 v6, s[12:15], s31 offen lds
s_add_u32 m0, s29, 48128
s_nop 0
buffer_load_dwordx4 v7, s[12:15], s31 offen lds
s_add_u32 s30, s30, s38
s_add_u32 s31, s31, s43
s_add_u32 s29, s29, s39
s_cmp_eq_u32 s29, 147456
s_cselect_b32 s29, 0, s29
s_cmp_eq_u32 s30, 1280
s_cselect_b32 s30, 0, s30
s_cselect_b32 s31, 0, s31
s_cselect_b32 s38, 0, s38
s_cselect_b32 s43, 0, s43
s_cselect_b32 s39, 0, s39
s_cselect_b32 s29, 0x30000, s29
s_cselect_b32 s10, 0, s10
s_cselect_b32 s14, 0, s14
s_mov_b32 s27, 0
s_waitcnt lgkmcnt(0)
K1Latt7:
M 132,56,40
RX 88,9,10240
RX 92,9,12288
M 136,56,44
RX 96,9,14336
RX 100,9,16384
M 140,56,48
TR 104,10,15744
M 144,56,52
TR 106,10,19584
M 148,60,40
RX 84,9,0
M 152,60,44
TR 108,10,15776
M 156,60,48
TR 110,10,19616
M 160,60,52
TR 112,10,15808
M 164,64,40
TR 114,10,19648
v_cndmask_b32 v36, v36, v32, s[44:45]
v_cndmask_b32 v37, v37, v32, s[44:45]
v_cndmask_b32 v38, v38, v32, s[44:45]
v_cndmask_b32 v39, v39, v32, s[44:45]
M 168,64,44
TR 116,10,15552
M 172,64,48
TR 118,10,19392
M 176,64,52
TR 120,10,15584
M 180,68,36
TR 122,10,19424
M 184,72,36
TR 124,10,15680
M 188,76,36
TR 126,10,19520
M 192,80,36
TR 128,10,15712
M 196,32,52
TR 130,10,19552
M 200,52,52
s_add_u32 s28, s28, 49152
s_cmp_eq_u32 s28, 147456
s_cselect_b32 s28, 0, s28
M 204,32,36
v_add_u32 v8, s28, v11
v_add_u32 v9, s28, v12
v_add_u32 v10, s28, v13
M 208,36,36
s_cmp_eq_u32 s27, 9
s_cbranch_scc1 K1Eatt7
s_waitcnt vmcnt(6) lgkmcnt(0)
s_barrier
M 132,104,88
s_add_u32 m0, s29, 7168
RX 40,8,10240
buffer_load_dwordx4 v2, s[8:11], s30 offen lds
M 136,104,92
s_add_u32 m0, s29, 15360
RX 44,8,12288
buffer_load_dwordx4 v3, s[8:11], s30 offen lds
M 140,104,96
s_add_u32 m0, s29, 23552
RX 48,8,14336
buffer_load_dwordx4 v4, s[12:15], s31 offen lds
M 144,104,100
s_add_u32 m0, s29, 31744
RX 52,8,16384
buffer_load_dwordx4 v5, s[12:15], s31 offen lds
M 148,108,88
s_add_u32 m0, s29, 39936
TR 56,10,384
buffer_load_dwordx4 v6, s[12:15], s31 offen lds
M 152,108,92
s_add_u32 m0, s29, 48128
TR 58,10,4224
buffer_load_dwordx4 v7, s[12:15], s31 offen lds
M 156,108,96
RX 36,8,0
TR 60,10,416
M 160,108,100
TR 62,10,4256
TR 64,10,448
M 164,112,88
TR 66,10,4288
v_cndmask_b32 v84, v84, v32, s[44:45]
v_cndmask_b32 v85, v85, v32, s[44:45]
v_cndmask_b32 v86, v86, v32, s[44:45]
v_cndmask_b32 v87, v87, v32, s[44:45]
M 168,112,92
TR 68,10,192
M 172,112,96
TR 70,10,4032
M 176,112,100
TR 72,10,224
M 180,116,84
TR 74,10,4064
M 184,120,84
TR 76,10,320
M 188,124,84
TR 78,10,4160
M 192,128,84
TR 80,10,352
M 196,32,100
TR 82,10,4192
M 200,100,100
s_add_u32 s30, s30, s38
s_add_u32 s31, s31, s43
s_add_u32 s29, s29, s39
M 204,32,84
s_cmp_eq_u32 s29, 147456
s_cselect_b32 s29, 0, s29
s_cmp_eq_u32 s30, 1280
M 208,84,84
s_cselect_b32 s30, 0, s30
s_cselect_b32 s31, 0, s31
s_cselect_b32 s38, 0, s38
s_cselect_b32 s43, 0, s43
s_cselect_b32 s39, 0, s39
s_cselect_b32 s29, 0x30000, s29
s_cselect_b32 s10, 0, s10
s_cselect_b32 s14, 0, s14
s_add_u32 s27, s27, 1
s_waitcnt lgkmcnt(0)
s_branch K1Latt7
K1Eatt7:
s_waitcnt lgkmcnt(0)
M 132,104,88
M 136,104,92
M 140,104,96
M 144,104,100
M 148,108,88
M 152,108,92
M 156,108,96
M 160,108,100
M 164,112,88
v_cndmask_b32 v84, v84, v32, s[44:45]
v_cndmask_b32 v85, v85, v32, s[44:45]
v_cndmask_b32 v86, v86, v32, s[44:45]
v_cndmask_b32 v87, v87, v32, s[44:45]
M 168,112,92
M 172,112,96
M 176,112,100
M 180,116,84
M 184,120,84
M 188,124,84
M 192,128,84
M 196,32,100
M 200,100,100
M 204,32,84
M 208,84,84
s_waitcnt vmcnt(0)
s_nop 7
s_nop 3
v_and_b32 v14, 15, v1
v_lshrrev_b32 v15, 4, v1
v_lshrrev_b32 v16, 2, v14
v_and_b32 v17, 3, v14
v_cmp_eq_u32 s[46:47], v16, v15
v_cmp_eq_u32 s[48:49], 1, v17
v_cmp_eq_u32 s[54:55], 2, v17
v_cmp_eq_u32 s[56:57], 3, v17
v_lshlrev_b32 v18, 2, v14
v_add_u32 v18, 98304, v18
s_mov_b32 s33, 0x3acccccd
s_mov_b32 s34, 0x3727c5ac
v_cndmask_b32 v200, v200, v201, s[48:49]
v_cndmask_b32 v200, v200, v202, s[54:55]
v_cndmask_b32 v200, v200, v203, s[56:57]
v_mul_f32 v196, s33, v196
v_mul_f32 v200, s33, v200
v_fma_f32 v200, -v196, v196, v200
v_max_f32 v200, 0, v200
v_add_f32 v200, s34, v200
v_rsq_f32 v200, v200
s_mov_b64 exec, s[46:47]
ds_write_b32 v18, v196 offset:512
ds_write_b32 v18, v200 offset:1088
s_mov_b64 exec, -1
v_cndmask_b32 v208, v208, v209, s[48:49]
v_cndmask_b32 v208, v208, v210, s[54:55]
v_cndmask_b32 v208, v208, v211, s[56:57]
v_mul_f32 v204, s33, v204
v_mul_f32 v208, s33, v208
v_fma_f32 v208, -v204, v204, v208
v_max_f32 v208, 0, v208
v_add_f32 v208, s34, v208
v_rsq_f32 v208, v208
s_mov_b64 exec, s[46:47]
ds_write_b32 v18, v204 offset:0
ds_write_b32 v18, v208 offset:576
s_mov_b64 exec, -1
v_add_u32 v19, 98304, v1
s_mov_b64 exec, s[44:45]
ds_write_b128 v19, v[180:183] offset:1536
ds_write_b128 v19, v[184:187] offset:1600
ds_write_b128 v19, v[188:191] offset:1792
ds_write_b128 v19, v[192:195] offset:1856
s_mov_b64 exec, -1
s_waitcnt lgkmcnt(0)
s_barrier
v_and_b32 v14, 15, v1
v_lshlrev_b32 v14, 2, v14
v_lshrrev_b32 v15, 4, v1
v_lshlrev_b32 v15, 4, v15
v_add_u32 v14, 98304, v14
v_add_u32 v15, 98304, v15
ds_read_b32 v36, v14 offset:0
ds_read_b32 v38, v14 offset:576
ds_read_b32 v42, v14 offset:320
ds_read_b32 v44, v14 offset:896
ds_read_b32 v48, v14 offset:384
ds_read_b32 v50, v14 offset:960
ds_read_b32 v54, v14 offset:448
ds_read_b32 v56, v14 offset:1024
ds_read_b32 v60, v14 offset:512
ds_read_b32 v62, v14 offset:1088
ds_read_b128 v[68:71], v15 offset:1536
ds_read_b128 v[72:75], v15 offset:1600
ds_read_b128 v[76:79], v15 offset:1792
ds_read_b128 v[80:83], v15 offset:1856
ds_read_b128 v[84:87], v15 offset:1920
ds_read_b128 v[88:91], v15 offset:1984
ds_read_b128 v[92:95], v15 offset:2048
s_waitcnt lgkmcnt(0)
v_lshlrev_b32 v16, 3, v1
v_and_b32 v17, 15, v1
v_lshrrev_b32 v18, 4, v1
v_lshlrev_b32 v18, 3, v18
v_lshl_add_u32 v17, v17, 5, v18
v_add_u32 v18, 32768, v16
v_add_u32 v19, 32768, v17
PFN 132,42,84
PFN 134,42,86
PMB 132,44,132
PMB 134,44,134
CV 132,132,133
CV 133,134,135
PFN 136,48,84
PFN 138,48,86
PMB 136,50,136
PMB 138,50,138
CV 136,136,137
CV 137,138,139
PFN 140,54,84
PFN 142,54,86
PMB 140,56,140
PMB 142,56,142
CV 140,140,141
CV 141,142,143
PFN 144,60,84
PFN 146,60,86
PMB 144,62,144
PMB 146,62,146
CV 144,144,145
CV 145,146,147
PFN 148,42,88
PFN 150,42,90
PMB 148,44,148
PMB 150,44,150
CV 148,148,149
CV 149,150,151
PFN 152,48,88
PFN 154,48,90
PMB 152,50,152
PMB 154,50,154
CV 152,152,153
CV 153,154,155
PFN 156,54,88
PFN 158,54,90
PMB 156,56,156
PMB 158,56,158
CV 156,156,157
CV 157,158,159
PFN 160,60,88
PFN 162,60,90
PMB 160,62,160
PMB 162,62,162
CV 160,160,161
CV 161,162,163
PFN 164,42,92
PFN 166,42,94
PMB 164,44,164
PMB 166,44,166
CV 164,164,165
CV 165,166,167
PFN 168,48,92
PFN 170,48,94
PMB 168,50,168
PMB 170,50,170
CV 168,168,169
CV 169,170,171
PFN 172,54,92
PFN 174,54,94
PMB 172,56,172
PMB 174,56,174
CV 172,172,173
CV 173,174,175
PFN 176,60,92
PFN 178,60,94
PMB 176,62,176
PMB 178,62,178
CV 176,176,177
CV 177,178,179
PFN 180,36,68
PFN 182,36,70
PMB 180,38,180
PMB 182,38,182
CV 180,180,181
CV 181,182,183
PFN 184,36,72
PFN 186,36,74
PMB 184,38,184
PMB 186,38,186
CV 184,184,185
CV 185,186,187
PFN 188,36,76
PFN 190,36,78
PMB 188,38,188
PMB 190,38,190
CV 188,188,189
CV 189,190,191
PFN 192,36,80
PFN 194,36,82
PMB 192,38,192
PMB 194,38,194
CV 192,192,193
CV 193,194,195
ds_write_b64 v19, v[132:133] offset:11776
ds_write_b64 v19, v[136:137] offset:19456
ds_write_b64 v19, v[140:141] offset:27136
ds_write_b64 v19, v[144:145] offset:34816
ds_write_b64 v19, v[148:149] offset:12288
ds_write_b64 v19, v[152:153] offset:19968
ds_write_b64 v19, v[156:157] offset:27648
ds_write_b64 v19, v[160:161] offset:35328
ds_write_b64 v19, v[164:165] offset:12800
ds_write_b64 v19, v[168:169] offset:20480
ds_write_b64 v19, v[172:173] offset:28160
ds_write_b64 v19, v[176:177] offset:35840
ds_write_b64 v16, v[180:181] offset:3072
ds_write_b64 v16, v[184:185] offset:3584
ds_write_b64 v17, v[188:189] offset:5120
ds_write_b64 v17, v[192:193] offset:5632
s_waitcnt lgkmcnt(0)
s_branch K1_ATTN
K1_ATTN:
s_mul_i32 s33, s26, 7680
v_lshlrev_b32 v14, 3, v1
v_add_u32 v14, s33, v14
v_and_b32 v86, 15, v1
v_lshrrev_b32 v87, 4, v1
v_and_b32 v88, 1, v86
v_lshlrev_b32 v89, 4, v88
v_lshl_add_u32 v16, v87, 2, v88
v_sub_u32 v16, v86, v16
v_mov_b32 v18, 0xf149f2ca
s_barrier
ds_read_b64 v[36:37], v14 offset:7680
ds_read_b64 v[46:47], v14 offset:2560
ds_read_b64 v[56:57], v14 offset:10240
ds_read_b64 v[38:39], v14 offset:8192
ds_read_b64 v[48:49], v14 offset:3072
ds_read_b64 v[58:59], v14 offset:10752
ds_read_b64 v[40:41], v14 offset:8704
ds_read_b64 v[50:51], v14 offset:3584
ds_read_b64 v[60:61], v14 offset:11264
ds_read_b64 v[42:43], v14 offset:9216
ds_read_b64 v[52:53], v14 offset:4096
ds_read_b64 v[62:63], v14 offset:11776
ds_read_b64 v[44:45], v14 offset:9728
ds_read_b64 v[54:55], v14 offset:4608
ds_read_b64 v[64:65], v14 offset:12288
TR 66,14,5120
TR 68,14,12800
TR 70,14,5632
TR 72,14,13312
TR 74,14,6144
TR 76,14,13824
TR 78,14,6656
TR 80,14,14336
TR 82,14,7168
TR 84,14,14848
v_add_u32 v17, 16, v16
v_cmp_gt_u32 vcc, 15, v17
s_nop 1
v_cndmask_b32 v90, v18, 0, vcc
v_add_u32 v17, 14, v16
v_cmp_gt_u32 vcc, 15, v17
s_nop 1
v_cndmask_b32 v91, v18, 0, vcc
v_add_u32 v17, 0, v16
v_cmp_gt_u32 vcc, 15, v17
s_nop 1
v_cndmask_b32 v92, v18, 0, vcc
v_add_u32 v17, -2, v16
v_cmp_gt_u32 vcc, 15, v17
s_nop 1
v_cndmask_b32 v93, v18, 0, vcc
s_add_u32 s33, s24, s26
s_cmp_lg_u32 s33, 0
s_cbranch_scc1 M016
v_mov_b32 v90, v18
v_mov_b32 v91, v18
M016:
v_cmp_eq_u32 s[46:47], 1, v88
v_cmp_eq_u32 s[48:49], 0, v87
v_cmp_le_u32 s[50:51], 1, v87
v_cmp_ge_u32 s[52:53], 1, v87
v_cmp_le_u32 s[54:55], 2, v87
v_cmp_ge_u32 s[56:57], 2, v87
v_cmp_eq_u32 s[58:59], 3, v87
s_mov_b32 s33, 0x3ea52b5c
s_waitcnt lgkmcnt(10)
v_mov_b32 v96, v36
v_mov_b32 v97, v37
v_cndmask_b32 v98, 0, v38, s[48:49]
v_cndmask_b32 v99, 0, v39, s[48:49]
v_cndmask_b32 v100, 0, v38, s[50:51]
v_cndmask_b32 v101, 0, v39, s[50:51]
v_cndmask_b32 v102, 0, v40, s[52:53]
v_cndmask_b32 v103, 0, v41, s[52:53]
v_cndmask_b32 v104, 0, v40, s[54:55]
v_cndmask_b32 v105, 0, v41, s[54:55]
v_cndmask_b32 v106, 0, v42, s[56:57]
v_cndmask_b32 v107, 0, v43, s[56:57]
v_cndmask_b32 v108, 0, v42, s[58:59]
v_cndmask_b32 v109, 0, v43, s[58:59]
v_mov_b32 v110, v44
v_mov_b32 v111, v45
s_nop 0
MZ 112,46,96
MZ 116,56,96
MZ 120,48,100
MZ 124,58,100
MZ 128,50,104
MZ 132,60,104
MZ 136,52,108
MZ 140,62,108
s_nop 7
s_nop 0
v_mov_b32 v184, s33
v_mov_b32 v186, 0x0c0c0100
v_mov_b32 v187, 0x0c0c0302
v_mov_b32 v188, 0x01000c0c
v_mov_b32 v189, 0x03020c0c
v_cndmask_b32 v186, v186, v188, s[46:47]
v_cndmask_b32 v187, v187, v189, s[46:47]
v_cndmask_b32 v144, v112, v113, s[46:47]
v_cndmask_b32 v145, v114, v115, s[46:47]
v_cndmask_b32 v146, v116, v117, s[46:47]
v_cndmask_b32 v147, v118, v119, s[46:47]
v_cndmask_b32 v148, v120, v121, s[46:47]
v_cndmask_b32 v149, v122, v123, s[46:47]
v_cndmask_b32 v150, v124, v125, s[46:47]
v_cndmask_b32 v151, v126, v127, s[46:47]
v_cndmask_b32 v152, v128, v129, s[46:47]
v_cndmask_b32 v153, v130, v131, s[46:47]
v_cndmask_b32 v154, v132, v133, s[46:47]
v_cndmask_b32 v155, v134, v135, s[46:47]
v_cndmask_b32 v156, v136, v137, s[46:47]
v_cndmask_b32 v157, v138, v139, s[46:47]
v_cndmask_b32 v158, v140, v141, s[46:47]
v_cndmask_b32 v159, v142, v143, s[46:47]
v_pk_fma_f32 v[144:145], v[144:145], v[184:185], v[90:91] op_sel_hi:[1,0,1]
v_pk_fma_f32 v[146:147], v[146:147], v[184:185], v[92:93] op_sel_hi:[1,0,1]
v_pk_fma_f32 v[148:149], v[148:149], v[184:185], v[90:91] op_sel_hi:[1,0,1]
v_pk_fma_f32 v[150:151], v[150:151], v[184:185], v[92:93] op_sel_hi:[1,0,1]
v_pk_fma_f32 v[152:153], v[152:153], v[184:185], v[90:91] op_sel_hi:[1,0,1]
v_pk_fma_f32 v[154:155], v[154:155], v[184:185], v[92:93] op_sel_hi:[1,0,1]
v_pk_fma_f32 v[156:157], v[156:157], v[184:185], v[90:91] op_sel_hi:[1,0,1]
v_pk_fma_f32 v[158:159], v[158:159], v[184:185], v[92:93] op_sel_hi:[1,0,1]
v_max_f32 v160, v144, v145
v_max3_f32 v160, v160, v146, v147
v_max_f32 v162, v148, v149
v_max3_f32 v162, v162, v150, v151
v_max_f32 v164, v152, v153
v_max3_f32 v164, v164, v154, v155
v_max_f32 v166, v156, v157
v_max3_f32 v166, v166, v158, v159
v_mov_b32 v161, v160
v_mov_b32 v163, v162
v_mov_b32 v165, v164
v_mov_b32 v167, v166
s_nop 0
v_permlane16_swap_b32 v160, v161
v_permlane16_swap_b32 v162, v163
v_permlane16_swap_b32 v164, v165
v_permlane16_swap_b32 v166, v167
s_nop 0
v_max_f32 v160, v160, v161
v_max_f32 v162, v162, v163
v_max_f32 v164, v164, v165
v_max_f32 v166, v166, v167
v_mov_b32 v161, v160
v_mov_b32 v163, v162
v_mov_b32 v165, v164
v_mov_b32 v167, v166
s_nop 0
v_permlane32_swap_b32 v160, v161
v_permlane32_swap_b32 v162, v163
v_permlane32_swap_b32 v164, v165
v_permlane32_swap_b32 v166, v167
s_nop 0
v_max_f32 v160, v160, v161
v_max_f32 v162, v162, v163
v_max_f32 v164, v164, v165
v_max_f32 v166, v166, v167
v_pk_add_f32 v[144:145], v[144:145], v[160:161] op_sel_hi:[1,0] neg_lo:[0,1] neg_hi:[0,1]
v_pk_add_f32 v[146:147], v[146:147], v[160:161] op_sel_hi:[1,0] neg_lo:[0,1] neg_hi:[0,1]
v_pk_add_f32 v[148:149], v[148:149], v[162:163] op_sel_hi:[1,0] neg_lo:[0,1] neg_hi:[0,1]
v_pk_add_f32 v[150:151], v[150:151], v[162:163] op_sel_hi:[1,0] neg_lo:[0,1] neg_hi:[0,1]
v_pk_add_f32 v[152:153], v[152:153], v[164:165] op_sel_hi:[1,0] neg_lo:[0,1] neg_hi:[0,1]
v_pk_add_f32 v[154:155], v[154:155], v[164:165] op_sel_hi:[1,0] neg_lo:[0,1] neg_hi:[0,1]
v_pk_add_f32 v[156:157], v[156:157], v[166:167] op_sel_hi:[1,0] neg_lo:[0,1] neg_hi:[0,1]
v_pk_add_f32 v[158:159], v[158:159], v[166:167] op_sel_hi:[1,0] neg_lo:[0,1] neg_hi:[0,1]
v_exp_f32 v144, v144
v_exp_f32 v145, v145
v_exp_f32 v146, v146
v_exp_f32 v147, v147
v_exp_f32 v148, v148
v_exp_f32 v149, v149
v_exp_f32 v150, v150
v_exp_f32 v151, v151
v_exp_f32 v152, v152
v_exp_f32 v153, v153
v_exp_f32 v154, v154
v_exp_f32 v155, v155
v_exp_f32 v156, v156
v_exp_f32 v157, v157
v_exp_f32 v158, v158
v_exp_f32 v159, v159
s_nop 0
v_cvt_pk_bf16_f32 v144, v144, v145
v_cvt_pk_bf16_f32 v146, v146, v147
v_cvt_pk_bf16_f32 v148, v148, v149
v_cvt_pk_bf16_f32 v150, v150, v151
v_cvt_pk_bf16_f32 v152, v152, v153
v_cvt_pk_bf16_f32 v154, v154, v155
v_cvt_pk_bf16_f32 v156, v156, v157
v_cvt_pk_bf16_f32 v158, v158, v159
v_perm_b32 v168, v144, v144, v186
v_perm_b32 v169, v144, v144, v187
v_perm_b32 v170, v146, v146, v186
v_perm_b32 v171, v146, v146, v187
v_perm_b32 v172, v148, v148, v186
v_perm_b32 v173, v148, v148, v187
v_perm_b32 v174, v150, v150, v186
v_perm_b32 v175, v150, v150, v187
v_perm_b32 v176, v152, v152, v186
v_perm_b32 v177, v152, v152, v187
v_perm_b32 v178, v154, v154, v186
v_perm_b32 v179, v154, v154, v187
v_perm_b32 v180, v156, v156, v186
v_perm_b32 v181, v156, v156, v187
v_perm_b32 v182, v158, v158, v186
v_perm_b32 v183, v158, v158, v187
s_waitcnt lgkmcnt(0)
s_nop 0
MZ 128,32,168
MZ 132,32,172
MZ 136,32,176
MZ 140,32,180
MZ 96,66,168
MZ 100,70,168
MZ 104,70,172
MZ 108,74,172
MZ 112,74,176
MZ 116,78,176
MZ 120,78,180
MZ 124,82,180
s_nop 7
v_rcp_f32 v128, v128
v_rcp_f32 v132, v132
v_rcp_f32 v136, v136
v_rcp_f32 v140, v140
v_mov_b32 v144, v128
v_cndmask_b32 v146, v132, v128, s[48:49]
v_cndmask_b32 v148, v136, v132, s[52:53]
v_cndmask_b32 v150, v140, v136, s[56:57]
v_mov_b32 v152, v140
v_cndmask_b32 v100, v104, v100, s[48:49]
v_cndmask_b32 v101, v105, v101, s[48:49]
v_cndmask_b32 v102, v106, v102, s[48:49]
v_cndmask_b32 v103, v107, v103, s[48:49]
v_cndmask_b32 v108, v112, v108, s[52:53]
v_cndmask_b32 v109, v113, v109, s[52:53]
v_cndmask_b32 v110, v114, v110, s[52:53]
v_cndmask_b32 v111, v115, v111, s[52:53]
v_cndmask_b32 v116, v120, v116, s[56:57]
v_cndmask_b32 v117, v121, v117, s[56:57]
v_cndmask_b32 v118, v122, v118, s[56:57]
v_cndmask_b32 v119, v123, v119, s[56:57]
PMB 96,144,96
PMB 98,144,98
CV 96,96,97
CV 97,98,99
PMB 100,146,100
PMB 102,146,102
CV 100,100,101
CV 101,102,103
PMB 108,148,108
PMB 110,148,110
CV 108,108,109
CV 109,110,111
PMB 116,150,116
PMB 118,150,118
CV 116,116,117
CV 117,118,119
PMB 124,152,124
PMB 126,152,126
CV 124,124,125
CV 125,126,127
v_lshlrev_b32 v14, 4, v1
s_lshl_b32 s33, s24, 1
s_lshr_b32 s34, s26, 2
s_add_u32 s33, s33, s34
s_mul_i32 s33, s33, 81920
s_and_b32 s34, s26, 3
s_lshl_b32 s34, s34, 10
s_add_u32 s33, s33, s34
s_add_u32 s33, s33, 7340032
s_mul_i32 s34, s25, 5
s_add_u32 s35, s34, 0
s_lshr_b32 s36, s35, 1
s_and_b32 s35, s35, 1
s_lshl_b32 s36, s36, 12
s_lshl_b32 s35, s35, 3
s_add_u32 s36, s36, s35
s_add_u32 s36, s36, s33
buffer_store_dwordx2 v[96:97], v14, s[16:19], s36 offen
s_add_u32 s35, s34, 1
s_lshr_b32 s36, s35, 1
s_and_b32 s35, s35, 1
s_lshl_b32 s36, s36, 12
s_lshl_b32 s35, s35, 3
s_add_u32 s36, s36, s35
s_add_u32 s36, s36, s33
buffer_store_dwordx2 v[100:101], v14, s[16:19], s36 offen
s_add_u32 s35, s34, 2
s_lshr_b32 s36, s35, 1
s_and_b32 s35, s35, 1
s_lshl_b32 s36, s36, 12
s_lshl_b32 s35, s35, 3
s_add_u32 s36, s36, s35
s_add_u32 s36, s36, s33
buffer_store_dwordx2 v[108:109], v14, s[16:19], s36 offen
s_add_u32 s35, s34, 3
s_lshr_b32 s36, s35, 1
s_and_b32 s35, s35, 1
s_lshl_b32 s36, s36, 12
s_lshl_b32 s35, s35, 3
s_add_u32 s36, s36, s35
s_add_u32 s36, s36, s33
buffer_store_dwordx2 v[116:117], v14, s[16:19], s36 offen
s_add_u32 s35, s34, 4
s_lshr_b32 s36, s35, 1
s_and_b32 s35, s35, 1
s_lshl_b32 s36, s36, 12
s_lshl_b32 s35, s35, 3
s_add_u32 s36, s36, s35
s_add_u32 s36, s36, s33
buffer_store_dwordx2 v[124:125], v14, s[16:19], s36 offen
s_endpgm
K1_FFN0:
v_lshrrev_b32 v14, 3, v1
v_and_b32 v15, 7, v1
v_xor_b32 v15, v15, v14
v_lshlrev_b32 v15, 4, v15
s_mov_b32 s30, 0
s_mov_b32 s31, 0
s_mov_b32 s29, 0
s_mov_b32 s28, 0
s_mov_b32 s43, 221184
s_mov_b32 s38, 128
s_mov_b32 s39, 49152
s_add_i32 s33, s32, 0
v_add_u32 v2, s33, v14
v_max_i32 v2, 0, v2
v_mul_u32_u24 v2, 1280, v2
v_add_u32 v2, v2, v15
s_waitcnt lgkmcnt(0)
s_mov_b32 s8, s4
s_mov_b32 s9, s5
s_mov_b32 s52, s62
s_mov_b32 s53, s63
s_mov_b32 s12, s60
s_mov_b32 s13, s61
s_add_u32 m0, s29, 0
s_nop 0
buffer_load_dwordx4 v2, s[8:11], s30 offen lds
s_add_i32 s33, s32, 64
v_add_u32 v3, s33, v14
v_max_i32 v3, 0, v3
v_mul_u32_u24 v3, 1280, v3
v_add_u32 v3, v3, v15
s_add_u32 m0, s29, 8192
s_nop 0
buffer_load_dwordx4 v3, s[8:11], s30 offen lds
s_add_i32 s33, s32, 128
v_add_u32 v4, s33, v14
v_max_i32 v4, 0, v4
v_mul_u32_u24 v4, 1280, v4
v_add_u32 v4, v4, v15
s_add_u32 m0, s29, 16384
s_nop 0
buffer_load_dwordx4 v4, s[8:11], s30 offen lds
v_add_u32 v16, 384, v1
v_mul_u32_u24 v17, 2185, v16
v_lshrrev_b32 v17, 16, v17
v_mul_u32_u24 v18, 30, v17
v_sub_u32 v18, v16, v18
v_and_b32 v19, 0x33, v17
v_and_b32 v20, 4, v17
v_lshl_or_b32 v19, v20, 1, v19
v_bfe_u32 v20, v17, 3, 1
v_lshl_or_b32 v19, v20, 2, v19
v_lshlrev_b32 v18, 4, v18
v_mul_u32_u24 v5, 3456, v19
v_add3_u32 v5, v5, v18, s36
s_add_u32 m0, s29, 24576
s_nop 0
buffer_load_dwordx4 v5, s[12:15], s31 offen lds
v_add_u32 v16, 896, v1
v_mul_u32_u24 v17, 2185, v16
v_lshrrev_b32 v17, 16, v17
v_mul_u32_u24 v18, 30, v17
v_sub_u32 v18, v16, v18
v_and_b32 v19, 0x33, v17
v_and_b32 v20, 4, v17
v_lshl_or_b32 v19, v20, 1, v19
v_bfe_u32 v20, v17, 3, 1
v_lshl_or_b32 v19, v20, 2, v19
v_lshlrev_b32 v18, 4, v18
v_mul_u32_u24 v6, 3456, v19
v_add3_u32 v6, v6, v18, s36
s_add_u32 m0, s29, 32768
s_nop 0
buffer_load_dwordx4 v6, s[12:15], s31 offen lds
v_add_u32 v16, 1408, v1
v_mul_u32_u24 v17, 2185, v16
v_lshrrev_b32 v17, 16, v17
v_mul_u32_u24 v18, 30, v17
v_sub_u32 v18, v16, v18
v_and_b32 v19, 0x33, v17
v_and_b32 v20, 4, v17
v_lshl_or_b32 v19, v20, 1, v19
v_bfe_u32 v20, v17, 3, 1
v_lshl_or_b32 v19, v20, 2, v19
v_lshlrev_b32 v18, 4, v18
v_mul_u32_u24 v7, 3456, v19
v_add3_u32 v7, v7, v18, s36
s_add_u32 m0, s29, 40960
s_nop 0
buffer_load_dwordx4 v7, s[12:15], s31 offen lds
s_add_u32 s30, s30, s38
s_add_u32 s31, s31, s43
s_add_u32 s29, s29, s39
s_cmp_eq_u32 s29, 147456
s_cselect_b32 s29, 0, s29
s_cmp_eq_u32 s30, 1280
s_cselect_b32 s30, 0, s30
s_cselect_b32 s31, 0, s31
s_cselect_b32 s38, 0, s38
s_cselect_b32 s43, 0, s43
s_cselect_b32 s39, 0, s39
s_cselect_b32 s29, 0x30000, s29
s_cselect_b32 s10, 0, s10
s_cselect_b32 s14, 0, s14
s_add_u32 m0, s29, 0
s_nop 0
buffer_load_dwordx4 v2, s[8:11], s30 offen lds
s_add_u32 m0, s29, 8192
s_nop 0
buffer_load_dwordx4 v3, s[8:11], s30 offen lds
s_add_u32 m0, s29, 16384
s_nop 0
buffer_load_dwordx4 v4, s[8:11], s30 offen lds
s_add_u32 m0, s29, 24576
s_nop 0
buffer_load_dwordx4 v5, s[12:15], s31 offen lds
s_add_u32 m0, s29, 32768
s_nop 0
buffer_load_dwordx4 v6, s[12:15], s31 offen lds
s_add_u32 m0, s29, 40960
s_nop 0
buffer_load_dwordx4 v7, s[12:15], s31 offen lds
s_add_u32 s30, s30, s38
s_add_u32 s31, s31, s43
s_add_u32 s29, s29, s39
s_cmp_eq_u32 s29, 147456
s_cselect_b32 s29, 0, s29
s_cmp_eq_u32 s30, 1280
s_cselect_b32 s30, 0, s30
s_cselect_b32 s31, 0, s31
s_cselect_b32 s38, 0, s38
s_cselect_b32 s43, 0, s43
s_cselect_b32 s39, 0, s39
s_cselect_b32 s29, 0x30000, s29
s_cselect_b32 s10, 0, s10
s_cselect_b32 s14, 0, s14
s_add_u32 s42, s37, 0
s_cmp_ge_u32 s42, 592
s_cbranch_scc1 RLS17
s_mov_b32 s22, 2211840
s_mov_b32 s23, 0x00020000
s_sub_u32 s35, s42, 432
s_cmp_ge_u32 s42, 432
s_cselect_b32 s20, s50, s52
s_cselect_b32 s21, s51, s53
s_cselect_b32 s22, 819200, s22
s_cselect_b32 s35, s35, s42
s_lshr_b32 s33, s35, 3
s_and_b32 s34, s35, 7
s_mul_i32 s33, s33, 40960
s_mul_i32 s34, s34, 160
s_add_u32 s33, s33, s34
v_add_u32 v16, 0, v1
v_mul_u32_u24 v17, 6554, v16
v_lshrrev_b32 v17, 16, v17
v_mul_u32_u24 v18, 10, v17
v_sub_u32 v18, v16, v18
v_lshlrev_b32 v18, 4, v18
v_mul_u32_u24 v17, 1280, v17
v_add_u32 v18, v18, v17
s_mov_b32 m0, 147456
s_nop 0
buffer_load_dwordx4 v18, s[20:23], s33 offen lds
v_add_u32 v16, 64, v1
v_mul_u32_u24 v17, 6554, v16
v_lshrrev_b32 v17, 16, v17
v_mul_u32_u24 v18, 10, v17
v_sub_u32 v18, v16, v18
v_lshlrev_b32 v18, 4, v18
v_mul_u32_u24 v17, 1280, v17
v_add_u32 v18, v18, v17
s_mov_b32 m0, 148480
s_nop 0
buffer_load_dwordx4 v18, s[20:23], s33 offen lds
v_add_u32 v16, 128, v1
v_mul_u32_u24 v17, 6554, v16
v_lshrrev_b32 v17, 16, v17
v_mul_u32_u24 v18, 10, v17
v_sub_u32 v18, v16, v18
v_lshlrev_b32 v18, 4, v18
v_mul_u32_u24 v17, 1280, v17
v_add_u32 v18, v18, v17
s_mov_b32 m0, 149504
s_nop 0
buffer_load_dwordx4 v18, s[20:23], s33 offen lds
v_add_u32 v16, 192, v1
v_mul_u32_u24 v17, 6554, v16
v_lshrrev_b32 v17, 16, v17
v_mul_u32_u24 v18, 10, v17
v_sub_u32 v18, v16, v18
v_lshlrev_b32 v18, 4, v18
v_mul_u32_u24 v17, 1280, v17
v_add_u32 v18, v18, v17
s_mov_b32 m0, 150528
s_nop 0
buffer_load_dwordx4 v18, s[20:23], s33 offen lds
v_add_u32 v16, 256, v1
v_mul_u32_u24 v17, 6554, v16
v_lshrrev_b32 v17, 16, v17
v_mul_u32_u24 v18, 10, v17
v_sub_u32 v18, v16, v18
v_lshlrev_b32 v18, 4, v18
v_mul_u32_u24 v17, 1280, v17
v_add_u32 v18, v18, v17
s_mov_b32 m0, 151552
s_nop 0
buffer_load_dwordx4 v18, s[20:23], s33 offen lds
RLS17:
v_and_b32 v14, 15, v1
v_lshrrev_b32 v15, 4, v1
v_and_b32 v16, 7, v14
v_xor_b32 v16, v16, v15
v_lshlrev_b32 v16, 4, v16
v_lshl_add_u32 v11, v14, 7, v16
v_xor_b32 v12, 64, v11
v_cmp_eq_u32 s[44:45], 0, v14
v_lshrrev_b32 v16, 1, v15
v_lshlrev_b32 v16, 4, v16
v_and_b32 v17, 1, v15
v_lshl_add_u32 v16, v17, 2, v16
v_bfe_u32 v17, v1, 2, 2
v_add_u32 v16, v16, v17
v_mul_u32_u24 v16, 480, v16
v_and_b32 v17, 3, v1
v_lshl_add_u32 v16, v17, 3, v16
v_add_u32 v13, 18432, v16
v_mov_b32 v132, 0
v_mov_b32 v133, 0
v_mov_b32 v134, 0
v_mov_b32 v135, 0
v_mov_b32 v136, 0
v_mov_b32 v137, 0
v_mov_b32 v138, 0
v_mov_b32 v139, 0
v_mov_b32 v140, 0
v_mov_b32 v141, 0
v_mov_b32 v142, 0
v_mov_b32 v143, 0
v_mov_b32 v144, 0
v_mov_b32 v145, 0
v_mov_b32 v146, 0
v_mov_b32 v147, 0
v_mov_b32 v148, 0
v_mov_b32 v149, 0
v_mov_b32 v150, 0
v_mov_b32 v151, 0
v_mov_b32 v152, 0
v_mov_b32 v153, 0
v_mov_b32 v154, 0
v_mov_b32 v155, 0
v_mov_b32 v156, 0
v_mov_b32 v157, 0
v_mov_b32 v158, 0
v_mov_b32 v159, 0
v_mov_b32 v160, 0
v_mov_b32 v161, 0
v_mov_b32 v162, 0
v_mov_b32 v163, 0
v_mov_b32 v164, 0
v_mov_b32 v165, 0
v_mov_b32 v166, 0
v_mov_b32 v167, 0
v_mov_b32 v168, 0
v_mov_b32 v169, 0
v_mov_b32 v170, 0
v_mov_b32 v171, 0
v_mov_b32 v172, 0
v_mov_b32 v173, 0
v_mov_b32 v174, 0
v_mov_b32 v175, 0
v_mov_b32 v176, 0
v_mov_b32 v177, 0
v_mov_b32 v178, 0
v_mov_b32 v179, 0
v_mov_b32 v180, 0
v_mov_b32 v181, 0
v_mov_b32 v182, 0
v_mov_b32 v183, 0
v_mov_b32 v184, 0
v_mov_b32 v185, 0
v_mov_b32 v186, 0
v_mov_b32 v187, 0
v_mov_b32 v188, 0
v_mov_b32 v189, 0
v_mov_b32 v190, 0
v_mov_b32 v191, 0
v_mov_b32 v192, 0
v_mov_b32 v193, 0
v_mov_b32 v194, 0
v_mov_b32 v195, 0
v_mov_b32 v196, 0
v_mov_b32 v197, 0
v_mov_b32 v198, 0
v_mov_b32 v199, 0
v_mov_b32 v200, 0
v_mov_b32 v201, 0
v_mov_b32 v202, 0
v_mov_b32 v203, 0
v_mov_b32 v32, 0x3f803f80
v_mov_b32 v33, 0x3f803f80
v_mov_b32 v34, 0x3f803f80
v_mov_b32 v35, 0x3f803f80
s_cmp_ge_u32 s42, 592
s_cbranch_scc1 FW18
s_waitcnt vmcnt(11)
s_branch FW19
FW18:
s_waitcnt vmcnt(6)
FW19:
s_barrier
v_add_u32 v8, s28, v11
v_add_u32 v9, s28, v12
v_add_u32 v10, s28, v13
RX 36,8,2048
RX 40,8,4096
RX 44,8,6144
RX 48,8,8192
TR 52,10,0
TR 54,10,3840
TR 56,10,32
TR 58,10,3872
TR 60,10,64
TR 62,10,3904
TR 64,10,96
TR 66,10,3936
s_add_u32 m0, s29, 0
s_nop 0
buffer_load_dwordx4 v2, s[8:11], s30 offen lds
s_add_u32 m0, s29, 8192
s_nop 0
buffer_load_dwordx4 v3, s[8:11], s30 offen lds
s_add_u32 m0, s29, 16384
s_nop 0
buffer_load_dwordx4 v4, s[8:11], s30 offen lds
s_add_u32 m0, s29, 24576
s_nop 0
buffer_load_dwordx4 v5, s[12:15], s31 offen lds
s_add_u32 m0, s29, 32768
s_nop 0
buffer_load_dwordx4 v6, s[12:15], s31 offen lds
s_add_u32 m0, s29, 40960
s_nop 0
buffer_load_dwordx4 v7, s[12:15], s31 offen lds
s_add_u32 s30, s30, s38
s_add_u32 s31, s31, s43
s_add_u32 s29, s29, s39
s_cmp_eq_u32 s29, 147456
s_cselect_b32 s29, 0, s29
s_cmp_eq_u32 s30, 1280
s_cselect_b32 s30, 0, s30
s_cselect_b32 s31, 0, s31
s_cselect_b32 s38, 0, s38
s_cselect_b32 s43, 0, s43
s_cselect_b32 s39, 0, s39
s_cselect_b32 s29, 0x30000, s29
s_cselect_b32 s10, 0, s10
s_cselect_b32 s14, 0, s14
s_mov_b32 s27, 0
s_waitcnt lgkmcnt(0)
K1Lffn0:
M 132,52,36
RX 84,9,2048
M 136,52,40
RX 88,9,4096
M 140,52,44
RX 92,9,6144
M 144,52,48
RX 96,9,8192
M 148,56,36
TR 100,10,15360
M 152,56,40
TR 102,10,19200
M 156,56,44
TR 104,10,15392
M 160,56,48
TR 106,10,19232
M 164,60,36
TR 108,10,15424
M 168,60,40
TR 110,10,19264
M 172,60,44
TR 112,10,15456
M 176,60,48
TR 114,10,19296
M 180,64,36
M 184,64,40
s_add_u32 s28, s28, 49152
s_cmp_eq_u32 s28, 147456
s_cselect_b32 s28, 0, s28
M 188,64,44
v_add_u32 v8, s28, v11
v_add_u32 v9, s28, v12
v_add_u32 v10, s28, v13
M 192,64,48
s_cmp_eq_u32 s27, 9
M 196,32,36
M 200,36,36
s_cbranch_scc1 K1Effn0
s_waitcnt vmcnt(6) lgkmcnt(0)
s_barrier
M 132,100,84
s_add_u32 m0, s29, 0
RX 36,8,2048
buffer_load_dwordx4 v2, s[8:11], s30 offen lds
M 136,100,88
s_add_u32 m0, s29, 8192
RX 40,8,4096
buffer_load_dwordx4 v3, s[8:11], s30 offen lds
M 140,100,92
s_add_u32 m0, s29, 16384
RX 44,8,6144
buffer_load_dwordx4 v4, s[8:11], s30 offen lds
M 144,100,96
s_add_u32 m0, s29, 24576
RX 48,8,8192
buffer_load_dwordx4 v5, s[12:15], s31 offen lds
M 148,104,84
s_add_u32 m0, s29, 32768
TR 52,10,0
buffer_load_dwordx4 v6, s[12:15], s31 offen lds
M 152,104,88
s_add_u32 m0, s29, 40960
TR 54,10,3840
buffer_load_dwordx4 v7, s[12:15], s31 offen lds
M 156,104,92
TR 56,10,32
M 160,104,96
TR 58,10,3872
M 164,108,84
TR 60,10,64
M 168,108,88
TR 62,10,3904
M 172,108,92
TR 64,10,96
M 176,108,96
TR 66,10,3936
M 180,112,84
s_add_u32 s30, s30, s38
s_add_u32 s31, s31, s43
s_add_u32 s29, s29, s39
M 184,112,88
s_cmp_eq_u32 s29, 147456
s_cselect_b32 s29, 0, s29
s_cmp_eq_u32 s30, 1280
M 188,112,92
s_cselect_b32 s30, 0, s30
s_cselect_b32 s31, 0, s31
s_cselect_b32 s38, 0, s38
M 192,112,96
s_cselect_b32 s43, 0, s43
s_cselect_b32 s39, 0, s39
s_cselect_b32 s29, 0x30000, s29
M 196,32,84
s_cselect_b32 s10, 0, s10
s_cselect_b32 s14, 0, s14
s_add_u32 s27, s27, 1
M 200,84,84
s_waitcnt lgkmcnt(0)
s_branch K1Lffn0
K1Effn0:
s_waitcnt lgkmcnt(0)
M 132,100,84
M 136,100,88
M 140,100,92
M 144,100,96
M 148,104,84
M 152,104,88
M 156,104,92
M 160,104,96
M 164,108,84
M 168,108,88
M 172,108,92
M 176,108,96
M 180,112,84
M 184,112,88
M 188,112,92
M 192,112,96
M 196,32,84
M 200,84,84
s_waitcnt vmcnt(0)
s_cmp_ge_u32 s42, 592
s_cbranch_scc1 RLO20
v_lshrrev_b32 v220, 2, v1
v_mul_u32_u24 v220, 160, v220
v_and_b32 v221, 3, v1
v_lshl_add_u32 v220, v221, 3, v220
v_add_u32 v220, 147456, v220
TR 224,220,0
TR 226,220,2560
TR 228,220,32
TR 230,220,2592
TR 232,220,64
TR 234,220,2624
TR 236,220,96
TR 238,220,2656
TR 240,220,128
TR 242,220,2688
s_sub_u32 s35, s42, 432
s_mov_b32 s33, 10485760
s_cmp_ge_u32 s42, 432
s_cselect_b32 s35, s35, s42
s_cselect_b32 s36, 20, 54
s_cselect_b32 s33, 13631488, s33
s_lshr_b32 s34, s35, 3
s_and_b32 s35, s35, 7
s_mul_i32 s35, s35, s36
s_add_u32 s35, s35, s34
s_mul_i32 s35, s35, 5120
s_add_u32 s33, s33, s35
s_add_u32 s34, s33, 4096
v_lshlrev_b32 v221, 4, v1
s_waitcnt lgkmcnt(0)
buffer_store_dwordx4 v[224:227], v221, s[16:19], s33 offen offset:0
buffer_store_dwordx4 v[228:231], v221, s[16:19], s33 offen offset:1024
buffer_store_dwordx4 v[232:235], v221, s[16:19], s33 offen offset:2048
buffer_store_dwordx4 v[236:239], v221, s[16:19], s33 offen offset:3072
buffer_store_dwordx4 v[240:243], v221, s[16:19], s34 offen
RLO20:
v_and_b32 v14, 15, v1
v_lshrrev_b32 v15, 4, v1
v_lshrrev_b32 v16, 2, v14
v_and_b32 v17, 3, v14
v_cmp_eq_u32 s[46:47], v16, v15
v_cmp_eq_u32 s[48:49], 1, v17
v_cmp_eq_u32 s[54:55], 2, v17
v_cmp_eq_u32 s[56:57], 3, v17
v_lshlrev_b32 v18, 2, v14
v_add_u32 v18, 98304, v18
s_mov_b32 s33, 0x3acccccd
s_mov_b32 s34, 0x3727c5ac
v_cndmask_b32 v200, v200, v201, s[48:49]
v_cndmask_b32 v200, v200, v202, s[54:55]
v_cndmask_b32 v200, v200, v203, s[56:57]
v_mul_f32 v196, s33, v196
v_mul_f32 v200, s33, v200
v_fma_f32 v200, -v196, v196, v200
v_max_f32 v200, 0, v200
v_add_f32 v200, s34, v200
v_rsq_f32 v200, v200
s_mov_b64 exec, s[46:47]
ds_write_b32 v18, v196 offset:64
ds_write_b32 v18, v200 offset:640
s_mov_b64 exec, -1
s_waitcnt lgkmcnt(0)
s_barrier
v_and_b32 v14, 15, v1
v_lshlrev_b32 v14, 2, v14
v_lshrrev_b32 v15, 4, v1
v_lshlrev_b32 v15, 4, v15
v_add_u32 v14, 98304, v14
v_add_u32 v15, 98304, v15
ds_read_b32 v36, v14 offset:64
ds_read_b32 v38, v14 offset:640
ds_read_b32 v42, v14 offset:128
ds_read_b32 v44, v14 offset:704
ds_read_b32 v48, v14 offset:192
ds_read_b32 v50, v14 offset:768
ds_read_b32 v54, v14 offset:256
ds_read_b32 v56, v14 offset:832
ds_read_b128 v[60:63], v15 offset:1152
ds_read_b128 v[64:67], v15 offset:1216
ds_read_b128 v[68:71], v15 offset:1280
ds_read_b128 v[72:75], v15 offset:1344
s_waitcnt lgkmcnt(0)
v_mov_b32 v16, 1.0
v_mov_b32 v17, 1.0
s_mov_b32 s33, 0xbfb8aa3b
v_mul_f32 v40, s33, v38
v_mul_f32 v46, s33, v44
v_mul_f32 v52, s33, v50
v_mul_f32 v58, s33, v56
PFN 132,36,60
PFN 134,36,62
PMB 18,40,132
PMB 20,40,134
v_exp_f32 v18, v18
v_exp_f32 v19, v19
v_exp_f32 v20, v20
v_exp_f32 v21, v21
PMB 132,38,132
PMB 134,38,134
PA 18,18,16
PA 20,20,16
v_rcp_f32 v18, v18
v_rcp_f32 v19, v19
v_rcp_f32 v20, v20
v_rcp_f32 v21, v21
s_nop 0
PM 132,132,18
PM 134,134,20
CV 132,132,133
CV 133,134,135
PFN 136,42,60
PFN 138,42,62
PMB 22,46,136
PMB 24,46,138
v_exp_f32 v22, v22
v_exp_f32 v23, v23
v_exp_f32 v24, v24
v_exp_f32 v25, v25
PMB 136,44,136
PMB 138,44,138
PA 22,22,16
PA 24,24,16
v_rcp_f32 v22, v22
v_rcp_f32 v23, v23
v_rcp_f32 v24, v24
v_rcp_f32 v25, v25
s_nop 0
PM 136,136,22
PM 138,138,24
CV 136,136,137
CV 137,138,139
PFN 140,48,60
PFN 142,48,62
PMB 18,52,140
PMB 20,52,142
v_exp_f32 v18, v18
v_exp_f32 v19, v19
v_exp_f32 v20, v20
v_exp_f32 v21, v21
PMB 140,50,140
PMB 142,50,142
PA 18,18,16
PA 20,20,16
v_rcp_f32 v18, v18
v_rcp_f32 v19, v19
v_rcp_f32 v20, v20
v_rcp_f32 v21, v21
s_nop 0
PM 140,140,18
PM 142,142,20
CV 140,140,141
CV 141,142,143
PFN 144,54,60
PFN 146,54,62
PMB 22,58,144
PMB 24,58,146
v_exp_f32 v22, v22
v_exp_f32 v23, v23
v_exp_f32 v24, v24
v_exp_f32 v25, v25
PMB 144,56,144
PMB 146,56,146
PA 22,22,16
PA 24,24,16
v_rcp_f32 v22, v22
v_rcp_f32 v23, v23
v_rcp_f32 v24, v24
v_rcp_f32 v25, v25
s_nop 0
PM 144,144,22
PM 146,146,24
CV 144,144,145
CV 145,146,147
PFN 148,36,64
PFN 150,36,66
PMB 18,40,148
PMB 20,40,150
v_exp_f32 v18, v18
v_exp_f32 v19, v19
v_exp_f32 v20, v20
v_exp_f32 v21, v21
PMB 148,38,148
PMB 150,38,150
PA 18,18,16
PA 20,20,16
v_rcp_f32 v18, v18
v_rcp_f32 v19, v19
v_rcp_f32 v20, v20
v_rcp_f32 v21, v21
s_nop 0
PM 148,148,18
PM 150,150,20
CV 148,148,149
CV 149,150,151
PFN 152,42,64
PFN 154,42,66
PMB 22,46,152
PMB 24,46,154
v_exp_f32 v22, v22
v_exp_f32 v23, v23
v_exp_f32 v24, v24
v_exp_f32 v25, v25
PMB 152,44,152
PMB 154,44,154
PA 22,22,16
PA 24,24,16
v_rcp_f32 v22, v22
v_rcp_f32 v23, v23
v_rcp_f32 v24, v24
v_rcp_f32 v25, v25
s_nop 0
PM 152,152,22
PM 154,154,24
CV 152,152,153
CV 153,154,155
PFN 156,48,64
PFN 158,48,66
PMB 18,52,156
PMB 20,52,158
v_exp_f32 v18, v18
v_exp_f32 v19, v19
v_exp_f32 v20, v20
v_exp_f32 v21, v21
PMB 156,50,156
PMB 158,50,158
PA 18,18,16
PA 20,20,16
v_rcp_f32 v18, v18
v_rcp_f32 v19, v19
v_rcp_f32 v20, v20
v_rcp_f32 v21, v21
s_nop 0
PM 156,156,18
PM 158,158,20
CV 156,156,157
CV 157,158,159
PFN 160,54,64
PFN 162,54,66
PMB 22,58,160
PMB 24,58,162
v_exp_f32 v22, v22
v_exp_f32 v23, v23
v_exp_f32 v24, v24
v_exp_f32 v25, v25
PMB 160,56,160
PMB 162,56,162
PA 22,22,16
PA 24,24,16
v_rcp_f32 v22, v22
v_rcp_f32 v23, v23
v_rcp_f32 v24, v24
v_rcp_f32 v25, v25
s_nop 0
PM 160,160,22
PM 162,162,24
CV 160,160,161
CV 161,162,163
PFN 164,36,68
PFN 166,36,70
PMB 18,40,164
PMB 20,40,166
v_exp_f32 v18, v18
v_exp_f32 v19, v19
v_exp_f32 v20, v20
v_exp_f32 v21, v21
PMB 164,38,164
PMB 166,38,166
PA 18,18,16
PA 20,20,16
v_rcp_f32 v18, v18
v_rcp_f32 v19, v19
v_rcp_f32 v20, v20
v_rcp_f32 v21, v21
s_nop 0
PM 164,164,18
PM 166,166,20
CV 164,164,165
CV 165,166,167
PFN 168,42,68
PFN 170,42,70
PMB 22,46,168
PMB 24,46,170
v_exp_f32 v22, v22
v_exp_f32 v23, v23
v_exp_f32 v24, v24
v_exp_f32 v25, v25
PMB 168,44,168
PMB 170,44,170
PA 22,22,16
PA 24,24,16
v_rcp_f32 v22, v22
v_rcp_f32 v23, v23
v_rcp_f32 v24, v24
v_rcp_f32 v25, v25
s_nop 0
PM 168,168,22
PM 170,170,24
CV 168,168,169
CV 169,170,171
PFN 172,48,68
PFN 174,48,70
PMB 18,52,172
PMB 20,52,174
v_exp_f32 v18, v18
v_exp_f32 v19, v19
v_exp_f32 v20, v20
v_exp_f32 v21, v21
PMB 172,50,172
PMB 174,50,174
PA 18,18,16
PA 20,20,16
v_rcp_f32 v18, v18
v_rcp_f32 v19, v19
v_rcp_f32 v20, v20
v_rcp_f32 v21, v21
s_nop 0
PM 172,172,18
PM 174,174,20
CV 172,172,173
CV 173,174,175
PFN 176,54,68
PFN 178,54,70
PMB 22,58,176
PMB 24,58,178
v_exp_f32 v22, v22
v_exp_f32 v23, v23
v_exp_f32 v24, v24
v_exp_f32 v25, v25
PMB 176,56,176
PMB 178,56,178
PA 22,22,16
PA 24,24,16
v_rcp_f32 v22, v22
v_rcp_f32 v23, v23
v_rcp_f32 v24, v24
v_rcp_f32 v25, v25
s_nop 0
PM 176,176,22
PM 178,178,24
CV 176,176,177
CV 177,178,179
PFN 180,36,72
PFN 182,36,74
PMB 18,40,180
PMB 20,40,182
v_exp_f32 v18, v18
v_exp_f32 v19, v19
v_exp_f32 v20, v20
v_exp_f32 v21, v21
PMB 180,38,180
PMB 182,38,182
PA 18,18,16
PA 20,20,16
v_rcp_f32 v18, v18
v_rcp_f32 v19, v19
v_rcp_f32 v20, v20
v_rcp_f32 v21, v21
s_nop 0
PM 180,180,18
PM 182,182,20
CV 180,180,181
CV 181,182,183
PFN 184,42,72
PFN 186,42,74
PMB 22,46,184
PMB 24,46,186
v_exp_f32 v22, v22
v_exp_f32 v23, v23
v_exp_f32 v24, v24
v_exp_f32 v25, v25
PMB 184,44,184
PMB 186,44,186
PA 22,22,16
PA 24,24,16
v_rcp_f32 v22, v22
v_rcp_f32 v23, v23
v_rcp_f32 v24, v24
v_rcp_f32 v25, v25
s_nop 0
PM 184,184,22
PM 186,186,24
CV 184,184,185
CV 185,186,187
PFN 188,48,72
PFN 190,48,74
PMB 18,52,188
PMB 20,52,190
v_exp_f32 v18, v18
v_exp_f32 v19, v19
v_exp_f32 v20, v20
v_exp_f32 v21, v21
PMB 188,50,188
PMB 190,50,190
PA 18,18,16
PA 20,20,16
v_rcp_f32 v18, v18
v_rcp_f32 v19, v19
v_rcp_f32 v20, v20
v_rcp_f32 v21, v21
s_nop 0
PM 188,188,18
PM 190,190,20
CV 188,188,189
CV 189,190,191
PFN 192,54,72
PFN 194,54,74
PMB 22,58,192
PMB 24,58,194
v_exp_f32 v22, v22
v_exp_f32 v23, v23
v_exp_f32 v24, v24
v_exp_f32 v25, v25
PMB 192,56,192
PMB 194,56,194
PA 22,22,16
PA 24,24,16
v_rcp_f32 v22, v22
v_rcp_f32 v23, v23
v_rcp_f32 v24, v24
v_rcp_f32 v25, v25
s_nop 0
PM 192,192,22
PM 194,194,24
CV 192,192,193
CV 193,194,195
s_mul_i32 s33, s24, 108
s_mul_i32 s34, s25, 7
s_add_u32 s33, s33, s34
s_lshl_b32 s33, s33, 12
v_lshlrev_b32 v14, 4, v1
s_add_u32 s34, s33, 0
buffer_store_dwordx2 v[132:133], v14, s[16:19], s34 offen
s_add_u32 s34, s33, 1024
buffer_store_dwordx2 v[136:137], v14, s[16:19], s34 offen
s_add_u32 s34, s33, 2048
buffer_store_dwordx2 v[140:141], v14, s[16:19], s34 offen
s_add_u32 s34, s33, 3072
buffer_store_dwordx2 v[144:145], v14, s[16:19], s34 offen
s_add_u32 s34, s33, 8
buffer_store_dwordx2 v[148:149], v14, s[16:19], s34 offen
s_add_u32 s34, s33, 1032
buffer_store_dwordx2 v[152:153], v14, s[16:19], s34 offen
s_add_u32 s34, s33, 2056
buffer_store_dwordx2 v[156:157], v14, s[16:19], s34 offen
s_add_u32 s34, s33, 3080
buffer_store_dwordx2 v[160:161], v14, s[16:19], s34 offen
s_add_u32 s34, s33, 4096
buffer_store_dwordx2 v[164:165], v14, s[16:19], s34 offen
s_add_u32 s34, s33, 5120
buffer_store_dwordx2 v[168:169], v14, s[16:19], s34 offen
s_add_u32 s34, s33, 6144
buffer_store_dwordx2 v[172:173], v14, s[16:19], s34 offen
s_add_u32 s34, s33, 7168
buffer_store_dwordx2 v[176:177], v14, s[16:19], s34 offen
s_add_u32 s34, s33, 4104
buffer_store_dwordx2 v[180:181], v14, s[16:19], s34 offen
s_add_u32 s34, s33, 5128
buffer_store_dwordx2 v[184:185], v14, s[16:19], s34 offen
s_add_u32 s34, s33, 6152
buffer_store_dwordx2 v[188:189], v14, s[16:19], s34 offen
s_add_u32 s34, s33, 7176
buffer_store_dwordx2 v[192:193], v14, s[16:19], s34 offen
s_endpgm
K1_FFN1:
v_lshrrev_b32 v14, 3, v1
v_and_b32 v15, 7, v1
v_xor_b32 v15, v15, v14
v_lshlrev_b32 v15, 4, v15
s_mov_b32 s30, 0
s_mov_b32 s31, 0
s_mov_b32 s29, 0
s_mov_b32 s28, 0
s_mov_b32 s43, 221184
s_mov_b32 s38, 128
s_mov_b32 s39, 49152
s_add_i32 s33, s32, 8
v_add_u32 v2, s33, v14
v_max_i32 v2, 0, v2
v_mul_u32_u24 v2, 1280, v2
v_add_u32 v2, v2, v15
s_waitcnt lgkmcnt(0)
s_mov_b32 s8, s4
s_mov_b32 s9, s5
s_mov_b32 s52, s62
s_mov_b32 s53, s63
s_mov_b32 s12, s60
s_mov_b32 s13, s61
s_add_u32 m0, s29, 1024
s_nop 0
buffer_load_dwordx4 v2, s[8:11], s30 offen lds
s_add_i32 s33, s32, 72
v_add_u32 v3, s33, v14
v_max_i32 v3, 0, v3
v_mul_u32_u24 v3, 1280, v3
v_add_u32 v3, v3, v15
s_add_u32 m0, s29, 9216
s_nop 0
buffer_load_dwordx4 v3, s[8:11], s30 offen lds
s_add_i32 s33, s32, 136
v_add_u32 v4, s33, v14
v_max_i32 v4, 0, v4
v_mul_u32_u24 v4, 1280, v4
v_add_u32 v4, v4, v15
s_add_u32 m0, s29, 17408
s_nop 0
buffer_load_dwordx4 v4, s[8:11], s30 offen lds
v_add_u32 v16, 448, v1
v_mul_u32_u24 v17, 2185, v16
v_lshrrev_b32 v17, 16, v17
v_mul_u32_u24 v18, 30, v17
v_sub_u32 v18, v16, v18
v_and_b32 v19, 0x33, v17
v_and_b32 v20, 4, v17
v_lshl_or_b32 v19, v20, 1, v19
v_bfe_u32 v20, v17, 3, 1
v_lshl_or_b32 v19, v20, 2, v19
v_lshlrev_b32 v18, 4, v18
v_mul_u32_u24 v5, 3456, v19
v_add3_u32 v5, v5, v18, s36
s_add_u32 m0, s29, 25600
s_nop 0
buffer_load_dwordx4 v5, s[12:15], s31 offen lds
v_add_u32 v16, 960, v1
v_mul_u32_u24 v17, 2185, v16
v_lshrrev_b32 v17, 16, v17
v_mul_u32_u24 v18, 30, v17
v_sub_u32 v18, v16, v18
v_and_b32 v19, 0x33, v17
v_and_b32 v20, 4, v17
v_lshl_or_b32 v19, v20, 1, v19
v_bfe_u32 v20, v17, 3, 1
v_lshl_or_b32 v19, v20, 2, v19
v_lshlrev_b32 v18, 4, v18
v_mul_u32_u24 v6, 3456, v19
v_add3_u32 v6, v6, v18, s36
s_add_u32 m0, s29, 33792
s_nop 0
buffer_load_dwordx4 v6, s[12:15], s31 offen lds
v_add_u32 v16, 1472, v1
v_mul_u32_u24 v17, 2185, v16
v_lshrrev_b32 v17, 16, v17
v_mul_u32_u24 v18, 30, v17
v_sub_u32 v18, v16, v18
v_and_b32 v19, 0x33, v17
v_and_b32 v20, 4, v17
v_lshl_or_b32 v19, v20, 1, v19
v_bfe_u32 v20, v17, 3, 1
v_lshl_or_b32 v19, v20, 2, v19
v_lshlrev_b32 v18, 4, v18
v_mul_u32_u24 v7, 3456, v19
v_add3_u32 v7, v7, v18, s36
s_add_u32 m0, s29, 41984
s_nop 0
buffer_load_dwordx4 v7, s[12:15], s31 offen lds
s_add_u32 s30, s30, s38
s_add_u32 s31, s31, s43
s_add_u32 s29, s29, s39
s_cmp_eq_u32 s29, 147456
s_cselect_b32 s29, 0, s29
s_cmp_eq_u32 s30, 1280
s_cselect_b32 s30, 0, s30
s_cselect_b32 s31, 0, s31
s_cselect_b32 s38, 0, s38
s_cselect_b32 s43, 0, s43
s_cselect_b32 s39, 0, s39
s_cselect_b32 s29, 0x30000, s29
s_cselect_b32 s10, 0, s10
s_cselect_b32 s14, 0, s14
s_add_u32 m0, s29, 1024
s_nop 0
buffer_load_dwordx4 v2, s[8:11], s30 offen lds
s_add_u32 m0, s29, 9216
s_nop 0
buffer_load_dwordx4 v3, s[8:11], s30 offen lds
s_add_u32 m0, s29, 17408
s_nop 0
buffer_load_dwordx4 v4, s[8:11], s30 offen lds
s_add_u32 m0, s29, 25600
s_nop 0
buffer_load_dwordx4 v5, s[12:15], s31 offen lds
s_add_u32 m0, s29, 33792
s_nop 0
buffer_load_dwordx4 v6, s[12:15], s31 offen lds
s_add_u32 m0, s29, 41984
s_nop 0
buffer_load_dwordx4 v7, s[12:15], s31 offen lds
s_add_u32 s30, s30, s38
s_add_u32 s31, s31, s43
s_add_u32 s29, s29, s39
s_cmp_eq_u32 s29, 147456
s_cselect_b32 s29, 0, s29
s_cmp_eq_u32 s30, 1280
s_cselect_b32 s30, 0, s30
s_cselect_b32 s31, 0, s31
s_cselect_b32 s38, 0, s38
s_cselect_b32 s43, 0, s43
s_cselect_b32 s39, 0, s39
s_cselect_b32 s29, 0x30000, s29
s_cselect_b32 s10, 0, s10
s_cselect_b32 s14, 0, s14
s_add_u32 s42, s37, 256
s_cmp_ge_u32 s42, 592
s_cbranch_scc1 RLS21
s_mov_b32 s22, 2211840
s_mov_b32 s23, 0x00020000
s_sub_u32 s35, s42, 432
s_cmp_ge_u32 s42, 432
s_cselect_b32 s20, s50, s52
s_cselect_b32 s21, s51, s53
s_cselect_b32 s22, 819200, s22
s_cselect_b32 s35, s35, s42
s_lshr_b32 s33, s35, 3
s_and_b32 s34, s35, 7
s_mul_i32 s33, s33, 40960
s_mul_i32 s34, s34, 160
s_add_u32 s33, s33, s34
v_add_u32 v16, 0, v1
v_mul_u32_u24 v17, 6554, v16
v_lshrrev_b32 v17, 16, v17
v_mul_u32_u24 v18, 10, v17
v_sub_u32 v18, v16, v18
v_lshlrev_b32 v18, 4, v18
v_mul_u32_u24 v17, 1280, v17
v_add_u32 v18, v18, v17
s_mov_b32 m0, 152576
s_nop 0
buffer_load_dwordx4 v18, s[20:23], s33 offen lds
v_add_u32 v16, 64, v1
v_mul_u32_u24 v17, 6554, v16
v_lshrrev_b32 v17, 16, v17
v_mul_u32_u24 v18, 10, v17
v_sub_u32 v18, v16, v18
v_lshlrev_b32 v18, 4, v18
v_mul_u32_u24 v17, 1280, v17
v_add_u32 v18, v18, v17
s_mov_b32 m0, 153600
s_nop 0
buffer_load_dwordx4 v18, s[20:23], s33 offen lds
v_add_u32 v16, 128, v1
v_mul_u32_u24 v17, 6554, v16
v_lshrrev_b32 v17, 16, v17
v_mul_u32_u24 v18, 10, v17
v_sub_u32 v18, v16, v18
v_lshlrev_b32 v18, 4, v18
v_mul_u32_u24 v17, 1280, v17
v_add_u32 v18, v18, v17
s_mov_b32 m0, 154624
s_nop 0
buffer_load_dwordx4 v18, s[20:23], s33 offen lds
v_add_u32 v16, 192, v1
v_mul_u32_u24 v17, 6554, v16
v_lshrrev_b32 v17, 16, v17
v_mul_u32_u24 v18, 10, v17
v_sub_u32 v18, v16, v18
v_lshlrev_b32 v18, 4, v18
v_mul_u32_u24 v17, 1280, v17
v_add_u32 v18, v18, v17
s_mov_b32 m0, 155648
s_nop 0
buffer_load_dwordx4 v18, s[20:23], s33 offen lds
v_add_u32 v16, 256, v1
v_mul_u32_u24 v17, 6554, v16
v_lshrrev_b32 v17, 16, v17
v_mul_u32_u24 v18, 10, v17
v_sub_u32 v18, v16, v18
v_lshlrev_b32 v18, 4, v18
v_mul_u32_u24 v17, 1280, v17
v_add_u32 v18, v18, v17
s_mov_b32 m0, 156672
s_nop 0
buffer_load_dwordx4 v18, s[20:23], s33 offen lds
RLS21:
v_and_b32 v14, 15, v1
v_lshrrev_b32 v15, 4, v1
v_and_b32 v16, 7, v14
v_xor_b32 v16, v16, v15
v_lshlrev_b32 v16, 4, v16
v_lshl_add_u32 v11, v14, 7, v16
v_xor_b32 v12, 64, v11
v_cmp_eq_u32 s[44:45], 0, v14
v_lshrrev_b32 v16, 1, v15
v_lshlrev_b32 v16, 4, v16
v_and_b32 v17, 1, v15
v_lshl_add_u32 v16, v17, 2, v16
v_bfe_u32 v17, v1, 2, 2
v_add_u32 v16, v16, v17
v_mul_u32_u24 v16, 480, v16
v_and_b32 v17, 3, v1
v_lshl_add_u32 v16, v17, 3, v16
v_add_u32 v13, 18432, v16
v_mov_b32 v132, 0
v_mov_b32 v133, 0
v_mov_b32 v134, 0
v_mov_b32 v135, 0
v_mov_b32 v136, 0
v_mov_b32 v137, 0
v_mov_b32 v138, 0
v_mov_b32 v139, 0
v_mov_b32 v140, 0
v_mov_b32 v141, 0
v_mov_b32 v142, 0
v_mov_b32 v143, 0
v_mov_b32 v144, 0
v_mov_b32 v145, 0
v_mov_b32 v146, 0
v_mov_b32 v147, 0
v_mov_b32 v148, 0
v_mov_b32 v149, 0
v_mov_b32 v150, 0
v_mov_b32 v151, 0
v_mov_b32 v152, 0
v_mov_b32 v153, 0
v_mov_b32 v154, 0
v_mov_b32 v155, 0
v_mov_b32 v156, 0
v_mov_b32 v157, 0
v_mov_b32 v158, 0
v_mov_b32 v159, 0
v_mov_b32 v160, 0
v_mov_b32 v161, 0
v_mov_b32 v162, 0
v_mov_b32 v163, 0
v_mov_b32 v164, 0
v_mov_b32 v165, 0
v_mov_b32 v166, 0
v_mov_b32 v167, 0
v_mov_b32 v168, 0
v_mov_b32 v169, 0
v_mov_b32 v170, 0
v_mov_b32 v171, 0
v_mov_b32 v172, 0
v_mov_b32 v173, 0
v_mov_b32 v174, 0
v_mov_b32 v175, 0
v_mov_b32 v176, 0
v_mov_b32 v177, 0
v_mov_b32 v178, 0
v_mov_b32 v179, 0
v_mov_b32 v180, 0
v_mov_b32 v181, 0
v_mov_b32 v182, 0
v_mov_b32 v183, 0
v_mov_b32 v184, 0
v_mov_b32 v185, 0
v_mov_b32 v186, 0
v_mov_b32 v187, 0
v_mov_b32 v188, 0
v_mov_b32 v189, 0
v_mov_b32 v190, 0
v_mov_b32 v191, 0
v_mov_b32 v192, 0
v_mov_b32 v193, 0
v_mov_b32 v194, 0
v_mov_b32 v195, 0
v_mov_b32 v196, 0
v_mov_b32 v197, 0
v_mov_b32 v198, 0
v_mov_b32 v199, 0
v_mov_b32 v200, 0
v_mov_b32 v201, 0
v_mov_b32 v202, 0
v_mov_b32 v203, 0
v_mov_b32 v32, 0x3f803f80
v_mov_b32 v33, 0x3f803f80
v_mov_b32 v34, 0x3f803f80
v_mov_b32 v35, 0x3f803f80
s_cmp_ge_u32 s42, 592
s_cbranch_scc1 FW22
s_waitcnt vmcnt(11)
s_branch FW23
FW22:
s_waitcnt vmcnt(6)
FW23:
s_barrier
v_add_u32 v8, s28, v11
v_add_u32 v9, s28, v12
v_add_u32 v10, s28, v13
RX 36,8,2048
RX 40,8,4096
RX 44,8,6144
RX 48,8,8192
TR 52,10,128
TR 54,10,3968
TR 56,10,160
TR 58,10,4000
TR 60,10,192
TR 62,10,4032
TR 64,10,224
TR 66,10,4064
s_add_u32 m0, s29, 1024
s_nop 0
buffer_load_dwordx4 v2, s[8:11], s30 offen lds
s_add_u32 m0, s29, 9216
s_nop 0
buffer_load_dwordx4 v3, s[8:11], s30 offen lds
s_add_u32 m0, s29, 17408
s_nop 0
buffer_load_dwordx4 v4, s[8:11], s30 offen lds
s_add_u32 m0, s29, 25600
s_nop 0
buffer_load_dwordx4 v5, s[12:15], s31 offen lds
s_add_u32 m0, s29, 33792
s_nop 0
buffer_load_dwordx4 v6, s[12:15], s31 offen lds
s_add_u32 m0, s29, 41984
s_nop 0
buffer_load_dwordx4 v7, s[12:15], s31 offen lds
s_add_u32 s30, s30, s38
s_add_u32 s31, s31, s43
s_add_u32 s29, s29, s39
s_cmp_eq_u32 s29, 147456
s_cselect_b32 s29, 0, s29
s_cmp_eq_u32 s30, 1280
s_cselect_b32 s30, 0, s30
s_cselect_b32 s31, 0, s31
s_cselect_b32 s38, 0, s38
s_cselect_b32 s43, 0, s43
s_cselect_b32 s39, 0, s39
s_cselect_b32 s29, 0x30000, s29
s_cselect_b32 s10, 0, s10
s_cselect_b32 s14, 0, s14
s_mov_b32 s27, 0
s_waitcnt lgkmcnt(0)
K1Lffn1:
M 132,52,36
RX 84,9,2048
M 136,52,40
RX 88,9,4096
M 140,52,44
RX 92,9,6144
M 144,52,48
RX 96,9,8192
M 148,56,36
TR 100,10,15488
M 152,56,40
TR 102,10,19328
M 156,56,44
TR 104,10,15520
M 160,56,48
TR 106,10,19360
M 164,60,36
TR 108,10,15552
M 168,60,40
TR 110,10,19392
M 172,60,44
TR 112,10,15584
M 176,60,48
TR 114,10,19424
M 180,64,36
M 184,64,40
s_add_u32 s28, s28, 49152
s_cmp_eq_u32 s28, 147456
s_cselect_b32 s28, 0, s28
M 188,64,44
v_add_u32 v8, s28, v11
v_add_u32 v9, s28, v12
v_add_u32 v10, s28, v13
M 192,64,48
s_cmp_eq_u32 s27, 9
M 196,32,40
M 200,40,40
s_cbranch_scc1 K1Effn1
s_waitcnt vmcnt(6) lgkmcnt(0)
s_barrier
M 132,100,84
s_add_u32 m0, s29, 1024
RX 36,8,2048
buffer_load_dwordx4 v2, s[8:11], s30 offen lds
M 136,100,88
s_add_u32 m0, s29, 9216
RX 40,8,4096
buffer_load_dwordx4 v3, s[8:11], s30 offen lds
M 140,100,92
s_add_u32 m0, s29, 17408
RX 44,8,6144
buffer_load_dwordx4 v4, s[8:11], s30 offen lds
M 144,100,96
s_add_u32 m0, s29, 25600
RX 48,8,8192
buffer_load_dwordx4 v5, s[12:15], s31 offen lds
M 148,104,84
s_add_u32 m0, s29, 33792
TR 52,10,128
buffer_load_dwordx4 v6, s[12:15], s31 offen lds
M 152,104,88
s_add_u32 m0, s29, 41984
TR 54,10,3968
buffer_load_dwordx4 v7, s[12:15], s31 offen lds
M 156,104,92
TR 56,10,160
M 160,104,96
TR 58,10,4000
M 164,108,84
TR 60,10,192
M 168,108,88
TR 62,10,4032
M 172,108,92
TR 64,10,224
M 176,108,96
TR 66,10,4064
M 180,112,84
s_add_u32 s30, s30, s38
s_add_u32 s31, s31, s43
s_add_u32 s29, s29, s39
M 184,112,88
s_cmp_eq_u32 s29, 147456
s_cselect_b32 s29, 0, s29
s_cmp_eq_u32 s30, 1280
M 188,112,92
s_cselect_b32 s30, 0, s30
s_cselect_b32 s31, 0, s31
s_cselect_b32 s38, 0, s38
M 192,112,96
s_cselect_b32 s43, 0, s43
s_cselect_b32 s39, 0, s39
s_cselect_b32 s29, 0x30000, s29
M 196,32,88
s_cselect_b32 s10, 0, s10
s_cselect_b32 s14, 0, s14
s_add_u32 s27, s27, 1
M 200,88,88
s_waitcnt lgkmcnt(0)
s_branch K1Lffn1
K1Effn1:
s_waitcnt lgkmcnt(0)
M 132,100,84
M 136,100,88
M 140,100,92
M 144,100,96
M 148,104,84
M 152,104,88
M 156,104,92
M 160,104,96
M 164,108,84
M 168,108,88
M 172,108,92
M 176,108,96
M 180,112,84
M 184,112,88
M 188,112,92
M 192,112,96
M 196,32,88
M 200,88,88
s_waitcnt vmcnt(0)
s_cmp_ge_u32 s42, 592
s_cbranch_scc1 RLO24
v_lshrrev_b32 v220, 2, v1
v_mul_u32_u24 v220, 160, v220
v_and_b32 v221, 3, v1
v_lshl_add_u32 v220, v221, 3, v220
v_add_u32 v220, 152576, v220
TR 224,220,0
TR 226,220,2560
TR 228,220,32
TR 230,220,2592
TR 232,220,64
TR 234,220,2624
TR 236,220,96
TR 238,220,2656
TR 240,220,128
TR 242,220,2688
s_sub_u32 s35, s42, 432
s_mov_b32 s33, 10485760
s_cmp_ge_u32 s42, 432
s_cselect_b32 s35, s35, s42
s_cselect_b32 s36, 20, 54
s_cselect_b32 s33, 13631488, s33
s_lshr_b32 s34, s35, 3
s_and_b32 s35, s35, 7
s_mul_i32 s35, s35, s36
s_add_u32 s35, s35, s34
s_mul_i32 s35, s35, 5120
s_add_u32 s33, s33, s35
s_add_u32 s34, s33, 4096
v_lshlrev_b32 v221, 4, v1
s_waitcnt lgkmcnt(0)
buffer_store_dwordx4 v[224:227], v221, s[16:19], s33 offen offset:0
buffer_store_dwordx4 v[228:231], v221, s[16:19], s33 offen offset:1024
buffer_store_dwordx4 v[232:235], v221, s[16:19], s33 offen offset:2048
buffer_store_dwordx4 v[236:239], v221, s[16:19], s33 offen offset:3072
buffer_store_dwordx4 v[240:243], v221, s[16:19], s34 offen
RLO24:
v_and_b32 v14, 15, v1
v_lshrrev_b32 v15, 4, v1
v_lshrrev_b32 v16, 2, v14
v_and_b32 v17, 3, v14
v_cmp_eq_u32 s[46:47], v16, v15
v_cmp_eq_u32 s[48:49], 1, v17
v_cmp_eq_u32 s[54:55], 2, v17
v_cmp_eq_u32 s[56:57], 3, v17
v_lshlrev_b32 v18, 2, v14
v_add_u32 v18, 98304, v18
s_mov_b32 s33, 0x3acccccd
s_mov_b32 s34, 0x3727c5ac
v_cndmask_b32 v200, v200, v201, s[48:49]
v_cndmask_b32 v200, v200, v202, s[54:55]
v_cndmask_b32 v200, v200, v203, s[56:57]
v_mul_f32 v196, s33, v196
v_mul_f32 v200, s33, v200
v_fma_f32 v200, -v196, v196, v200
v_max_f32 v200, 0, v200
v_add_f32 v200, s34, v200
v_rsq_f32 v200, v200
s_mov_b64 exec, s[46:47]
ds_write_b32 v18, v196 offset:128
ds_write_b32 v18, v200 offset:704
s_mov_b64 exec, -1
s_waitcnt lgkmcnt(0)
s_barrier
v_and_b32 v14, 15, v1
v_lshlrev_b32 v14, 2, v14
v_lshrrev_b32 v15, 4, v1
v_lshlrev_b32 v15, 4, v15
v_add_u32 v14, 98304, v14
v_add_u32 v15, 98304, v15
ds_read_b32 v36, v14 offset:64
ds_read_b32 v38, v14 offset:640
ds_read_b32 v42, v14 offset:128
ds_read_b32 v44, v14 offset:704
ds_read_b32 v48, v14 offset:192
ds_read_b32 v50, v14 offset:768
ds_read_b32 v54, v14 offset:256
ds_read_b32 v56, v14 offset:832
ds_read_b128 v[60:63], v15 offset:1408
ds_read_b128 v[64:67], v15 offset:1472
ds_read_b128 v[68:71], v15 offset:1536
ds_read_b128 v[72:75], v15 offset:1600
s_waitcnt lgkmcnt(0)
v_mov_b32 v16, 1.0
v_mov_b32 v17, 1.0
s_mov_b32 s33, 0xbfb8aa3b
v_mul_f32 v40, s33, v38
v_mul_f32 v46, s33, v44
v_mul_f32 v52, s33, v50
v_mul_f32 v58, s33, v56
PFN 132,36,60
PFN 134,36,62
PMB 18,40,132
PMB 20,40,134
v_exp_f32 v18, v18
v_exp_f32 v19, v19
v_exp_f32 v20, v20
v_exp_f32 v21, v21
PMB 132,38,132
PMB 134,38,134
PA 18,18,16
PA 20,20,16
v_rcp_f32 v18, v18
v_rcp_f32 v19, v19
v_rcp_f32 v20, v20
v_rcp_f32 v21, v21
s_nop 0
PM 132,132,18
PM 134,134,20
CV 132,132,133
CV 133,134,135
PFN 136,42,60
PFN 138,42,62
PMB 22,46,136
PMB 24,46,138
v_exp_f32 v22, v22
v_exp_f32 v23, v23
v_exp_f32 v24, v24
v_exp_f32 v25, v25
PMB 136,44,136
PMB 138,44,138
PA 22,22,16
PA 24,24,16
v_rcp_f32 v22, v22
v_rcp_f32 v23, v23
v_rcp_f32 v24, v24
v_rcp_f32 v25, v25
s_nop 0
PM 136,136,22
PM 138,138,24
CV 136,136,137
CV 137,138,139
PFN 140,48,60
PFN 142,48,62
PMB 18,52,140
PMB 20,52,142
v_exp_f32 v18, v18
v_exp_f32 v19, v19
v_exp_f32 v20, v20
v_exp_f32 v21, v21
PMB 140,50,140
PMB 142,50,142
PA 18,18,16
PA 20,20,16
v_rcp_f32 v18, v18
v_rcp_f32 v19, v19
v_rcp_f32 v20, v20
v_rcp_f32 v21, v21
s_nop 0
PM 140,140,18
PM 142,142,20
CV 140,140,141
CV 141,142,143
PFN 144,54,60
PFN 146,54,62
PMB 22,58,144
PMB 24,58,146
v_exp_f32 v22, v22
v_exp_f32 v23, v23
v_exp_f32 v24, v24
v_exp_f32 v25, v25
PMB 144,56,144
PMB 146,56,146
PA 22,22,16
PA 24,24,16
v_rcp_f32 v22, v22
v_rcp_f32 v23, v23
v_rcp_f32 v24, v24
v_rcp_f32 v25, v25
s_nop 0
PM 144,144,22
PM 146,146,24
CV 144,144,145
CV 145,146,147
PFN 148,36,64
PFN 150,36,66
PMB 18,40,148
PMB 20,40,150
v_exp_f32 v18, v18
v_exp_f32 v19, v19
v_exp_f32 v20, v20
v_exp_f32 v21, v21
PMB 148,38,148
PMB 150,38,150
PA 18,18,16
PA 20,20,16
v_rcp_f32 v18, v18
v_rcp_f32 v19, v19
v_rcp_f32 v20, v20
v_rcp_f32 v21, v21
s_nop 0
PM 148,148,18
PM 150,150,20
CV 148,148,149
CV 149,150,151
PFN 152,42,64
PFN 154,42,66
PMB 22,46,152
PMB 24,46,154
v_exp_f32 v22, v22
v_exp_f32 v23, v23
v_exp_f32 v24, v24
v_exp_f32 v25, v25
PMB 152,44,152
PMB 154,44,154
PA 22,22,16
PA 24,24,16
v_rcp_f32 v22, v22
v_rcp_f32 v23, v23
v_rcp_f32 v24, v24
v_rcp_f32 v25, v25
s_nop 0
PM 152,152,22
PM 154,154,24
CV 152,152,153
CV 153,154,155
PFN 156,48,64
PFN 158,48,66
PMB 18,52,156
PMB 20,52,158
v_exp_f32 v18, v18
v_exp_f32 v19, v19
v_exp_f32 v20, v20
v_exp_f32 v21, v21
PMB 156,50,156
PMB 158,50,158
PA 18,18,16
PA 20,20,16
v_rcp_f32 v18, v18
v_rcp_f32 v19, v19
v_rcp_f32 v20, v20
v_rcp_f32 v21, v21
s_nop 0
PM 156,156,18
PM 158,158,20
CV 156,156,157
CV 157,158,159
PFN 160,54,64
PFN 162,54,66
PMB 22,58,160
PMB 24,58,162
v_exp_f32 v22, v22
v_exp_f32 v23, v23
v_exp_f32 v24, v24
v_exp_f32 v25, v25
PMB 160,56,160
PMB 162,56,162
PA 22,22,16
PA 24,24,16
v_rcp_f32 v22, v22
v_rcp_f32 v23, v23
v_rcp_f32 v24, v24
v_rcp_f32 v25, v25
s_nop 0
PM 160,160,22
PM 162,162,24
CV 160,160,161
CV 161,162,163
PFN 164,36,68
PFN 166,36,70
PMB 18,40,164
PMB 20,40,166
v_exp_f32 v18, v18
v_exp_f32 v19, v19
v_exp_f32 v20, v20
v_exp_f32 v21, v21
PMB 164,38,164
PMB 166,38,166
PA 18,18,16
PA 20,20,16
v_rcp_f32 v18, v18
v_rcp_f32 v19, v19
v_rcp_f32 v20, v20
v_rcp_f32 v21, v21
s_nop 0
PM 164,164,18
PM 166,166,20
CV 164,164,165
CV 165,166,167
PFN 168,42,68
PFN 170,42,70
PMB 22,46,168
PMB 24,46,170
v_exp_f32 v22, v22
v_exp_f32 v23, v23
v_exp_f32 v24, v24
v_exp_f32 v25, v25
PMB 168,44,168
PMB 170,44,170
PA 22,22,16
PA 24,24,16
v_rcp_f32 v22, v22
v_rcp_f32 v23, v23
v_rcp_f32 v24, v24
v_rcp_f32 v25, v25
s_nop 0
PM 168,168,22
PM 170,170,24
CV 168,168,169
CV 169,170,171
PFN 172,48,68
PFN 174,48,70
PMB 18,52,172
PMB 20,52,174
v_exp_f32 v18, v18
v_exp_f32 v19, v19
v_exp_f32 v20, v20
v_exp_f32 v21, v21
PMB 172,50,172
PMB 174,50,174
PA 18,18,16
PA 20,20,16
v_rcp_f32 v18, v18
v_rcp_f32 v19, v19
v_rcp_f32 v20, v20
v_rcp_f32 v21, v21
s_nop 0
PM 172,172,18
PM 174,174,20
CV 172,172,173
CV 173,174,175
PFN 176,54,68
PFN 178,54,70
PMB 22,58,176
PMB 24,58,178
v_exp_f32 v22, v22
v_exp_f32 v23, v23
v_exp_f32 v24, v24
v_exp_f32 v25, v25
PMB 176,56,176
PMB 178,56,178
PA 22,22,16
PA 24,24,16
v_rcp_f32 v22, v22
v_rcp_f32 v23, v23
v_rcp_f32 v24, v24
v_rcp_f32 v25, v25
s_nop 0
PM 176,176,22
PM 178,178,24
CV 176,176,177
CV 177,178,179
PFN 180,36,72
PFN 182,36,74
PMB 18,40,180
PMB 20,40,182
v_exp_f32 v18, v18
v_exp_f32 v19, v19
v_exp_f32 v20, v20
v_exp_f32 v21, v21
PMB 180,38,180
PMB 182,38,182
PA 18,18,16
PA 20,20,16
v_rcp_f32 v18, v18
v_rcp_f32 v19, v19
v_rcp_f32 v20, v20
v_rcp_f32 v21, v21
s_nop 0
PM 180,180,18
PM 182,182,20
CV 180,180,181
CV 181,182,183
PFN 184,42,72
PFN 186,42,74
PMB 22,46,184
PMB 24,46,186
v_exp_f32 v22, v22
v_exp_f32 v23, v23
v_exp_f32 v24, v24
v_exp_f32 v25, v25
PMB 184,44,184
PMB 186,44,186
PA 22,22,16
PA 24,24,16
v_rcp_f32 v22, v22
v_rcp_f32 v23, v23
v_rcp_f32 v24, v24
v_rcp_f32 v25, v25
s_nop 0
PM 184,184,22
PM 186,186,24
CV 184,184,185
CV 185,186,187
PFN 188,48,72
PFN 190,48,74
PMB 18,52,188
PMB 20,52,190
v_exp_f32 v18, v18
v_exp_f32 v19, v19
v_exp_f32 v20, v20
v_exp_f32 v21, v21
PMB 188,50,188
PMB 190,50,190
PA 18,18,16
PA 20,20,16
v_rcp_f32 v18, v18
v_rcp_f32 v19, v19
v_rcp_f32 v20, v20
v_rcp_f32 v21, v21
s_nop 0
PM 188,188,18
PM 190,190,20
CV 188,188,189
CV 189,190,191
PFN 192,54,72
PFN 194,54,74
PMB 22,58,192
PMB 24,58,194
v_exp_f32 v22, v22
v_exp_f32 v23, v23
v_exp_f32 v24, v24
v_exp_f32 v25, v25
PMB 192,56,192
PMB 194,56,194
PA 22,22,16
PA 24,24,16
v_rcp_f32 v22, v22
v_rcp_f32 v23, v23
v_rcp_f32 v24, v24
v_rcp_f32 v25, v25
s_nop 0
PM 192,192,22
PM 194,194,24
CV 192,192,193
CV 193,194,195
s_mul_i32 s33, s24, 108
s_mul_i32 s34, s25, 7
s_add_u32 s33, s33, s34
s_lshl_b32 s33, s33, 12
v_lshlrev_b32 v14, 4, v1
s_add_u32 s34, s33, 8192
buffer_store_dwordx2 v[132:133], v14, s[16:19], s34 offen
s_add_u32 s34, s33, 9216
buffer_store_dwordx2 v[136:137], v14, s[16:19], s34 offen
s_add_u32 s34, s33, 10240
buffer_store_dwordx2 v[140:141], v14, s[16:19], s34 offen
s_add_u32 s34, s33, 11264
buffer_store_dwordx2 v[144:145], v14, s[16:19], s34 offen
s_add_u32 s34, s33, 8200
buffer_store_dwordx2 v[148:149], v14, s[16:19], s34 offen
s_add_u32 s34, s33, 9224
buffer_store_dwordx2 v[152:153], v14, s[16:19], s34 offen
s_add_u32 s34, s33, 10248
buffer_store_dwordx2 v[156:157], v14, s[16:19], s34 offen
s_add_u32 s34, s33, 11272
buffer_store_dwordx2 v[160:161], v14, s[16:19], s34 offen
s_add_u32 s34, s33, 12288
buffer_store_dwordx2 v[164:165], v14, s[16:19], s34 offen
s_add_u32 s34, s33, 13312
buffer_store_dwordx2 v[168:169], v14, s[16:19], s34 offen
s_add_u32 s34, s33, 14336
buffer_store_dwordx2 v[172:173], v14, s[16:19], s34 offen
s_add_u32 s34, s33, 15360
buffer_store_dwordx2 v[176:177], v14, s[16:19], s34 offen
s_add_u32 s34, s33, 12296
buffer_store_dwordx2 v[180:181], v14, s[16:19], s34 offen
s_add_u32 s34, s33, 13320
buffer_store_dwordx2 v[184:185], v14, s[16:19], s34 offen
s_add_u32 s34, s33, 14344
buffer_store_dwordx2 v[188:189], v14, s[16:19], s34 offen
s_add_u32 s34, s33, 15368
buffer_store_dwordx2 v[192:193], v14, s[16:19], s34 offen
s_endpgm
K1_FFN2:
v_lshrrev_b32 v14, 3, v1
v_and_b32 v15, 7, v1
v_xor_b32 v15, v15, v14
v_lshlrev_b32 v15, 4, v15
s_mov_b32 s30, 0
s_mov_b32 s31, 0
s_mov_b32 s29, 0
s_mov_b32 s28, 0
s_mov_b32 s43, 221184
s_mov_b32 s38, 128
s_mov_b32 s39, 49152
s_add_i32 s33, s32, 16
v_add_u32 v2, s33, v14
v_max_i32 v2, 0, v2
v_mul_u32_u24 v2, 1280, v2
v_add_u32 v2, v2, v15
s_waitcnt lgkmcnt(0)
s_mov_b32 s8, s4
s_mov_b32 s9, s5
s_mov_b32 s52, s62
s_mov_b32 s53, s63
s_mov_b32 s12, s60
s_mov_b32 s13, s61
s_add_u32 m0, s29, 2048
s_nop 0
buffer_load_dwordx4 v2, s[8:11], s30 offen lds
s_add_i32 s33, s32, 80
v_add_u32 v3, s33, v14
v_max_i32 v3, 0, v3
v_mul_u32_u24 v3, 1280, v3
v_add_u32 v3, v3, v15
s_add_u32 m0, s29, 10240
s_nop 0
buffer_load_dwordx4 v3, s[8:11], s30 offen lds
v_add_u32 v16, 0, v1
v_mul_u32_u24 v17, 2185, v16
v_lshrrev_b32 v17, 16, v17
v_mul_u32_u24 v18, 30, v17
v_sub_u32 v18, v16, v18
v_and_b32 v19, 0x33, v17
v_and_b32 v20, 4, v17
v_lshl_or_b32 v19, v20, 1, v19
v_bfe_u32 v20, v17, 3, 1
v_lshl_or_b32 v19, v20, 2, v19
v_lshlrev_b32 v18, 4, v18
v_mul_u32_u24 v4, 3456, v19
v_add3_u32 v4, v4, v18, s36
s_add_u32 m0, s29, 18432
s_nop 0
buffer_load_dwordx4 v4, s[12:15], s31 offen lds
v_add_u32 v16, 512, v1
v_mul_u32_u24 v17, 2185, v16
v_lshrrev_b32 v17, 16, v17
v_mul_u32_u24 v18, 30, v17
v_sub_u32 v18, v16, v18
v_and_b32 v19, 0x33, v17
v_and_b32 v20, 4, v17
v_lshl_or_b32 v19, v20, 1, v19
v_bfe_u32 v20, v17, 3, 1
v_lshl_or_b32 v19, v20, 2, v19
v_lshlrev_b32 v18, 4, v18
v_mul_u32_u24 v5, 3456, v19
v_add3_u32 v5, v5, v18, s36
s_add_u32 m0, s29, 26624
s_nop 0
buffer_load_dwordx4 v5, s[12:15], s31 offen lds
v_add_u32 v16, 1024, v1
v_mul_u32_u24 v17, 2185, v16
v_lshrrev_b32 v17, 16, v17
v_mul_u32_u24 v18, 30, v17
v_sub_u32 v18, v16, v18
v_and_b32 v19, 0x33, v17
v_and_b32 v20, 4, v17
v_lshl_or_b32 v19, v20, 1, v19
v_bfe_u32 v20, v17, 3, 1
v_lshl_or_b32 v19, v20, 2, v19
v_lshlrev_b32 v18, 4, v18
v_mul_u32_u24 v6, 3456, v19
v_add3_u32 v6, v6, v18, s36
s_add_u32 m0, s29, 34816
s_nop 0
buffer_load_dwordx4 v6, s[12:15], s31 offen lds
v_add_u32 v16, 1536, v1
v_mul_u32_u24 v17, 2185, v16
v_lshrrev_b32 v17, 16, v17
v_mul_u32_u24 v18, 30, v17
v_sub_u32 v18, v16, v18
v_and_b32 v19, 0x33, v17
v_and_b32 v20, 4, v17
v_lshl_or_b32 v19, v20, 1, v19
v_bfe_u32 v20, v17, 3, 1
v_lshl_or_b32 v19, v20, 2, v19
v_lshlrev_b32 v18, 4, v18
v_mul_u32_u24 v7, 3456, v19
v_add3_u32 v7, v7, v18, s36
s_add_u32 m0, s29, 43008
s_nop 0
buffer_load_dwordx4 v7, s[12:15], s31 offen lds
s_add_u32 s30, s30, s38
s_add_u32 s31, s31, s43
s_add_u32 s29, s29, s39
s_cmp_eq_u32 s29, 147456
s_cselect_b32 s29, 0, s29
s_cmp_eq_u32 s30, 1280
s_cselect_b32 s30, 0, s30
s_cselect_b32 s31, 0, s31
s_cselect_b32 s38, 0, s38
s_cselect_b32 s43, 0, s43
s_cselect_b32 s39, 0, s39
s_cselect_b32 s29, 0x30000, s29
s_cselect_b32 s10, 0, s10
s_cselect_b32 s14, 0, s14
s_add_u32 m0, s29, 2048
s_nop 0
buffer_load_dwordx4 v2, s[8:11], s30 offen lds
s_add_u32 m0, s29, 10240
s_nop 0
buffer_load_dwordx4 v3, s[8:11], s30 offen lds
s_add_u32 m0, s29, 18432
s_nop 0
buffer_load_dwordx4 v4, s[12:15], s31 offen lds
s_add_u32 m0, s29, 26624
s_nop 0
buffer_load_dwordx4 v5, s[12:15], s31 offen lds
s_add_u32 m0, s29, 34816
s_nop 0
buffer_load_dwordx4 v6, s[12:15], s31 offen lds
s_add_u32 m0, s29, 43008
s_nop 0
buffer_load_dwordx4 v7, s[12:15], s31 offen lds
s_add_u32 s30, s30, s38
s_add_u32 s31, s31, s43
s_add_u32 s29, s29, s39
s_cmp_eq_u32 s29, 147456
s_cselect_b32 s29, 0, s29
s_cmp_eq_u32 s30, 1280
s_cselect_b32 s30, 0, s30
s_cselect_b32 s31, 0, s31
s_cselect_b32 s38, 0, s38
s_cselect_b32 s43, 0, s43
s_cselect_b32 s39, 0, s39
s_cselect_b32 s29, 0x30000, s29
s_cselect_b32 s10, 0, s10
s_cselect_b32 s14, 0, s14
s_add_u32 s42, s37, 512
s_cmp_ge_u32 s42, 592
s_cbranch_scc1 RLS25
s_mov_b32 s22, 2211840
s_mov_b32 s23, 0x00020000
s_sub_u32 s35, s42, 432
s_cmp_ge_u32 s42, 432
s_cselect_b32 s20, s50, s52
s_cselect_b32 s21, s51, s53
s_cselect_b32 s22, 819200, s22
s_cselect_b32 s35, s35, s42
s_lshr_b32 s33, s35, 3
s_and_b32 s34, s35, 7
s_mul_i32 s33, s33, 40960
s_mul_i32 s34, s34, 160
s_add_u32 s33, s33, s34
v_add_u32 v16, 0, v1
v_mul_u32_u24 v17, 6554, v16
v_lshrrev_b32 v17, 16, v17
v_mul_u32_u24 v18, 10, v17
v_sub_u32 v18, v16, v18
v_lshlrev_b32 v18, 4, v18
v_mul_u32_u24 v17, 1280, v17
v_add_u32 v18, v18, v17
s_mov_b32 m0, 157696
s_nop 0
buffer_load_dwordx4 v18, s[20:23], s33 offen lds
v_add_u32 v16, 64, v1
v_mul_u32_u24 v17, 6554, v16
v_lshrrev_b32 v17, 16, v17
v_mul_u32_u24 v18, 10, v17
v_sub_u32 v18, v16, v18
v_lshlrev_b32 v18, 4, v18
v_mul_u32_u24 v17, 1280, v17
v_add_u32 v18, v18, v17
s_mov_b32 m0, 158720
s_nop 0
buffer_load_dwordx4 v18, s[20:23], s33 offen lds
v_add_u32 v16, 128, v1
v_mul_u32_u24 v17, 6554, v16
v_lshrrev_b32 v17, 16, v17
v_mul_u32_u24 v18, 10, v17
v_sub_u32 v18, v16, v18
v_lshlrev_b32 v18, 4, v18
v_mul_u32_u24 v17, 1280, v17
v_add_u32 v18, v18, v17
s_mov_b32 m0, 159744
s_nop 0
buffer_load_dwordx4 v18, s[20:23], s33 offen lds
v_add_u32 v16, 192, v1
v_mul_u32_u24 v17, 6554, v16
v_lshrrev_b32 v17, 16, v17
v_mul_u32_u24 v18, 10, v17
v_sub_u32 v18, v16, v18
v_lshlrev_b32 v18, 4, v18
v_mul_u32_u24 v17, 1280, v17
v_add_u32 v18, v18, v17
s_mov_b32 m0, 160768
s_nop 0
buffer_load_dwordx4 v18, s[20:23], s33 offen lds
v_add_u32 v16, 256, v1
v_mul_u32_u24 v17, 6554, v16
v_lshrrev_b32 v17, 16, v17
v_mul_u32_u24 v18, 10, v17
v_sub_u32 v18, v16, v18
v_lshlrev_b32 v18, 4, v18
v_mul_u32_u24 v17, 1280, v17
v_add_u32 v18, v18, v17
s_mov_b32 m0, 161792
s_nop 0
buffer_load_dwordx4 v18, s[20:23], s33 offen lds
RLS25:
v_and_b32 v14, 15, v1
v_lshrrev_b32 v15, 4, v1
v_and_b32 v16, 7, v14
v_xor_b32 v16, v16, v15
v_lshlrev_b32 v16, 4, v16
v_lshl_add_u32 v11, v14, 7, v16
v_xor_b32 v12, 64, v11
v_cmp_eq_u32 s[44:45], 0, v14
v_lshrrev_b32 v16, 1, v15
v_lshlrev_b32 v16, 4, v16
v_and_b32 v17, 1, v15
v_lshl_add_u32 v16, v17, 2, v16
v_bfe_u32 v17, v1, 2, 2
v_add_u32 v16, v16, v17
v_mul_u32_u24 v16, 480, v16
v_and_b32 v17, 3, v1
v_lshl_add_u32 v16, v17, 3, v16
v_add_u32 v13, 18432, v16
v_mov_b32 v132, 0
v_mov_b32 v133, 0
v_mov_b32 v134, 0
v_mov_b32 v135, 0
v_mov_b32 v136, 0
v_mov_b32 v137, 0
v_mov_b32 v138, 0
v_mov_b32 v139, 0
v_mov_b32 v140, 0
v_mov_b32 v141, 0
v_mov_b32 v142, 0
v_mov_b32 v143, 0
v_mov_b32 v144, 0
v_mov_b32 v145, 0
v_mov_b32 v146, 0
v_mov_b32 v147, 0
v_mov_b32 v148, 0
v_mov_b32 v149, 0
v_mov_b32 v150, 0
v_mov_b32 v151, 0
v_mov_b32 v152, 0
v_mov_b32 v153, 0
v_mov_b32 v154, 0
v_mov_b32 v155, 0
v_mov_b32 v156, 0
v_mov_b32 v157, 0
v_mov_b32 v158, 0
v_mov_b32 v159, 0
v_mov_b32 v160, 0
v_mov_b32 v161, 0
v_mov_b32 v162, 0
v_mov_b32 v163, 0
v_mov_b32 v164, 0
v_mov_b32 v165, 0
v_mov_b32 v166, 0
v_mov_b32 v167, 0
v_mov_b32 v168, 0
v_mov_b32 v169, 0
v_mov_b32 v170, 0
v_mov_b32 v171, 0
v_mov_b32 v172, 0
v_mov_b32 v173, 0
v_mov_b32 v174, 0
v_mov_b32 v175, 0
v_mov_b32 v176, 0
v_mov_b32 v177, 0
v_mov_b32 v178, 0
v_mov_b32 v179, 0
v_mov_b32 v180, 0
v_mov_b32 v181, 0
v_mov_b32 v182, 0
v_mov_b32 v183, 0
v_mov_b32 v184, 0
v_mov_b32 v185, 0
v_mov_b32 v186, 0
v_mov_b32 v187, 0
v_mov_b32 v188, 0
v_mov_b32 v189, 0
v_mov_b32 v190, 0
v_mov_b32 v191, 0
v_mov_b32 v192, 0
v_mov_b32 v193, 0
v_mov_b32 v194, 0
v_mov_b32 v195, 0
v_mov_b32 v196, 0
v_mov_b32 v197, 0
v_mov_b32 v198, 0
v_mov_b32 v199, 0
v_mov_b32 v200, 0
v_mov_b32 v201, 0
v_mov_b32 v202, 0
v_mov_b32 v203, 0
v_mov_b32 v32, 0x3f803f80
v_mov_b32 v33, 0x3f803f80
v_mov_b32 v34, 0x3f803f80
v_mov_b32 v35, 0x3f803f80
s_cmp_ge_u32 s42, 592
s_cbranch_scc1 FW26
s_waitcnt vmcnt(11)
s_branch FW27
FW26:
s_waitcnt vmcnt(6)
FW27:
s_barrier
v_add_u32 v8, s28, v11
v_add_u32 v9, s28, v12
v_add_u32 v10, s28, v13
RX 36,8,2048
RX 40,8,4096
RX 44,8,6144
RX 48,8,8192
TR 52,10,256
TR 54,10,4096
TR 56,10,288
TR 58,10,4128
TR 60,10,320
TR 62,10,4160
TR 64,10,0
TR 66,10,3840
s_add_u32 m0, s29, 2048
s_nop 0
buffer_load_dwordx4 v2, s[8:11], s30 offen lds
s_add_u32 m0, s29, 10240
s_nop 0
buffer_load_dwordx4 v3, s[8:11], s30 offen lds
s_add_u32 m0, s29, 18432
s_nop 0
buffer_load_dwordx4 v4, s[12:15], s31 offen lds
s_add_u32 m0, s29, 26624
s_nop 0
buffer_load_dwordx4 v5, s[12:15], s31 offen lds
s_add_u32 m0, s29, 34816
s_nop 0
buffer_load_dwordx4 v6, s[12:15], s31 offen lds
s_add_u32 m0, s29, 43008
s_nop 0
buffer_load_dwordx4 v7, s[12:15], s31 offen lds
s_add_u32 s30, s30, s38
s_add_u32 s31, s31, s43
s_add_u32 s29, s29, s39
s_cmp_eq_u32 s29, 147456
s_cselect_b32 s29, 0, s29
s_cmp_eq_u32 s30, 1280
s_cselect_b32 s30, 0, s30
s_cselect_b32 s31, 0, s31
s_cselect_b32 s38, 0, s38
s_cselect_b32 s43, 0, s43
s_cselect_b32 s39, 0, s39
s_cselect_b32 s29, 0x30000, s29
s_cselect_b32 s10, 0, s10
s_cselect_b32 s14, 0, s14
s_mov_b32 s27, 0
s_waitcnt lgkmcnt(0)
K1Lffn2:
M 132,52,36
RX 84,9,2048
M 136,52,40
RX 88,9,4096
M 140,52,44
RX 92,9,6144
M 144,52,48
RX 96,9,8192
M 148,56,36
TR 100,10,15616
M 152,56,40
TR 102,10,19456
M 156,56,44
TR 104,10,15648
M 160,56,48
TR 106,10,19488
M 164,60,36
TR 108,10,15680
M 168,60,40
TR 110,10,19520
M 172,60,44
TR 112,10,15360
M 176,60,48
TR 114,10,19200
M 180,52,32
M 184,56,32
s_add_u32 s28, s28, 49152
s_cmp_eq_u32 s28, 147456
s_cselect_b32 s28, 0, s28
M 188,60,32
v_add_u32 v8, s28, v11
v_add_u32 v9, s28, v12
v_add_u32 v10, s28, v13
M 192,64,32
s_cmp_eq_u32 s27, 9
M 196,32,44
M 200,44,44
s_cbranch_scc1 K1Effn2
s_waitcnt vmcnt(6) lgkmcnt(0)
s_barrier
M 132,100,84
s_add_u32 m0, s29, 2048
RX 36,8,2048
buffer_load_dwordx4 v2, s[8:11], s30 offen lds
M 136,100,88
s_add_u32 m0, s29, 10240
RX 40,8,4096
buffer_load_dwordx4 v3, s[8:11], s30 offen lds
M 140,100,92
s_add_u32 m0, s29, 18432
RX 44,8,6144
buffer_load_dwordx4 v4, s[12:15], s31 offen lds
M 144,100,96
s_add_u32 m0, s29, 26624
RX 48,8,8192
buffer_load_dwordx4 v5, s[12:15], s31 offen lds
M 148,104,84
s_add_u32 m0, s29, 34816
TR 52,10,256
buffer_load_dwordx4 v6, s[12:15], s31 offen lds
M 152,104,88
s_add_u32 m0, s29, 43008
TR 54,10,4096
buffer_load_dwordx4 v7, s[12:15], s31 offen lds
M 156,104,92
TR 56,10,288
M 160,104,96
TR 58,10,4128
M 164,108,84
TR 60,10,320
M 168,108,88
TR 62,10,4160
M 172,108,92
TR 64,10,0
M 176,108,96
TR 66,10,3840
M 180,100,32
s_add_u32 s30, s30, s38
s_add_u32 s31, s31, s43
s_add_u32 s29, s29, s39
M 184,104,32
s_cmp_eq_u32 s29, 147456
s_cselect_b32 s29, 0, s29
s_cmp_eq_u32 s30, 1280
M 188,108,32
s_cselect_b32 s30, 0, s30
s_cselect_b32 s31, 0, s31
s_cselect_b32 s38, 0, s38
M 192,112,32
s_cselect_b32 s43, 0, s43
s_cselect_b32 s39, 0, s39
s_cselect_b32 s29, 0x30000, s29
M 196,32,92
s_cselect_b32 s10, 0, s10
s_cselect_b32 s14, 0, s14
s_add_u32 s27, s27, 1
M 200,92,92
s_waitcnt lgkmcnt(0)
s_branch K1Lffn2
K1Effn2:
s_waitcnt lgkmcnt(0)
M 132,100,84
M 136,100,88
M 140,100,92
M 144,100,96
M 148,104,84
M 152,104,88
M 156,104,92
M 160,104,96
M 164,108,84
M 168,108,88
M 172,108,92
M 176,108,96
M 180,100,32
M 184,104,32
M 188,108,32
M 192,112,32
M 196,32,92
M 200,92,92
s_waitcnt vmcnt(0)
s_cmp_ge_u32 s42, 592
s_cbranch_scc1 RLO28
v_lshrrev_b32 v220, 2, v1
v_mul_u32_u24 v220, 160, v220
v_and_b32 v221, 3, v1
v_lshl_add_u32 v220, v221, 3, v220
v_add_u32 v220, 157696, v220
TR 224,220,0
TR 226,220,2560
TR 228,220,32
TR 230,220,2592
TR 232,220,64
TR 234,220,2624
TR 236,220,96
TR 238,220,2656
TR 240,220,128
TR 242,220,2688
s_sub_u32 s35, s42, 432
s_mov_b32 s33, 10485760
s_cmp_ge_u32 s42, 432
s_cselect_b32 s35, s35, s42
s_cselect_b32 s36, 20, 54
s_cselect_b32 s33, 13631488, s33
s_lshr_b32 s34, s35, 3
s_and_b32 s35, s35, 7
s_mul_i32 s35, s35, s36
s_add_u32 s35, s35, s34
s_mul_i32 s35, s35, 5120
s_add_u32 s33, s33, s35
s_add_u32 s34, s33, 4096
v_lshlrev_b32 v221, 4, v1
s_waitcnt lgkmcnt(0)
buffer_store_dwordx4 v[224:227], v221, s[16:19], s33 offen offset:0
buffer_store_dwordx4 v[228:231], v221, s[16:19], s33 offen offset:1024
buffer_store_dwordx4 v[232:235], v221, s[16:19], s33 offen offset:2048
buffer_store_dwordx4 v[236:239], v221, s[16:19], s33 offen offset:3072
buffer_store_dwordx4 v[240:243], v221, s[16:19], s34 offen
RLO28:
v_and_b32 v14, 15, v1
v_lshrrev_b32 v15, 4, v1
v_lshrrev_b32 v16, 2, v14
v_and_b32 v17, 3, v14
v_cmp_eq_u32 s[46:47], v16, v15
v_cmp_eq_u32 s[48:49], 1, v17
v_cmp_eq_u32 s[54:55], 2, v17
v_cmp_eq_u32 s[56:57], 3, v17
v_lshlrev_b32 v18, 2, v14
v_add_u32 v18, 98304, v18
s_mov_b32 s33, 0x3acccccd
s_mov_b32 s34, 0x3727c5ac
v_cndmask_b32 v200, v200, v201, s[48:49]
v_cndmask_b32 v200, v200, v202, s[54:55]
v_cndmask_b32 v200, v200, v203, s[56:57]
v_mul_f32 v196, s33, v196
v_mul_f32 v200, s33, v200
v_fma_f32 v200, -v196, v196, v200
v_max_f32 v200, 0, v200
v_add_f32 v200, s34, v200
v_rsq_f32 v200, v200
s_mov_b64 exec, s[46:47]
ds_write_b32 v18, v196 offset:192
ds_write_b32 v18, v200 offset:768
s_mov_b64 exec, -1
v_add_u32 v19, 98304, v1
s_mov_b64 exec, s[44:45]
ds_write_b128 v19, v[180:183] offset:1664
ds_write_b128 v19, v[184:187] offset:1728
ds_write_b128 v19, v[188:191] offset:1792
ds_write_b128 v19, v[192:195] offset:1152
s_mov_b64 exec, -1
s_waitcnt lgkmcnt(0)
s_barrier
v_and_b32 v14, 15, v1
v_lshlrev_b32 v14, 2, v14
v_lshrrev_b32 v15, 4, v1
v_lshlrev_b32 v15, 4, v15
v_add_u32 v14, 98304, v14
v_add_u32 v15, 98304, v15
ds_read_b32 v36, v14 offset:64
ds_read_b32 v38, v14 offset:640
ds_read_b32 v42, v14 offset:128
ds_read_b32 v44, v14 offset:704
ds_read_b32 v48, v14 offset:192
ds_read_b32 v50, v14 offset:768
ds_read_b32 v54, v14 offset:256
ds_read_b32 v56, v14 offset:832
ds_read_b128 v[60:63], v15 offset:1664
ds_read_b128 v[64:67], v15 offset:1728
ds_read_b128 v[68:71], v15 offset:1792
s_waitcnt lgkmcnt(0)
v_mov_b32 v16, 1.0
v_mov_b32 v17, 1.0
s_mov_b32 s33, 0xbfb8aa3b
v_mul_f32 v40, s33, v38
v_mul_f32 v46, s33, v44
v_mul_f32 v52, s33, v50
v_mul_f32 v58, s33, v56
PFN 132,36,60
PFN 134,36,62
PMB 18,40,132
PMB 20,40,134
v_exp_f32 v18, v18
v_exp_f32 v19, v19
v_exp_f32 v20, v20
v_exp_f32 v21, v21
PMB 132,38,132
PMB 134,38,134
PA 18,18,16
PA 20,20,16
v_rcp_f32 v18, v18
v_rcp_f32 v19, v19
v_rcp_f32 v20, v20
v_rcp_f32 v21, v21
s_nop 0
PM 132,132,18
PM 134,134,20
CV 132,132,133
CV 133,134,135
PFN 136,42,60
PFN 138,42,62
PMB 22,46,136
PMB 24,46,138
v_exp_f32 v22, v22
v_exp_f32 v23, v23
v_exp_f32 v24, v24
v_exp_f32 v25, v25
PMB 136,44,136
PMB 138,44,138
PA 22,22,16
PA 24,24,16
v_rcp_f32 v22, v22
v_rcp_f32 v23, v23
v_rcp_f32 v24, v24
v_rcp_f32 v25, v25
s_nop 0
PM 136,136,22
PM 138,138,24
CV 136,136,137
CV 137,138,139
PFN 140,48,60
PFN 142,48,62
PMB 18,52,140
PMB 20,52,142
v_exp_f32 v18, v18
v_exp_f32 v19, v19
v_exp_f32 v20, v20
v_exp_f32 v21, v21
PMB 140,50,140
PMB 142,50,142
PA 18,18,16
PA 20,20,16
v_rcp_f32 v18, v18
v_rcp_f32 v19, v19
v_rcp_f32 v20, v20
v_rcp_f32 v21, v21
s_nop 0
PM 140,140,18
PM 142,142,20
CV 140,140,141
CV 141,142,143
PFN 144,54,60
PFN 146,54,62
PMB 22,58,144
PMB 24,58,146
v_exp_f32 v22, v22
v_exp_f32 v23, v23
v_exp_f32 v24, v24
v_exp_f32 v25, v25
PMB 144,56,144
PMB 146,56,146
PA 22,22,16
PA 24,24,16
v_rcp_f32 v22, v22
v_rcp_f32 v23, v23
v_rcp_f32 v24, v24
v_rcp_f32 v25, v25
s_nop 0
PM 144,144,22
PM 146,146,24
CV 144,144,145
CV 145,146,147
PFN 148,36,64
PFN 150,36,66
PMB 18,40,148
PMB 20,40,150
v_exp_f32 v18, v18
v_exp_f32 v19, v19
v_exp_f32 v20, v20
v_exp_f32 v21, v21
PMB 148,38,148
PMB 150,38,150
PA 18,18,16
PA 20,20,16
v_rcp_f32 v18, v18
v_rcp_f32 v19, v19
v_rcp_f32 v20, v20
v_rcp_f32 v21, v21
s_nop 0
PM 148,148,18
PM 150,150,20
CV 148,148,149
CV 149,150,151
PFN 152,42,64
PFN 154,42,66
PMB 22,46,152
PMB 24,46,154
v_exp_f32 v22, v22
v_exp_f32 v23, v23
v_exp_f32 v24, v24
v_exp_f32 v25, v25
PMB 152,44,152
PMB 154,44,154
PA 22,22,16
PA 24,24,16
v_rcp_f32 v22, v22
v_rcp_f32 v23, v23
v_rcp_f32 v24, v24
v_rcp_f32 v25, v25
s_nop 0
PM 152,152,22
PM 154,154,24
CV 152,152,153
CV 153,154,155
PFN 156,48,64
PFN 158,48,66
PMB 18,52,156
PMB 20,52,158
v_exp_f32 v18, v18
v_exp_f32 v19, v19
v_exp_f32 v20, v20
v_exp_f32 v21, v21
PMB 156,50,156
PMB 158,50,158
PA 18,18,16
PA 20,20,16
v_rcp_f32 v18, v18
v_rcp_f32 v19, v19
v_rcp_f32 v20, v20
v_rcp_f32 v21, v21
s_nop 0
PM 156,156,18
PM 158,158,20
CV 156,156,157
CV 157,158,159
PFN 160,54,64
PFN 162,54,66
PMB 22,58,160
PMB 24,58,162
v_exp_f32 v22, v22
v_exp_f32 v23, v23
v_exp_f32 v24, v24
v_exp_f32 v25, v25
PMB 160,56,160
PMB 162,56,162
PA 22,22,16
PA 24,24,16
v_rcp_f32 v22, v22
v_rcp_f32 v23, v23
v_rcp_f32 v24, v24
v_rcp_f32 v25, v25
s_nop 0
PM 160,160,22
PM 162,162,24
CV 160,160,161
CV 161,162,163
PFN 164,36,68
PFN 166,36,70
PMB 18,40,164
PMB 20,40,166
v_exp_f32 v18, v18
v_exp_f32 v19, v19
v_exp_f32 v20, v20
v_exp_f32 v21, v21
PMB 164,38,164
PMB 166,38,166
PA 18,18,16
PA 20,20,16
v_rcp_f32 v18, v18
v_rcp_f32 v19, v19
v_rcp_f32 v20, v20
v_rcp_f32 v21, v21
s_nop 0
PM 164,164,18
PM 166,166,20
CV 164,164,165
CV 165,166,167
PFN 168,42,68
PFN 170,42,70
PMB 22,46,168
PMB 24,46,170
v_exp_f32 v22, v22
v_exp_f32 v23, v23
v_exp_f32 v24, v24
v_exp_f32 v25, v25
PMB 168,44,168
PMB 170,44,170
PA 22,22,16
PA 24,24,16
v_rcp_f32 v22, v22
v_rcp_f32 v23, v23
v_rcp_f32 v24, v24
v_rcp_f32 v25, v25
s_nop 0
PM 168,168,22
PM 170,170,24
CV 168,168,169
CV 169,170,171
PFN 172,48,68
PFN 174,48,70
PMB 18,52,172
PMB 20,52,174
v_exp_f32 v18, v18
v_exp_f32 v19, v19
v_exp_f32 v20, v20
v_exp_f32 v21, v21
PMB 172,50,172
PMB 174,50,174
PA 18,18,16
PA 20,20,16
v_rcp_f32 v18, v18
v_rcp_f32 v19, v19
v_rcp_f32 v20, v20
v_rcp_f32 v21, v21
s_nop 0
PM 172,172,18
PM 174,174,20
CV 172,172,173
CV 173,174,175
PFN 176,54,68
PFN 178,54,70
PMB 22,58,176
PMB 24,58,178
v_exp_f32 v22, v22
v_exp_f32 v23, v23
v_exp_f32 v24, v24
v_exp_f32 v25, v25
PMB 176,56,176
PMB 178,56,178
PA 22,22,16
PA 24,24,16
v_rcp_f32 v22, v22
v_rcp_f32 v23, v23
v_rcp_f32 v24, v24
v_rcp_f32 v25, v25
s_nop 0
PM 176,176,22
PM 178,178,24
CV 176,176,177
CV 177,178,179
s_mul_i32 s33, s24, 108
s_mul_i32 s34, s25, 7
s_add_u32 s33, s33, s34
s_lshl_b32 s33, s33, 12
v_lshlrev_b32 v14, 4, v1
s_add_u32 s34, s33, 16384
buffer_store_dwordx2 v[132:133], v14, s[16:19], s34 offen
s_add_u32 s34, s33, 17408
buffer_store_dwordx2 v[136:137], v14, s[16:19], s34 offen
s_add_u32 s34, s33, 18432
buffer_store_dwordx2 v[140:141], v14, s[16:19], s34 offen
s_add_u32 s34, s33, 19456
buffer_store_dwordx2 v[144:145], v14, s[16:19], s34 offen
s_add_u32 s34, s33, 16392
buffer_store_dwordx2 v[148:149], v14, s[16:19], s34 offen
s_add_u32 s34, s33, 17416
buffer_store_dwordx2 v[152:153], v14, s[16:19], s34 offen
s_add_u32 s34, s33, 18440
buffer_store_dwordx2 v[156:157], v14, s[16:19], s34 offen
s_add_u32 s34, s33, 19464
buffer_store_dwordx2 v[160:161], v14, s[16:19], s34 offen
s_cmp_eq_u32 s25, 7
s_cbranch_scc1 SK29
s_add_u32 s34, s33, 20480
buffer_store_dwordx2 v[164:165], v14, s[16:19], s34 offen
s_add_u32 s34, s33, 21504
buffer_store_dwordx2 v[168:169], v14, s[16:19], s34 offen
s_add_u32 s34, s33, 22528
buffer_store_dwordx2 v[172:173], v14, s[16:19], s34 offen
s_add_u32 s34, s33, 23552
buffer_store_dwordx2 v[176:177], v14, s[16:19], s34 offen
SK29:
s_endpgm
K1_FFN3:
v_lshrrev_b32 v14, 3, v1
v_and_b32 v15, 7, v1
v_xor_b32 v15, v15, v14
v_lshlrev_b32 v15, 4, v15
s_mov_b32 s30, 0
s_mov_b32 s31, 0
s_mov_b32 s29, 0
s_mov_b32 s28, 0
s_mov_b32 s43, 221184
s_mov_b32 s38, 128
s_mov_b32 s39, 49152
s_add_i32 s33, s32, 24
v_add_u32 v2, s33, v14
v_max_i32 v2, 0, v2
v_mul_u32_u24 v2, 1280, v2
v_add_u32 v2, v2, v15
s_waitcnt lgkmcnt(0)
s_mov_b32 s8, s4
s_mov_b32 s9, s5
s_mov_b32 s52, s62
s_mov_b32 s53, s63
s_mov_b32 s12, s60
s_mov_b32 s13, s61
s_add_u32 m0, s29, 3072
s_nop 0
buffer_load_dwordx4 v2, s[8:11], s30 offen lds
s_add_i32 s33, s32, 88
v_add_u32 v3, s33, v14
v_max_i32 v3, 0, v3
v_mul_u32_u24 v3, 1280, v3
v_add_u32 v3, v3, v15
s_add_u32 m0, s29, 11264
s_nop 0
buffer_load_dwordx4 v3, s[8:11], s30 offen lds
v_add_u32 v16, 64, v1
v_mul_u32_u24 v17, 2185, v16
v_lshrrev_b32 v17, 16, v17
v_mul_u32_u24 v18, 30, v17
v_sub_u32 v18, v16, v18
v_and_b32 v19, 0x33, v17
v_and_b32 v20, 4, v17
v_lshl_or_b32 v19, v20, 1, v19
v_bfe_u32 v20, v17, 3, 1
v_lshl_or_b32 v19, v20, 2, v19
v_lshlrev_b32 v18, 4, v18
v_mul_u32_u24 v4, 3456, v19
v_add3_u32 v4, v4, v18, s36
s_add_u32 m0, s29, 19456
s_nop 0
buffer_load_dwordx4 v4, s[12:15], s31 offen lds
v_add_u32 v16, 576, v1
v_mul_u32_u24 v17, 2185, v16
v_lshrrev_b32 v17, 16, v17
v_mul_u32_u24 v18, 30, v17
v_sub_u32 v18, v16, v18
v_and_b32 v19, 0x33, v17
v_and_b32 v20, 4, v17
v_lshl_or_b32 v19, v20, 1, v19
v_bfe_u32 v20, v17, 3, 1
v_lshl_or_b32 v19, v20, 2, v19
v_lshlrev_b32 v18, 4, v18
v_mul_u32_u24 v5, 3456, v19
v_add3_u32 v5, v5, v18, s36
s_add_u32 m0, s29, 27648
s_nop 0
buffer_load_dwordx4 v5, s[12:15], s31 offen lds
v_add_u32 v16, 1088, v1
v_mul_u32_u24 v17, 2185, v16
v_lshrrev_b32 v17, 16, v17
v_mul_u32_u24 v18, 30, v17
v_sub_u32 v18, v16, v18
v_and_b32 v19, 0x33, v17
v_and_b32 v20, 4, v17
v_lshl_or_b32 v19, v20, 1, v19
v_bfe_u32 v20, v17, 3, 1
v_lshl_or_b32 v19, v20, 2, v19
v_lshlrev_b32 v18, 4, v18
v_mul_u32_u24 v6, 3456, v19
v_add3_u32 v6, v6, v18, s36
s_add_u32 m0, s29, 35840
s_nop 0
buffer_load_dwordx4 v6, s[12:15], s31 offen lds
v_add_u32 v16, 1600, v1
v_mul_u32_u24 v17, 2185, v16
v_lshrrev_b32 v17, 16, v17
v_mul_u32_u24 v18, 30, v17
v_sub_u32 v18, v16, v18
v_and_b32 v19, 0x33, v17
v_and_b32 v20, 4, v17
v_lshl_or_b32 v19, v20, 1, v19
v_bfe_u32 v20, v17, 3, 1
v_lshl_or_b32 v19, v20, 2, v19
v_lshlrev_b32 v18, 4, v18
v_mul_u32_u24 v7, 3456, v19
v_add3_u32 v7, v7, v18, s36
s_add_u32 m0, s29, 44032
s_nop 0
buffer_load_dwordx4 v7, s[12:15], s31 offen lds
s_add_u32 s30, s30, s38
s_add_u32 s31, s31, s43
s_add_u32 s29, s29, s39
s_cmp_eq_u32 s29, 147456
s_cselect_b32 s29, 0, s29
s_cmp_eq_u32 s30, 1280
s_cselect_b32 s30, 0, s30
s_cselect_b32 s31, 0, s31
s_cselect_b32 s38, 0, s38
s_cselect_b32 s43, 0, s43
s_cselect_b32 s39, 0, s39
s_cselect_b32 s29, 0x30000, s29
s_cselect_b32 s10, 0, s10
s_cselect_b32 s14, 0, s14
s_add_u32 m0, s29, 3072
s_nop 0
buffer_load_dwordx4 v2, s[8:11], s30 offen lds
s_add_u32 m0, s29, 11264
s_nop 0
buffer_load_dwordx4 v3, s[8:11], s30 offen lds
s_add_u32 m0, s29, 19456
s_nop 0
buffer_load_dwordx4 v4, s[12:15], s31 offen lds
s_add_u32 m0, s29, 27648
s_nop 0
buffer_load_dwordx4 v5, s[12:15], s31 offen lds
s_add_u32 m0, s29, 35840
s_nop 0
buffer_load_dwordx4 v6, s[12:15], s31 offen lds
s_add_u32 m0, s29, 44032
s_nop 0
buffer_load_dwordx4 v7, s[12:15], s31 offen lds
s_add_u32 s30, s30, s38
s_add_u32 s31, s31, s43
s_add_u32 s29, s29, s39
s_cmp_eq_u32 s29, 147456
s_cselect_b32 s29, 0, s29
s_cmp_eq_u32 s30, 1280
s_cselect_b32 s30, 0, s30
s_cselect_b32 s31, 0, s31
s_cselect_b32 s38, 0, s38
s_cselect_b32 s43, 0, s43
s_cselect_b32 s39, 0, s39
s_cselect_b32 s29, 0x30000, s29
s_cselect_b32 s10, 0, s10
s_cselect_b32 s14, 0, s14
v_and_b32 v14, 15, v1
v_lshrrev_b32 v15, 4, v1
v_and_b32 v16, 7, v14
v_xor_b32 v16, v16, v15
v_lshlrev_b32 v16, 4, v16
v_lshl_add_u32 v11, v14, 7, v16
v_xor_b32 v12, 64, v11
v_cmp_eq_u32 s[44:45], 0, v14
v_lshrrev_b32 v16, 1, v15
v_lshlrev_b32 v16, 4, v16
v_and_b32 v17, 1, v15
v_lshl_add_u32 v16, v17, 2, v16
v_bfe_u32 v17, v1, 2, 2
v_add_u32 v16, v16, v17
v_mul_u32_u24 v16, 480, v16
v_and_b32 v17, 3, v1
v_lshl_add_u32 v16, v17, 3, v16
v_add_u32 v13, 18432, v16
v_mov_b32 v132, 0
v_mov_b32 v133, 0
v_mov_b32 v134, 0
v_mov_b32 v135, 0
v_mov_b32 v136, 0
v_mov_b32 v137, 0
v_mov_b32 v138, 0
v_mov_b32 v139, 0
v_mov_b32 v140, 0
v_mov_b32 v141, 0
v_mov_b32 v142, 0
v_mov_b32 v143, 0
v_mov_b32 v144, 0
v_mov_b32 v145, 0
v_mov_b32 v146, 0
v_mov_b32 v147, 0
v_mov_b32 v148, 0
v_mov_b32 v149, 0
v_mov_b32 v150, 0
v_mov_b32 v151, 0
v_mov_b32 v152, 0
v_mov_b32 v153, 0
v_mov_b32 v154, 0
v_mov_b32 v155, 0
v_mov_b32 v156, 0
v_mov_b32 v157, 0
v_mov_b32 v158, 0
v_mov_b32 v159, 0
v_mov_b32 v160, 0
v_mov_b32 v161, 0
v_mov_b32 v162, 0
v_mov_b32 v163, 0
v_mov_b32 v164, 0
v_mov_b32 v165, 0
v_mov_b32 v166, 0
v_mov_b32 v167, 0
v_mov_b32 v168, 0
v_mov_b32 v169, 0
v_mov_b32 v170, 0
v_mov_b32 v171, 0
v_mov_b32 v172, 0
v_mov_b32 v173, 0
v_mov_b32 v174, 0
v_mov_b32 v175, 0
v_mov_b32 v176, 0
v_mov_b32 v177, 0
v_mov_b32 v178, 0
v_mov_b32 v179, 0
v_mov_b32 v180, 0
v_mov_b32 v181, 0
v_mov_b32 v182, 0
v_mov_b32 v183, 0
v_mov_b32 v184, 0
v_mov_b32 v185, 0
v_mov_b32 v186, 0
v_mov_b32 v187, 0
v_mov_b32 v188, 0
v_mov_b32 v189, 0
v_mov_b32 v190, 0
v_mov_b32 v191, 0
v_mov_b32 v192, 0
v_mov_b32 v193, 0
v_mov_b32 v194, 0
v_mov_b32 v195, 0
v_mov_b32 v196, 0
v_mov_b32 v197, 0
v_mov_b32 v198, 0
v_mov_b32 v199, 0
v_mov_b32 v200, 0
v_mov_b32 v201, 0
v_mov_b32 v202, 0
v_mov_b32 v203, 0
v_mov_b32 v32, 0x3f803f80
v_mov_b32 v33, 0x3f803f80
v_mov_b32 v34, 0x3f803f80
v_mov_b32 v35, 0x3f803f80
s_waitcnt vmcnt(6)
s_barrier
v_add_u32 v8, s28, v11
v_add_u32 v9, s28, v12
v_add_u32 v10, s28, v13
RX 36,8,2048
RX 40,8,4096
RX 44,8,6144
RX 48,8,8192
TR 52,10,352
TR 54,10,4192
TR 56,10,384
TR 58,10,4224
TR 60,10,416
TR 62,10,4256
TR 64,10,128
TR 66,10,3968
s_add_u32 m0, s29, 3072
s_nop 0
buffer_load_dwordx4 v2, s[8:11], s30 offen lds
s_add_u32 m0, s29, 11264
s_nop 0
buffer_load_dwordx4 v3, s[8:11], s30 offen lds
s_add_u32 m0, s29, 19456
s_nop 0
buffer_load_dwordx4 v4, s[12:15], s31 offen lds
s_add_u32 m0, s29, 27648
s_nop 0
buffer_load_dwordx4 v5, s[12:15], s31 offen lds
s_add_u32 m0, s29, 35840
s_nop 0
buffer_load_dwordx4 v6, s[12:15], s31 offen lds
s_add_u32 m0, s29, 44032
s_nop 0
buffer_load_dwordx4 v7, s[12:15], s31 offen lds
s_add_u32 s30, s30, s38
s_add_u32 s31, s31, s43
s_add_u32 s29, s29, s39
s_cmp_eq_u32 s29, 147456
s_cselect_b32 s29, 0, s29
s_cmp_eq_u32 s30, 1280
s_cselect_b32 s30, 0, s30
s_cselect_b32 s31, 0, s31
s_cselect_b32 s38, 0, s38
s_cselect_b32 s43, 0, s43
s_cselect_b32 s39, 0, s39
s_cselect_b32 s29, 0x30000, s29
s_cselect_b32 s10, 0, s10
s_cselect_b32 s14, 0, s14
s_mov_b32 s27, 0
s_waitcnt lgkmcnt(0)
K1Lffn3:
M 132,52,36
RX 84,9,2048
M 136,52,40
RX 88,9,4096
M 140,52,44
RX 92,9,6144
M 144,52,48
RX 96,9,8192
M 148,56,36
TR 100,10,15712
M 152,56,40
TR 102,10,19552
M 156,56,44
TR 104,10,15744
M 160,56,48
TR 106,10,19584
M 164,60,36
TR 108,10,15776
M 168,60,40
TR 110,10,19616
M 172,60,44
TR 112,10,15488
M 176,60,48
TR 114,10,19328
M 180,52,32
M 184,56,32
s_add_u32 s28, s28, 49152
s_cmp_eq_u32 s28, 147456
s_cselect_b32 s28, 0, s28
M 188,60,32
v_add_u32 v8, s28, v11
v_add_u32 v9, s28, v12
v_add_u32 v10, s28, v13
M 192,64,32
s_cmp_eq_u32 s27, 9
M 196,32,48
M 200,48,48
s_cbranch_scc1 K1Effn3
s_waitcnt vmcnt(6) lgkmcnt(0)
s_barrier
M 132,100,84
s_add_u32 m0, s29, 3072
RX 36,8,2048
buffer_load_dwordx4 v2, s[8:11], s30 offen lds
M 136,100,88
s_add_u32 m0, s29, 11264
RX 40,8,4096
buffer_load_dwordx4 v3, s[8:11], s30 offen lds
M 140,100,92
s_add_u32 m0, s29, 19456
RX 44,8,6144
buffer_load_dwordx4 v4, s[12:15], s31 offen lds
M 144,100,96
s_add_u32 m0, s29, 27648
RX 48,8,8192
buffer_load_dwordx4 v5, s[12:15], s31 offen lds
M 148,104,84
s_add_u32 m0, s29, 35840
TR 52,10,352
buffer_load_dwordx4 v6, s[12:15], s31 offen lds
M 152,104,88
s_add_u32 m0, s29, 44032
TR 54,10,4192
buffer_load_dwordx4 v7, s[12:15], s31 offen lds
M 156,104,92
TR 56,10,384
M 160,104,96
TR 58,10,4224
M 164,108,84
TR 60,10,416
M 168,108,88
TR 62,10,4256
M 172,108,92
TR 64,10,128
M 176,108,96
TR 66,10,3968
M 180,100,32
s_add_u32 s30, s30, s38
s_add_u32 s31, s31, s43
s_add_u32 s29, s29, s39
M 184,104,32
s_cmp_eq_u32 s29, 147456
s_cselect_b32 s29, 0, s29
s_cmp_eq_u32 s30, 1280
M 188,108,32
s_cselect_b32 s30, 0, s30
s_cselect_b32 s31, 0, s31
s_cselect_b32 s38, 0, s38
M 192,112,32
s_cselect_b32 s43, 0, s43
s_cselect_b32 s39, 0, s39
s_cselect_b32 s29, 0x30000, s29
M 196,32,96
s_cselect_b32 s10, 0, s10
s_cselect_b32 s14, 0, s14
s_add_u32 s27, s27, 1
M 200,96,96
s_waitcnt lgkmcnt(0)
s_branch K1Lffn3
K1Effn3:
s_waitcnt lgkmcnt(0)
M 132,100,84
M 136,100,88
M 140,100,92
M 144,100,96
M 148,104,84
M 152,104,88
M 156,104,92
M 160,104,96
M 164,108,84
M 168,108,88
M 172,108,92
M 176,108,96
M 180,100,32
M 184,104,32
M 188,108,32
M 192,112,32
M 196,32,96
M 200,96,96
s_waitcnt vmcnt(0)
s_nop 7
s_nop 3
v_and_b32 v14, 15, v1
v_lshrrev_b32 v15, 4, v1
v_lshrrev_b32 v16, 2, v14
v_and_b32 v17, 3, v14
v_cmp_eq_u32 s[46:47], v16, v15
v_cmp_eq_u32 s[48:49], 1, v17
v_cmp_eq_u32 s[54:55], 2, v17
v_cmp_eq_u32 s[56:57], 3, v17
v_lshlrev_b32 v18, 2, v14
v_add_u32 v18, 98304, v18
s_mov_b32 s33, 0x3acccccd
s_mov_b32 s34, 0x3727c5ac
v_cndmask_b32 v200, v200, v201, s[48:49]
v_cndmask_b32 v200, v200, v202, s[54:55]
v_cndmask_b32 v200, v200, v203, s[56:57]
v_mul_f32 v196, s33, v196
v_mul_f32 v200, s33, v200
v_fma_f32 v200, -v196, v196, v200
v_max_f32 v200, 0, v200
v_add_f32 v200, s34, v200
v_rsq_f32 v200, v200
s_mov_b64 exec, s[46:47]
ds_write_b32 v18, v196 offset:256
ds_write_b32 v18, v200 offset:832
s_mov_b64 exec, -1
v_add_u32 v19, 98304, v1
s_mov_b64 exec, s[44:45]
ds_write_b128 v19, v[180:183] offset:1856
ds_write_b128 v19, v[184:187] offset:1920
ds_write_b128 v19, v[188:191] offset:1984
ds_write_b128 v19, v[192:195] offset:1408
s_mov_b64 exec, -1
s_waitcnt lgkmcnt(0)
s_barrier
v_and_b32 v14, 15, v1
v_lshlrev_b32 v14, 2, v14
v_lshrrev_b32 v15, 4, v1
v_lshlrev_b32 v15, 4, v15
v_add_u32 v14, 98304, v14
v_add_u32 v15, 98304, v15
ds_read_b32 v36, v14 offset:64
ds_read_b32 v38, v14 offset:640
ds_read_b32 v42, v14 offset:128
ds_read_b32 v44, v14 offset:704
ds_read_b32 v48, v14 offset:192
ds_read_b32 v50, v14 offset:768
ds_read_b32 v54, v14 offset:256
ds_read_b32 v56, v14 offset:832
ds_read_b128 v[60:63], v15 offset:1856
ds_read_b128 v[64:67], v15 offset:1920
ds_read_b128 v[68:71], v15 offset:1984
s_waitcnt lgkmcnt(0)
v_mov_b32 v16, 1.0
v_mov_b32 v17, 1.0
s_mov_b32 s33, 0xbfb8aa3b
v_mul_f32 v40, s33, v38
v_mul_f32 v46, s33, v44
v_mul_f32 v52, s33, v50
v_mul_f32 v58, s33, v56
PFN 132,36,60
PFN 134,36,62
PMB 18,40,132
PMB 20,40,134
v_exp_f32 v18, v18
v_exp_f32 v19, v19
v_exp_f32 v20, v20
v_exp_f32 v21, v21
PMB 132,38,132
PMB 134,38,134
PA 18,18,16
PA 20,20,16
v_rcp_f32 v18, v18
v_rcp_f32 v19, v19
v_rcp_f32 v20, v20
v_rcp_f32 v21, v21
s_nop 0
PM 132,132,18
PM 134,134,20
CV 132,132,133
CV 133,134,135
PFN 136,42,60
PFN 138,42,62
PMB 22,46,136
PMB 24,46,138
v_exp_f32 v22, v22
v_exp_f32 v23, v23
v_exp_f32 v24, v24
v_exp_f32 v25, v25
PMB 136,44,136
PMB 138,44,138
PA 22,22,16
PA 24,24,16
v_rcp_f32 v22, v22
v_rcp_f32 v23, v23
v_rcp_f32 v24, v24
v_rcp_f32 v25, v25
s_nop 0
PM 136,136,22
PM 138,138,24
CV 136,136,137
CV 137,138,139
PFN 140,48,60
PFN 142,48,62
PMB 18,52,140
PMB 20,52,142
v_exp_f32 v18, v18
v_exp_f32 v19, v19
v_exp_f32 v20, v20
v_exp_f32 v21, v21
PMB 140,50,140
PMB 142,50,142
PA 18,18,16
PA 20,20,16
v_rcp_f32 v18, v18
v_rcp_f32 v19, v19
v_rcp_f32 v20, v20
v_rcp_f32 v21, v21
s_nop 0
PM 140,140,18
PM 142,142,20
CV 140,140,141
CV 141,142,143
PFN 144,54,60
PFN 146,54,62
PMB 22,58,144
PMB 24,58,146
v_exp_f32 v22, v22
v_exp_f32 v23, v23
v_exp_f32 v24, v24
v_exp_f32 v25, v25
PMB 144,56,144
PMB 146,56,146
PA 22,22,16
PA 24,24,16
v_rcp_f32 v22, v22
v_rcp_f32 v23, v23
v_rcp_f32 v24, v24
v_rcp_f32 v25, v25
s_nop 0
PM 144,144,22
PM 146,146,24
CV 144,144,145
CV 145,146,147
PFN 148,36,64
PFN 150,36,66
PMB 18,40,148
PMB 20,40,150
v_exp_f32 v18, v18
v_exp_f32 v19, v19
v_exp_f32 v20, v20
v_exp_f32 v21, v21
PMB 148,38,148
PMB 150,38,150
PA 18,18,16
PA 20,20,16
v_rcp_f32 v18, v18
v_rcp_f32 v19, v19
v_rcp_f32 v20, v20
v_rcp_f32 v21, v21
s_nop 0
PM 148,148,18
PM 150,150,20
CV 148,148,149
CV 149,150,151
PFN 152,42,64
PFN 154,42,66
PMB 22,46,152
PMB 24,46,154
v_exp_f32 v22, v22
v_exp_f32 v23, v23
v_exp_f32 v24, v24
v_exp_f32 v25, v25
PMB 152,44,152
PMB 154,44,154
PA 22,22,16
PA 24,24,16
v_rcp_f32 v22, v22
v_rcp_f32 v23, v23
v_rcp_f32 v24, v24
v_rcp_f32 v25, v25
s_nop 0
PM 152,152,22
PM 154,154,24
CV 152,152,153
CV 153,154,155
PFN 156,48,64
PFN 158,48,66
PMB 18,52,156
PMB 20,52,158
v_exp_f32 v18, v18
v_exp_f32 v19, v19
v_exp_f32 v20, v20
v_exp_f32 v21, v21
PMB 156,50,156
PMB 158,50,158
PA 18,18,16
PA 20,20,16
v_rcp_f32 v18, v18
v_rcp_f32 v19, v19
v_rcp_f32 v20, v20
v_rcp_f32 v21, v21
s_nop 0
PM 156,156,18
PM 158,158,20
CV 156,156,157
CV 157,158,159
PFN 160,54,64
PFN 162,54,66
PMB 22,58,160
PMB 24,58,162
v_exp_f32 v22, v22
v_exp_f32 v23, v23
v_exp_f32 v24, v24
v_exp_f32 v25, v25
PMB 160,56,160
PMB 162,56,162
PA 22,22,16
PA 24,24,16
v_rcp_f32 v22, v22
v_rcp_f32 v23, v23
v_rcp_f32 v24, v24
v_rcp_f32 v25, v25
s_nop 0
PM 160,160,22
PM 162,162,24
CV 160,160,161
CV 161,162,163
PFN 164,36,68
PFN 166,36,70
PMB 18,40,164
PMB 20,40,166
v_exp_f32 v18, v18
v_exp_f32 v19, v19
v_exp_f32 v20, v20
v_exp_f32 v21, v21
PMB 164,38,164
PMB 166,38,166
PA 18,18,16
PA 20,20,16
v_rcp_f32 v18, v18
v_rcp_f32 v19, v19
v_rcp_f32 v20, v20
v_rcp_f32 v21, v21
s_nop 0
PM 164,164,18
PM 166,166,20
CV 164,164,165
CV 165,166,167
PFN 168,42,68
PFN 170,42,70
PMB 22,46,168
PMB 24,46,170
v_exp_f32 v22, v22
v_exp_f32 v23, v23
v_exp_f32 v24, v24
v_exp_f32 v25, v25
PMB 168,44,168
PMB 170,44,170
PA 22,22,16
PA 24,24,16
v_rcp_f32 v22, v22
v_rcp_f32 v23, v23
v_rcp_f32 v24, v24
v_rcp_f32 v25, v25
s_nop 0
PM 168,168,22
PM 170,170,24
CV 168,168,169
CV 169,170,171
PFN 172,48,68
PFN 174,48,70
PMB 18,52,172
PMB 20,52,174
v_exp_f32 v18, v18
v_exp_f32 v19, v19
v_exp_f32 v20, v20
v_exp_f32 v21, v21
PMB 172,50,172
PMB 174,50,174
PA 18,18,16
PA 20,20,16
v_rcp_f32 v18, v18
v_rcp_f32 v19, v19
v_rcp_f32 v20, v20
v_rcp_f32 v21, v21
s_nop 0
PM 172,172,18
PM 174,174,20
CV 172,172,173
CV 173,174,175
PFN 176,54,68
PFN 178,54,70
PMB 22,58,176
PMB 24,58,178
v_exp_f32 v22, v22
v_exp_f32 v23, v23
v_exp_f32 v24, v24
v_exp_f32 v25, v25
PMB 176,56,176
PMB 178,56,178
PA 22,22,16
PA 24,24,16
v_rcp_f32 v22, v22
v_rcp_f32 v23, v23
v_rcp_f32 v24, v24
v_rcp_f32 v25, v25
s_nop 0
PM 176,176,22
PM 178,178,24
CV 176,176,177
CV 177,178,179
s_mul_i32 s33, s24, 108
s_mul_i32 s34, s25, 7
s_add_u32 s33, s33, s34
s_lshl_b32 s33, s33, 12
v_lshlrev_b32 v14, 4, v1
s_cmp_eq_u32 s25, 7
s_cbranch_scc1 SK30
s_add_u32 s34, s33, 20488
buffer_store_dwordx2 v[132:133], v14, s[16:19], s34 offen
s_add_u32 s34, s33, 21512
buffer_store_dwordx2 v[136:137], v14, s[16:19], s34 offen
s_add_u32 s34, s33, 22536
buffer_store_dwordx2 v[140:141], v14, s[16:19], s34 offen
s_add_u32 s34, s33, 23560
buffer_store_dwordx2 v[144:145], v14, s[16:19], s34 offen
s_add_u32 s34, s33, 24576
buffer_store_dwordx2 v[148:149], v14, s[16:19], s34 offen
s_add_u32 s34, s33, 25600
buffer_store_dwordx2 v[152:153], v14, s[16:19], s34 offen
s_add_u32 s34, s33, 26624
buffer_store_dwordx2 v[156:157], v14, s[16:19], s34 offen
s_add_u32 s34, s33, 27648
buffer_store_dwordx2 v[160:161], v14, s[16:19], s34 offen
s_add_u32 s34, s33, 24584
buffer_store_dwordx2 v[164:165], v14, s[16:19], s34 offen
s_add_u32 s34, s33, 25608
buffer_store_dwordx2 v[168:169], v14, s[16:19], s34 offen
s_add_u32 s34, s33, 26632
buffer_store_dwordx2 v[172:173], v14, s[16:19], s34 offen
s_add_u32 s34, s33, 27656
buffer_store_dwordx2 v[176:177], v14, s[16:19], s34 offen
SK30:
s_endpgm
K1_FFN4:
v_lshrrev_b32 v14, 3, v1
v_and_b32 v15, 7, v1
v_xor_b32 v15, v15, v14
v_lshlrev_b32 v15, 4, v15
s_mov_b32 s30, 0
s_mov_b32 s31, 0
s_mov_b32 s29, 0
s_mov_b32 s28, 0
s_mov_b32 s43, 221184
s_mov_b32 s38, 128
s_mov_b32 s39, 49152
s_add_i32 s33, s32, 32
v_add_u32 v2, s33, v14
v_max_i32 v2, 0, v2
v_mul_u32_u24 v2, 1280, v2
v_add_u32 v2, v2, v15
s_waitcnt lgkmcnt(0)
s_mov_b32 s8, s4
s_mov_b32 s9, s5
s_mov_b32 s52, s62
s_mov_b32 s53, s63
s_mov_b32 s12, s60
s_mov_b32 s13, s61
s_add_u32 m0, s29, 4096
s_nop 0
buffer_load_dwordx4 v2, s[8:11], s30 offen lds
s_add_i32 s33, s32, 96
v_add_u32 v3, s33, v14
v_max_i32 v3, 0, v3
v_mul_u32_u24 v3, 1280, v3
v_add_u32 v3, v3, v15
s_add_u32 m0, s29, 12288
s_nop 0
buffer_load_dwordx4 v3, s[8:11], s30 offen lds
v_add_u32 v16, 128, v1
v_mul_u32_u24 v17, 2185, v16
v_lshrrev_b32 v17, 16, v17
v_mul_u32_u24 v18, 30, v17
v_sub_u32 v18, v16, v18
v_and_b32 v19, 0x33, v17
v_and_b32 v20, 4, v17
v_lshl_or_b32 v19, v20, 1, v19
v_bfe_u32 v20, v17, 3, 1
v_lshl_or_b32 v19, v20, 2, v19
v_lshlrev_b32 v18, 4, v18
v_mul_u32_u24 v4, 3456, v19
v_add3_u32 v4, v4, v18, s36
s_add_u32 m0, s29, 20480
s_nop 0
buffer_load_dwordx4 v4, s[12:15], s31 offen lds
v_add_u32 v16, 640, v1
v_mul_u32_u24 v17, 2185, v16
v_lshrrev_b32 v17, 16, v17
v_mul_u32_u24 v18, 30, v17
v_sub_u32 v18, v16, v18
v_and_b32 v19, 0x33, v17
v_and_b32 v20, 4, v17
v_lshl_or_b32 v19, v20, 1, v19
v_bfe_u32 v20, v17, 3, 1
v_lshl_or_b32 v19, v20, 2, v19
v_lshlrev_b32 v18, 4, v18
v_mul_u32_u24 v5, 3456, v19
v_add3_u32 v5, v5, v18, s36
s_add_u32 m0, s29, 28672
s_nop 0
buffer_load_dwordx4 v5, s[12:15], s31 offen lds
v_add_u32 v16, 1152, v1
v_mul_u32_u24 v17, 2185, v16
v_lshrrev_b32 v17, 16, v17
v_mul_u32_u24 v18, 30, v17
v_sub_u32 v18, v16, v18
v_and_b32 v19, 0x33, v17
v_and_b32 v20, 4, v17
v_lshl_or_b32 v19, v20, 1, v19
v_bfe_u32 v20, v17, 3, 1
v_lshl_or_b32 v19, v20, 2, v19
v_lshlrev_b32 v18, 4, v18
v_mul_u32_u24 v6, 3456, v19
v_add3_u32 v6, v6, v18, s36
s_add_u32 m0, s29, 36864
s_nop 0
buffer_load_dwordx4 v6, s[12:15], s31 offen lds
v_add_u32 v16, 1664, v1
v_mul_u32_u24 v17, 2185, v16
v_lshrrev_b32 v17, 16, v17
v_mul_u32_u24 v18, 30, v17
v_sub_u32 v18, v16, v18
v_and_b32 v19, 0x33, v17
v_and_b32 v20, 4, v17
v_lshl_or_b32 v19, v20, 1, v19
v_bfe_u32 v20, v17, 3, 1
v_lshl_or_b32 v19, v20, 2, v19
v_lshlrev_b32 v18, 4, v18
v_mul_u32_u24 v7, 3456, v19
v_add3_u32 v7, v7, v18, s36
s_add_u32 m0, s29, 45056
s_nop 0
buffer_load_dwordx4 v7, s[12:15], s31 offen lds
s_add_u32 s30, s30, s38
s_add_u32 s31, s31, s43
s_add_u32 s29, s29, s39
s_cmp_eq_u32 s29, 147456
s_cselect_b32 s29, 0, s29
s_cmp_eq_u32 s30, 1280
s_cselect_b32 s30, 0, s30
s_cselect_b32 s31, 0, s31
s_cselect_b32 s38, 0, s38
s_cselect_b32 s43, 0, s43
s_cselect_b32 s39, 0, s39
s_cselect_b32 s29, 0x30000, s29
s_cselect_b32 s10, 0, s10
s_cselect_b32 s14, 0, s14
s_add_u32 m0, s29, 4096
s_nop 0
buffer_load_dwordx4 v2, s[8:11], s30 offen lds
s_add_u32 m0, s29, 12288
s_nop 0
buffer_load_dwordx4 v3, s[8:11], s30 offen lds
s_add_u32 m0, s29, 20480
s_nop 0
buffer_load_dwordx4 v4, s[12:15], s31 offen lds
s_add_u32 m0, s29, 28672
s_nop 0
buffer_load_dwordx4 v5, s[12:15], s31 offen lds
s_add_u32 m0, s29, 36864
s_nop 0
buffer_load_dwordx4 v6, s[12:15], s31 offen lds
s_add_u32 m0, s29, 45056
s_nop 0
buffer_load_dwordx4 v7, s[12:15], s31 offen lds
s_add_u32 s30, s30, s38
s_add_u32 s31, s31, s43
s_add_u32 s29, s29, s39
s_cmp_eq_u32 s29, 147456
s_cselect_b32 s29, 0, s29
s_cmp_eq_u32 s30, 1280
s_cselect_b32 s30, 0, s30
s_cselect_b32 s31, 0, s31
s_cselect_b32 s38, 0, s38
s_cselect_b32 s43, 0, s43
s_cselect_b32 s39, 0, s39
s_cselect_b32 s29, 0x30000, s29
s_cselect_b32 s10, 0, s10
s_cselect_b32 s14, 0, s14
v_and_b32 v14, 15, v1
v_lshrrev_b32 v15, 4, v1
v_and_b32 v16, 7, v14
v_xor_b32 v16, v16, v15
v_lshlrev_b32 v16, 4, v16
v_lshl_add_u32 v11, v14, 7, v16
v_xor_b32 v12, 64, v11
v_cmp_eq_u32 s[44:45], 0, v14
v_lshrrev_b32 v16, 1, v15
v_lshlrev_b32 v16, 4, v16
v_and_b32 v17, 1, v15
v_lshl_add_u32 v16, v17, 2, v16
v_bfe_u32 v17, v1, 2, 2
v_add_u32 v16, v16, v17
v_mul_u32_u24 v16, 480, v16
v_and_b32 v17, 3, v1
v_lshl_add_u32 v16, v17, 3, v16
v_add_u32 v13, 18432, v16
v_mov_b32 v132, 0
v_mov_b32 v133, 0
v_mov_b32 v134, 0
v_mov_b32 v135, 0
v_mov_b32 v136, 0
v_mov_b32 v137, 0
v_mov_b32 v138, 0
v_mov_b32 v139, 0
v_mov_b32 v140, 0
v_mov_b32 v141, 0
v_mov_b32 v142, 0
v_mov_b32 v143, 0
v_mov_b32 v144, 0
v_mov_b32 v145, 0
v_mov_b32 v146, 0
v_mov_b32 v147, 0
v_mov_b32 v148, 0
v_mov_b32 v149, 0
v_mov_b32 v150, 0
v_mov_b32 v151, 0
v_mov_b32 v152, 0
v_mov_b32 v153, 0
v_mov_b32 v154, 0
v_mov_b32 v155, 0
v_mov_b32 v156, 0
v_mov_b32 v157, 0
v_mov_b32 v158, 0
v_mov_b32 v159, 0
v_mov_b32 v160, 0
v_mov_b32 v161, 0
v_mov_b32 v162, 0
v_mov_b32 v163, 0
v_mov_b32 v164, 0
v_mov_b32 v165, 0
v_mov_b32 v166, 0
v_mov_b32 v167, 0
v_mov_b32 v168, 0
v_mov_b32 v169, 0
v_mov_b32 v170, 0
v_mov_b32 v171, 0
v_mov_b32 v172, 0
v_mov_b32 v173, 0
v_mov_b32 v174, 0
v_mov_b32 v175, 0
v_mov_b32 v176, 0
v_mov_b32 v177, 0
v_mov_b32 v178, 0
v_mov_b32 v179, 0
v_mov_b32 v180, 0
v_mov_b32 v181, 0
v_mov_b32 v182, 0
v_mov_b32 v183, 0
v_mov_b32 v184, 0
v_mov_b32 v185, 0
v_mov_b32 v186, 0
v_mov_b32 v187, 0
v_mov_b32 v188, 0
v_mov_b32 v189, 0
v_mov_b32 v190, 0
v_mov_b32 v191, 0
v_mov_b32 v192, 0
v_mov_b32 v193, 0
v_mov_b32 v194, 0
v_mov_b32 v195, 0
v_mov_b32 v196, 0
v_mov_b32 v197, 0
v_mov_b32 v198, 0
v_mov_b32 v199, 0
v_mov_b32 v200, 0
v_mov_b32 v201, 0
v_mov_b32 v202, 0
v_mov_b32 v203, 0
v_mov_b32 v32, 0x3f803f80
v_mov_b32 v33, 0x3f803f80
v_mov_b32 v34, 0x3f803f80
v_mov_b32 v35, 0x3f803f80
s_waitcnt vmcnt(6)
s_barrier
v_add_u32 v8, s28, v11
v_add_u32 v9, s28, v12
v_add_u32 v10, s28, v13
RX 36,8,10240
RX 40,8,12288
RX 44,8,14336
RX 48,8,16384
TR 52,10,0
TR 54,10,3840
TR 56,10,32
TR 58,10,3872
TR 60,10,64
TR 62,10,3904
TR 64,10,96
TR 66,10,3936
s_add_u32 m0, s29, 4096
s_nop 0
buffer_load_dwordx4 v2, s[8:11], s30 offen lds
s_add_u32 m0, s29, 12288
s_nop 0
buffer_load_dwordx4 v3, s[8:11], s30 offen lds
s_add_u32 m0, s29, 20480
s_nop 0
buffer_load_dwordx4 v4, s[12:15], s31 offen lds
s_add_u32 m0, s29, 28672
s_nop 0
buffer_load_dwordx4 v5, s[12:15], s31 offen lds
s_add_u32 m0, s29, 36864
s_nop 0
buffer_load_dwordx4 v6, s[12:15], s31 offen lds
s_add_u32 m0, s29, 45056
s_nop 0
buffer_load_dwordx4 v7, s[12:15], s31 offen lds
s_add_u32 s30, s30, s38
s_add_u32 s31, s31, s43
s_add_u32 s29, s29, s39
s_cmp_eq_u32 s29, 147456
s_cselect_b32 s29, 0, s29
s_cmp_eq_u32 s30, 1280
s_cselect_b32 s30, 0, s30
s_cselect_b32 s31, 0, s31
s_cselect_b32 s38, 0, s38
s_cselect_b32 s43, 0, s43
s_cselect_b32 s39, 0, s39
s_cselect_b32 s29, 0x30000, s29
s_cselect_b32 s10, 0, s10
s_cselect_b32 s14, 0, s14
s_mov_b32 s27, 0
s_waitcnt lgkmcnt(0)
K1Lffn4:
M 132,52,36
RX 84,9,10240
M 136,52,40
RX 88,9,12288
M 140,52,44
RX 92,9,14336
M 144,52,48
RX 96,9,16384
M 148,56,36
TR 100,10,15360
M 152,56,40
TR 102,10,19200
M 156,56,44
TR 104,10,15392
M 160,56,48
TR 106,10,19232
M 164,60,36
TR 108,10,15424
M 168,60,40
TR 110,10,19264
M 172,60,44
TR 112,10,15456
M 176,60,48
TR 114,10,19296
M 180,64,36
M 184,64,40
s_add_u32 s28, s28, 49152
s_cmp_eq_u32 s28, 147456
s_cselect_b32 s28, 0, s28
M 188,64,44
v_add_u32 v8, s28, v11
v_add_u32 v9, s28, v12
v_add_u32 v10, s28, v13
M 192,64,48
s_cmp_eq_u32 s27, 9
M 196,32,36
M 200,36,36
s_cbranch_scc1 K1Effn4
s_waitcnt vmcnt(6) lgkmcnt(0)
s_barrier
M 132,100,84
s_add_u32 m0, s29, 4096
RX 36,8,10240
buffer_load_dwordx4 v2, s[8:11], s30 offen lds
M 136,100,88
s_add_u32 m0, s29, 12288
RX 40,8,12288
buffer_load_dwordx4 v3, s[8:11], s30 offen lds
M 140,100,92
s_add_u32 m0, s29, 20480
RX 44,8,14336
buffer_load_dwordx4 v4, s[12:15], s31 offen lds
M 144,100,96
s_add_u32 m0, s29, 28672
RX 48,8,16384
buffer_load_dwordx4 v5, s[12:15], s31 offen lds
M 148,104,84
s_add_u32 m0, s29, 36864
TR 52,10,0
buffer_load_dwordx4 v6, s[12:15], s31 offen lds
M 152,104,88
s_add_u32 m0, s29, 45056
TR 54,10,3840
buffer_load_dwordx4 v7, s[12:15], s31 offen lds
M 156,104,92
TR 56,10,32
M 160,104,96
TR 58,10,3872
M 164,108,84
TR 60,10,64
M 168,108,88
TR 62,10,3904
M 172,108,92
TR 64,10,96
M 176,108,96
TR 66,10,3936
M 180,112,84
s_add_u32 s30, s30, s38
s_add_u32 s31, s31, s43
s_add_u32 s29, s29, s39
M 184,112,88
s_cmp_eq_u32 s29, 147456
s_cselect_b32 s29, 0, s29
s_cmp_eq_u32 s30, 1280
M 188,112,92
s_cselect_b32 s30, 0, s30
s_cselect_b32 s31, 0, s31
s_cselect_b32 s38, 0, s38
M 192,112,96
s_cselect_b32 s43, 0, s43
s_cselect_b32 s39, 0, s39
s_cselect_b32 s29, 0x30000, s29
M 196,32,84
s_cselect_b32 s10, 0, s10
s_cselect_b32 s14, 0, s14
s_add_u32 s27, s27, 1
M 200,84,84
s_waitcnt lgkmcnt(0)
s_branch K1Lffn4
K1Effn4:
s_waitcnt lgkmcnt(0)
M 132,100,84
M 136,100,88
M 140,100,92
M 144,100,96
M 148,104,84
M 152,104,88
M 156,104,92
M 160,104,96
M 164,108,84
M 168,108,88
M 172,108,92
M 176,108,96
M 180,112,84
M 184,112,88
M 188,112,92
M 192,112,96
M 196,32,84
M 200,84,84
s_waitcnt vmcnt(0)
s_nop 7
s_nop 3
v_and_b32 v14, 15, v1
v_lshrrev_b32 v15, 4, v1
v_lshrrev_b32 v16, 2, v14
v_and_b32 v17, 3, v14
v_cmp_eq_u32 s[46:47], v16, v15
v_cmp_eq_u32 s[48:49], 1, v17
v_cmp_eq_u32 s[54:55], 2, v17
v_cmp_eq_u32 s[56:57], 3, v17
v_lshlrev_b32 v18, 2, v14
v_add_u32 v18, 98304, v18
s_mov_b32 s33, 0x3acccccd
s_mov_b32 s34, 0x3727c5ac
v_cndmask_b32 v200, v200, v201, s[48:49]
v_cndmask_b32 v200, v200, v202, s[54:55]
v_cndmask_b32 v200, v200, v203, s[56:57]
v_mul_f32 v196, s33, v196
v_mul_f32 v200, s33, v200
v_fma_f32 v200, -v196, v196, v200
v_max_f32 v200, 0, v200
v_add_f32 v200, s34, v200
v_rsq_f32 v200, v200
s_mov_b64 exec, s[46:47]
ds_write_b32 v18, v196 offset:320
ds_write_b32 v18, v200 offset:896
s_mov_b64 exec, -1
s_waitcnt lgkmcnt(0)
s_barrier
v_and_b32 v14, 15, v1
v_lshlrev_b32 v14, 2, v14
v_lshrrev_b32 v15, 4, v1
v_lshlrev_b32 v15, 4, v15
v_add_u32 v14, 98304, v14
v_add_u32 v15, 98304, v15
ds_read_b32 v36, v14 offset:320
ds_read_b32 v38, v14 offset:896
ds_read_b32 v42, v14 offset:384
ds_read_b32 v44, v14 offset:960
ds_read_b32 v48, v14 offset:448
ds_read_b32 v50, v14 offset:1024
ds_read_b32 v54, v14 offset:512
ds_read_b32 v56, v14 offset:1088
ds_read_b128 v[60:63], v15 offset:1152
ds_read_b128 v[64:67], v15 offset:1216
ds_read_b128 v[68:71], v15 offset:1280
ds_read_b128 v[72:75], v15 offset:1344
s_waitcnt lgkmcnt(0)
v_mov_b32 v16, 1.0
v_mov_b32 v17, 1.0
s_mov_b32 s33, 0xbfb8aa3b
v_mul_f32 v40, s33, v38
v_mul_f32 v46, s33, v44
v_mul_f32 v52, s33, v50
v_mul_f32 v58, s33, v56
PFN 132,36,60
PFN 134,36,62
PMB 18,40,132
PMB 20,40,134
v_exp_f32 v18, v18
v_exp_f32 v19, v19
v_exp_f32 v20, v20
v_exp_f32 v21, v21
PMB 132,38,132
PMB 134,38,134
PA 18,18,16
PA 20,20,16
v_rcp_f32 v18, v18
v_rcp_f32 v19, v19
v_rcp_f32 v20, v20
v_rcp_f32 v21, v21
s_nop 0
PM 132,132,18
PM 134,134,20
CV 132,132,133
CV 133,134,135
PFN 136,42,60
PFN 138,42,62
PMB 22,46,136
PMB 24,46,138
v_exp_f32 v22, v22
v_exp_f32 v23, v23
v_exp_f32 v24, v24
v_exp_f32 v25, v25
PMB 136,44,136
PMB 138,44,138
PA 22,22,16
PA 24,24,16
v_rcp_f32 v22, v22
v_rcp_f32 v23, v23
v_rcp_f32 v24, v24
v_rcp_f32 v25, v25
s_nop 0
PM 136,136,22
PM 138,138,24
CV 136,136,137
CV 137,138,139
PFN 140,48,60
PFN 142,48,62
PMB 18,52,140
PMB 20,52,142
v_exp_f32 v18, v18
v_exp_f32 v19, v19
v_exp_f32 v20, v20
v_exp_f32 v21, v21
PMB 140,50,140
PMB 142,50,142
PA 18,18,16
PA 20,20,16
v_rcp_f32 v18, v18
v_rcp_f32 v19, v19
v_rcp_f32 v20, v20
v_rcp_f32 v21, v21
s_nop 0
PM 140,140,18
PM 142,142,20
CV 140,140,141
CV 141,142,143
PFN 144,54,60
PFN 146,54,62
PMB 22,58,144
PMB 24,58,146
v_exp_f32 v22, v22
v_exp_f32 v23, v23
v_exp_f32 v24, v24
v_exp_f32 v25, v25
PMB 144,56,144
PMB 146,56,146
PA 22,22,16
PA 24,24,16
v_rcp_f32 v22, v22
v_rcp_f32 v23, v23
v_rcp_f32 v24, v24
v_rcp_f32 v25, v25
s_nop 0
PM 144,144,22
PM 146,146,24
CV 144,144,145
CV 145,146,147
PFN 148,36,64
PFN 150,36,66
PMB 18,40,148
PMB 20,40,150
v_exp_f32 v18, v18
v_exp_f32 v19, v19
v_exp_f32 v20, v20
v_exp_f32 v21, v21
PMB 148,38,148
PMB 150,38,150
PA 18,18,16
PA 20,20,16
v_rcp_f32 v18, v18
v_rcp_f32 v19, v19
v_rcp_f32 v20, v20
v_rcp_f32 v21, v21
s_nop 0
PM 148,148,18
PM 150,150,20
CV 148,148,149
CV 149,150,151
PFN 152,42,64
PFN 154,42,66
PMB 22,46,152
PMB 24,46,154
v_exp_f32 v22, v22
v_exp_f32 v23, v23
v_exp_f32 v24, v24
v_exp_f32 v25, v25
PMB 152,44,152
PMB 154,44,154
PA 22,22,16
PA 24,24,16
v_rcp_f32 v22, v22
v_rcp_f32 v23, v23
v_rcp_f32 v24, v24
v_rcp_f32 v25, v25
s_nop 0
PM 152,152,22
PM 154,154,24
CV 152,152,153
CV 153,154,155
PFN 156,48,64
PFN 158,48,66
PMB 18,52,156
PMB 20,52,158
v_exp_f32 v18, v18
v_exp_f32 v19, v19
v_exp_f32 v20, v20
v_exp_f32 v21, v21
PMB 156,50,156
PMB 158,50,158
PA 18,18,16
PA 20,20,16
v_rcp_f32 v18, v18
v_rcp_f32 v19, v19
v_rcp_f32 v20, v20
v_rcp_f32 v21, v21
s_nop 0
PM 156,156,18
PM 158,158,20
CV 156,156,157
CV 157,158,159
PFN 160,54,64
PFN 162,54,66
PMB 22,58,160
PMB 24,58,162
v_exp_f32 v22, v22
v_exp_f32 v23, v23
v_exp_f32 v24, v24
v_exp_f32 v25, v25
PMB 160,56,160
PMB 162,56,162
PA 22,22,16
PA 24,24,16
v_rcp_f32 v22, v22
v_rcp_f32 v23, v23
v_rcp_f32 v24, v24
v_rcp_f32 v25, v25
s_nop 0
PM 160,160,22
PM 162,162,24
CV 160,160,161
CV 161,162,163
PFN 164,36,68
PFN 166,36,70
PMB 18,40,164
PMB 20,40,166
v_exp_f32 v18, v18
v_exp_f32 v19, v19
v_exp_f32 v20, v20
v_exp_f32 v21, v21
PMB 164,38,164
PMB 166,38,166
PA 18,18,16
PA 20,20,16
v_rcp_f32 v18, v18
v_rcp_f32 v19, v19
v_rcp_f32 v20, v20
v_rcp_f32 v21, v21
s_nop 0
PM 164,164,18
PM 166,166,20
CV 164,164,165
CV 165,166,167
PFN 168,42,68
PFN 170,42,70
PMB 22,46,168
PMB 24,46,170
v_exp_f32 v22, v22
v_exp_f32 v23, v23
v_exp_f32 v24, v24
v_exp_f32 v25, v25
PMB 168,44,168
PMB 170,44,170
PA 22,22,16
PA 24,24,16
v_rcp_f32 v22, v22
v_rcp_f32 v23, v23
v_rcp_f32 v24, v24
v_rcp_f32 v25, v25
s_nop 0
PM 168,168,22
PM 170,170,24
CV 168,168,169
CV 169,170,171
PFN 172,48,68
PFN 174,48,70
PMB 18,52,172
PMB 20,52,174
v_exp_f32 v18, v18
v_exp_f32 v19, v19
v_exp_f32 v20, v20
v_exp_f32 v21, v21
PMB 172,50,172
PMB 174,50,174
PA 18,18,16
PA 20,20,16
v_rcp_f32 v18, v18
v_rcp_f32 v19, v19
v_rcp_f32 v20, v20
v_rcp_f32 v21, v21
s_nop 0
PM 172,172,18
PM 174,174,20
CV 172,172,173
CV 173,174,175
PFN 176,54,68
PFN 178,54,70
PMB 22,58,176
PMB 24,58,178
v_exp_f32 v22, v22
v_exp_f32 v23, v23
v_exp_f32 v24, v24
v_exp_f32 v25, v25
PMB 176,56,176
PMB 178,56,178
PA 22,22,16
PA 24,24,16
v_rcp_f32 v22, v22
v_rcp_f32 v23, v23
v_rcp_f32 v24, v24
v_rcp_f32 v25, v25
s_nop 0
PM 176,176,22
PM 178,178,24
CV 176,176,177
CV 177,178,179
PFN 180,36,72
PFN 182,36,74
PMB 18,40,180
PMB 20,40,182
v_exp_f32 v18, v18
v_exp_f32 v19, v19
v_exp_f32 v20, v20
v_exp_f32 v21, v21
PMB 180,38,180
PMB 182,38,182
PA 18,18,16
PA 20,20,16
v_rcp_f32 v18, v18
v_rcp_f32 v19, v19
v_rcp_f32 v20, v20
v_rcp_f32 v21, v21
s_nop 0
PM 180,180,18
PM 182,182,20
CV 180,180,181
CV 181,182,183
PFN 184,42,72
PFN 186,42,74
PMB 22,46,184
PMB 24,46,186
v_exp_f32 v22, v22
v_exp_f32 v23, v23
v_exp_f32 v24, v24
v_exp_f32 v25, v25
PMB 184,44,184
PMB 186,44,186
PA 22,22,16
PA 24,24,16
v_rcp_f32 v22, v22
v_rcp_f32 v23, v23
v_rcp_f32 v24, v24
v_rcp_f32 v25, v25
s_nop 0
PM 184,184,22
PM 186,186,24
CV 184,184,185
CV 185,186,187
PFN 188,48,72
PFN 190,48,74
PMB 18,52,188
PMB 20,52,190
v_exp_f32 v18, v18
v_exp_f32 v19, v19
v_exp_f32 v20, v20
v_exp_f32 v21, v21
PMB 188,50,188
PMB 190,50,190
PA 18,18,16
PA 20,20,16
v_rcp_f32 v18, v18
v_rcp_f32 v19, v19
v_rcp_f32 v20, v20
v_rcp_f32 v21, v21
s_nop 0
PM 188,188,18
PM 190,190,20
CV 188,188,189
CV 189,190,191
PFN 192,54,72
PFN 194,54,74
PMB 22,58,192
PMB 24,58,194
v_exp_f32 v22, v22
v_exp_f32 v23, v23
v_exp_f32 v24, v24
v_exp_f32 v25, v25
PMB 192,56,192
PMB 194,56,194
PA 22,22,16
PA 24,24,16
v_rcp_f32 v22, v22
v_rcp_f32 v23, v23
v_rcp_f32 v24, v24
v_rcp_f32 v25, v25
s_nop 0
PM 192,192,22
PM 194,194,24
CV 192,192,193
CV 193,194,195
s_mul_i32 s33, s24, 108
s_mul_i32 s34, s25, 7
s_add_u32 s33, s33, s34
s_lshl_b32 s33, s33, 12
v_lshlrev_b32 v14, 4, v1
s_add_u32 s34, s33, 221184
buffer_store_dwordx2 v[132:133], v14, s[16:19], s34 offen
s_add_u32 s34, s33, 222208
buffer_store_dwordx2 v[136:137], v14, s[16:19], s34 offen
s_add_u32 s34, s33, 223232
buffer_store_dwordx2 v[140:141], v14, s[16:19], s34 offen
s_add_u32 s34, s33, 224256
buffer_store_dwordx2 v[144:145], v14, s[16:19], s34 offen
s_add_u32 s34, s33, 221192
buffer_store_dwordx2 v[148:149], v14, s[16:19], s34 offen
s_add_u32 s34, s33, 222216
buffer_store_dwordx2 v[152:153], v14, s[16:19], s34 offen
s_add_u32 s34, s33, 223240
buffer_store_dwordx2 v[156:157], v14, s[16:19], s34 offen
s_add_u32 s34, s33, 224264
buffer_store_dwordx2 v[160:161], v14, s[16:19], s34 offen
s_add_u32 s34, s33, 225280
buffer_store_dwordx2 v[164:165], v14, s[16:19], s34 offen
s_add_u32 s34, s33, 226304
buffer_store_dwordx2 v[168:169], v14, s[16:19], s34 offen
s_add_u32 s34, s33, 227328
buffer_store_dwordx2 v[172:173], v14, s[16:19], s34 offen
s_add_u32 s34, s33, 228352
buffer_store_dwordx2 v[176:177], v14, s[16:19], s34 offen
s_add_u32 s34, s33, 225288
buffer_store_dwordx2 v[180:181], v14, s[16:19], s34 offen
s_add_u32 s34, s33, 226312
buffer_store_dwordx2 v[184:185], v14, s[16:19], s34 offen
s_add_u32 s34, s33, 227336
buffer_store_dwordx2 v[188:189], v14, s[16:19], s34 offen
s_add_u32 s34, s33, 228360
buffer_store_dwordx2 v[192:193], v14, s[16:19], s34 offen
s_endpgm
K1_FFN5:
v_lshrrev_b32 v14, 3, v1
v_and_b32 v15, 7, v1
v_xor_b32 v15, v15, v14
v_lshlrev_b32 v15, 4, v15
s_mov_b32 s30, 0
s_mov_b32 s31, 0
s_mov_b32 s29, 0
s_mov_b32 s28, 0
s_mov_b32 s43, 221184
s_mov_b32 s38, 128
s_mov_b32 s39, 49152
s_add_i32 s33, s32, 40
v_add_u32 v2, s33, v14
v_max_i32 v2, 0, v2
v_mul_u32_u24 v2, 1280, v2
v_add_u32 v2, v2, v15
s_waitcnt lgkmcnt(0)
s_mov_b32 s8, s4
s_mov_b32 s9, s5
s_mov_b32 s52, s62
s_mov_b32 s53, s63
s_mov_b32 s12, s60
s_mov_b32 s13, s61
s_add_u32 m0, s29, 5120
s_nop 0
buffer_load_dwordx4 v2, s[8:11], s30 offen lds
s_add_i32 s33, s32, 104
v_add_u32 v3, s33, v14
v_max_i32 v3, 0, v3
v_mul_u32_u24 v3, 1280, v3
v_add_u32 v3, v3, v15
s_add_u32 m0, s29, 13312
s_nop 0
buffer_load_dwordx4 v3, s[8:11], s30 offen lds
v_add_u32 v16, 192, v1
v_mul_u32_u24 v17, 2185, v16
v_lshrrev_b32 v17, 16, v17
v_mul_u32_u24 v18, 30, v17
v_sub_u32 v18, v16, v18
v_and_b32 v19, 0x33, v17
v_and_b32 v20, 4, v17
v_lshl_or_b32 v19, v20, 1, v19
v_bfe_u32 v20, v17, 3, 1
v_lshl_or_b32 v19, v20, 2, v19
v_lshlrev_b32 v18, 4, v18
v_mul_u32_u24 v4, 3456, v19
v_add3_u32 v4, v4, v18, s36
s_add_u32 m0, s29, 21504
s_nop 0
buffer_load_dwordx4 v4, s[12:15], s31 offen lds
v_add_u32 v16, 704, v1
v_mul_u32_u24 v17, 2185, v16
v_lshrrev_b32 v17, 16, v17
v_mul_u32_u24 v18, 30, v17
v_sub_u32 v18, v16, v18
v_and_b32 v19, 0x33, v17
v_and_b32 v20, 4, v17
v_lshl_or_b32 v19, v20, 1, v19
v_bfe_u32 v20, v17, 3, 1
v_lshl_or_b32 v19, v20, 2, v19
v_lshlrev_b32 v18, 4, v18
v_mul_u32_u24 v5, 3456, v19
v_add3_u32 v5, v5, v18, s36
s_add_u32 m0, s29, 29696
s_nop 0
buffer_load_dwordx4 v5, s[12:15], s31 offen lds
v_add_u32 v16, 1216, v1
v_mul_u32_u24 v17, 2185, v16
v_lshrrev_b32 v17, 16, v17
v_mul_u32_u24 v18, 30, v17
v_sub_u32 v18, v16, v18
v_and_b32 v19, 0x33, v17
v_and_b32 v20, 4, v17
v_lshl_or_b32 v19, v20, 1, v19
v_bfe_u32 v20, v17, 3, 1
v_lshl_or_b32 v19, v20, 2, v19
v_lshlrev_b32 v18, 4, v18
v_mul_u32_u24 v6, 3456, v19
v_add3_u32 v6, v6, v18, s36
s_add_u32 m0, s29, 37888
s_nop 0
buffer_load_dwordx4 v6, s[12:15], s31 offen lds
v_add_u32 v16, 1728, v1
v_mul_u32_u24 v17, 2185, v16
v_lshrrev_b32 v17, 16, v17
v_mul_u32_u24 v18, 30, v17
v_sub_u32 v18, v16, v18
v_and_b32 v19, 0x33, v17
v_and_b32 v20, 4, v17
v_lshl_or_b32 v19, v20, 1, v19
v_bfe_u32 v20, v17, 3, 1
v_lshl_or_b32 v19, v20, 2, v19
v_lshlrev_b32 v18, 4, v18
v_mul_u32_u24 v7, 3456, v19
v_add3_u32 v7, v7, v18, s36
s_add_u32 m0, s29, 46080
s_nop 0
buffer_load_dwordx4 v7, s[12:15], s31 offen lds
s_add_u32 s30, s30, s38
s_add_u32 s31, s31, s43
s_add_u32 s29, s29, s39
s_cmp_eq_u32 s29, 147456
s_cselect_b32 s29, 0, s29
s_cmp_eq_u32 s30, 1280
s_cselect_b32 s30, 0, s30
s_cselect_b32 s31, 0, s31
s_cselect_b32 s38, 0, s38
s_cselect_b32 s43, 0, s43
s_cselect_b32 s39, 0, s39
s_cselect_b32 s29, 0x30000, s29
s_cselect_b32 s10, 0, s10
s_cselect_b32 s14, 0, s14
s_add_u32 m0, s29, 5120
s_nop 0
buffer_load_dwordx4 v2, s[8:11], s30 offen lds
s_add_u32 m0, s29, 13312
s_nop 0
buffer_load_dwordx4 v3, s[8:11], s30 offen lds
s_add_u32 m0, s29, 21504
s_nop 0
buffer_load_dwordx4 v4, s[12:15], s31 offen lds
s_add_u32 m0, s29, 29696
s_nop 0
buffer_load_dwordx4 v5, s[12:15], s31 offen lds
s_add_u32 m0, s29, 37888
s_nop 0
buffer_load_dwordx4 v6, s[12:15], s31 offen lds
s_add_u32 m0, s29, 46080
s_nop 0
buffer_load_dwordx4 v7, s[12:15], s31 offen lds
s_add_u32 s30, s30, s38
s_add_u32 s31, s31, s43
s_add_u32 s29, s29, s39
s_cmp_eq_u32 s29, 147456
s_cselect_b32 s29, 0, s29
s_cmp_eq_u32 s30, 1280
s_cselect_b32 s30, 0, s30
s_cselect_b32 s31, 0, s31
s_cselect_b32 s38, 0, s38
s_cselect_b32 s43, 0, s43
s_cselect_b32 s39, 0, s39
s_cselect_b32 s29, 0x30000, s29
s_cselect_b32 s10, 0, s10
s_cselect_b32 s14, 0, s14
v_and_b32 v14, 15, v1
v_lshrrev_b32 v15, 4, v1
v_and_b32 v16, 7, v14
v_xor_b32 v16, v16, v15
v_lshlrev_b32 v16, 4, v16
v_lshl_add_u32 v11, v14, 7, v16
v_xor_b32 v12, 64, v11
v_cmp_eq_u32 s[44:45], 0, v14
v_lshrrev_b32 v16, 1, v15
v_lshlrev_b32 v16, 4, v16
v_and_b32 v17, 1, v15
v_lshl_add_u32 v16, v17, 2, v16
v_bfe_u32 v17, v1, 2, 2
v_add_u32 v16, v16, v17
v_mul_u32_u24 v16, 480, v16
v_and_b32 v17, 3, v1
v_lshl_add_u32 v16, v17, 3, v16
v_add_u32 v13, 18432, v16
v_mov_b32 v132, 0
v_mov_b32 v133, 0
v_mov_b32 v134, 0
v_mov_b32 v135, 0
v_mov_b32 v136, 0
v_mov_b32 v137, 0
v_mov_b32 v138, 0
v_mov_b32 v139, 0
v_mov_b32 v140, 0
v_mov_b32 v141, 0
v_mov_b32 v142, 0
v_mov_b32 v143, 0
v_mov_b32 v144, 0
v_mov_b32 v145, 0
v_mov_b32 v146, 0
v_mov_b32 v147, 0
v_mov_b32 v148, 0
v_mov_b32 v149, 0
v_mov_b32 v150, 0
v_mov_b32 v151, 0
v_mov_b32 v152, 0
v_mov_b32 v153, 0
v_mov_b32 v154, 0
v_mov_b32 v155, 0
v_mov_b32 v156, 0
v_mov_b32 v157, 0
v_mov_b32 v158, 0
v_mov_b32 v159, 0
v_mov_b32 v160, 0
v_mov_b32 v161, 0
v_mov_b32 v162, 0
v_mov_b32 v163, 0
v_mov_b32 v164, 0
v_mov_b32 v165, 0
v_mov_b32 v166, 0
v_mov_b32 v167, 0
v_mov_b32 v168, 0
v_mov_b32 v169, 0
v_mov_b32 v170, 0
v_mov_b32 v171, 0
v_mov_b32 v172, 0
v_mov_b32 v173, 0
v_mov_b32 v174, 0
v_mov_b32 v175, 0
v_mov_b32 v176, 0
v_mov_b32 v177, 0
v_mov_b32 v178, 0
v_mov_b32 v179, 0
v_mov_b32 v180, 0
v_mov_b32 v181, 0
v_mov_b32 v182, 0
v_mov_b32 v183, 0
v_mov_b32 v184, 0
v_mov_b32 v185, 0
v_mov_b32 v186, 0
v_mov_b32 v187, 0
v_mov_b32 v188, 0
v_mov_b32 v189, 0
v_mov_b32 v190, 0
v_mov_b32 v191, 0
v_mov_b32 v192, 0
v_mov_b32 v193, 0
v_mov_b32 v194, 0
v_mov_b32 v195, 0
v_mov_b32 v196, 0
v_mov_b32 v197, 0
v_mov_b32 v198, 0
v_mov_b32 v199, 0
v_mov_b32 v200, 0
v_mov_b32 v201, 0
v_mov_b32 v202, 0
v_mov_b32 v203, 0
v_mov_b32 v32, 0x3f803f80
v_mov_b32 v33, 0x3f803f80
v_mov_b32 v34, 0x3f803f80
v_mov_b32 v35, 0x3f803f80
s_waitcnt vmcnt(6)
s_barrier
v_add_u32 v8, s28, v11
v_add_u32 v9, s28, v12
v_add_u32 v10, s28, v13
RX 36,8,10240
RX 40,8,12288
RX 44,8,14336
RX 48,8,16384
TR 52,10,128
TR 54,10,3968
TR 56,10,160
TR 58,10,4000
TR 60,10,192
TR 62,10,4032
TR 64,10,224
TR 66,10,4064
s_add_u32 m0, s29, 5120
s_nop 0
buffer_load_dwordx4 v2, s[8:11], s30 offen lds
s_add_u32 m0, s29, 13312
s_nop 0
buffer_load_dwordx4 v3, s[8:11], s30 offen lds
s_add_u32 m0, s29, 21504
s_nop 0
buffer_load_dwordx4 v4, s[12:15], s31 offen lds
s_add_u32 m0, s29, 29696
s_nop 0
buffer_load_dwordx4 v5, s[12:15], s31 offen lds
s_add_u32 m0, s29, 37888
s_nop 0
buffer_load_dwordx4 v6, s[12:15], s31 offen lds
s_add_u32 m0, s29, 46080
s_nop 0
buffer_load_dwordx4 v7, s[12:15], s31 offen lds
s_add_u32 s30, s30, s38
s_add_u32 s31, s31, s43
s_add_u32 s29, s29, s39
s_cmp_eq_u32 s29, 147456
s_cselect_b32 s29, 0, s29
s_cmp_eq_u32 s30, 1280
s_cselect_b32 s30, 0, s30
s_cselect_b32 s31, 0, s31
s_cselect_b32 s38, 0, s38
s_cselect_b32 s43, 0, s43
s_cselect_b32 s39, 0, s39
s_cselect_b32 s29, 0x30000, s29
s_cselect_b32 s10, 0, s10
s_cselect_b32 s14, 0, s14
s_mov_b32 s27, 0
s_waitcnt lgkmcnt(0)
K1Lffn5:
M 132,52,36
RX 84,9,10240
M 136,52,40
RX 88,9,12288
M 140,52,44
RX 92,9,14336
M 144,52,48
RX 96,9,16384
M 148,56,36
TR 100,10,15488
M 152,56,40
TR 102,10,19328
M 156,56,44
TR 104,10,15520
M 160,56,48
TR 106,10,19360
M 164,60,36
TR 108,10,15552
M 168,60,40
TR 110,10,19392
M 172,60,44
TR 112,10,15584
M 176,60,48
TR 114,10,19424
M 180,64,36
M 184,64,40
s_add_u32 s28, s28, 49152
s_cmp_eq_u32 s28, 147456
s_cselect_b32 s28, 0, s28
M 188,64,44
v_add_u32 v8, s28, v11
v_add_u32 v9, s28, v12
v_add_u32 v10, s28, v13
M 192,64,48
s_cmp_eq_u32 s27, 9
M 196,32,40
M 200,40,40
s_cbranch_scc1 K1Effn5
s_waitcnt vmcnt(6) lgkmcnt(0)
s_barrier
M 132,100,84
s_add_u32 m0, s29, 5120
RX 36,8,10240
buffer_load_dwordx4 v2, s[8:11], s30 offen lds
M 136,100,88
s_add_u32 m0, s29, 13312
RX 40,8,12288
buffer_load_dwordx4 v3, s[8:11], s30 offen lds
M 140,100,92
s_add_u32 m0, s29, 21504
RX 44,8,14336
buffer_load_dwordx4 v4, s[12:15], s31 offen lds
M 144,100,96
s_add_u32 m0, s29, 29696
RX 48,8,16384
buffer_load_dwordx4 v5, s[12:15], s31 offen lds
M 148,104,84
s_add_u32 m0, s29, 37888
TR 52,10,128
buffer_load_dwordx4 v6, s[12:15], s31 offen lds
M 152,104,88
s_add_u32 m0, s29, 46080
TR 54,10,3968
buffer_load_dwordx4 v7, s[12:15], s31 offen lds
M 156,104,92
TR 56,10,160
M 160,104,96
TR 58,10,4000
M 164,108,84
TR 60,10,192
M 168,108,88
TR 62,10,4032
M 172,108,92
TR 64,10,224
M 176,108,96
TR 66,10,4064
M 180,112,84
s_add_u32 s30, s30, s38
s_add_u32 s31, s31, s43
s_add_u32 s29, s29, s39
M 184,112,88
s_cmp_eq_u32 s29, 147456
s_cselect_b32 s29, 0, s29
s_cmp_eq_u32 s30, 1280
M 188,112,92
s_cselect_b32 s30, 0, s30
s_cselect_b32 s31, 0, s31
s_cselect_b32 s38, 0, s38
M 192,112,96
s_cselect_b32 s43, 0, s43
s_cselect_b32 s39, 0, s39
s_cselect_b32 s29, 0x30000, s29
M 196,32,88
s_cselect_b32 s10, 0, s10
s_cselect_b32 s14, 0, s14
s_add_u32 s27, s27, 1
M 200,88,88
s_waitcnt lgkmcnt(0)
s_branch K1Lffn5
K1Effn5:
s_waitcnt lgkmcnt(0)
M 132,100,84
M 136,100,88
M 140,100,92
M 144,100,96
M 148,104,84
M 152,104,88
M 156,104,92
M 160,104,96
M 164,108,84
M 168,108,88
M 172,108,92
M 176,108,96
M 180,112,84
M 184,112,88
M 188,112,92
M 192,112,96
M 196,32,88
M 200,88,88
s_waitcnt vmcnt(0)
s_nop 7
s_nop 3
v_and_b32 v14, 15, v1
v_lshrrev_b32 v15, 4, v1
v_lshrrev_b32 v16, 2, v14
v_and_b32 v17, 3, v14
v_cmp_eq_u32 s[46:47], v16, v15
v_cmp_eq_u32 s[48:49], 1, v17
v_cmp_eq_u32 s[54:55], 2, v17
v_cmp_eq_u32 s[56:57], 3, v17
v_lshlrev_b32 v18, 2, v14
v_add_u32 v18, 98304, v18
s_mov_b32 s33, 0x3acccccd
s_mov_b32 s34, 0x3727c5ac
v_cndmask_b32 v200, v200, v201, s[48:49]
v_cndmask_b32 v200, v200, v202, s[54:55]
v_cndmask_b32 v200, v200, v203, s[56:57]
v_mul_f32 v196, s33, v196
v_mul_f32 v200, s33, v200
v_fma_f32 v200, -v196, v196, v200
v_max_f32 v200, 0, v200
v_add_f32 v200, s34, v200
v_rsq_f32 v200, v200
s_mov_b64 exec, s[46:47]
ds_write_b32 v18, v196 offset:384
ds_write_b32 v18, v200 offset:960
s_mov_b64 exec, -1
s_waitcnt lgkmcnt(0)
s_barrier
v_and_b32 v14, 15, v1
v_lshlrev_b32 v14, 2, v14
v_lshrrev_b32 v15, 4, v1
v_lshlrev_b32 v15, 4, v15
v_add_u32 v14, 98304, v14
v_add_u32 v15, 98304, v15
ds_read_b32 v36, v14 offset:320
ds_read_b32 v38, v14 offset:896
ds_read_b32 v42, v14 offset:384
ds_read_b32 v44, v14 offset:960
ds_read_b32 v48, v14 offset:448
ds_read_b32 v50, v14 offset:1024
ds_read_b32 v54, v14 offset:512
ds_read_b32 v56, v14 offset:1088
ds_read_b128 v[60:63], v15 offset:1408
ds_read_b128 v[64:67], v15 offset:1472
ds_read_b128 v[68:71], v15 offset:1536
ds_read_b128 v[72:75], v15 offset:1600
s_waitcnt lgkmcnt(0)
v_mov_b32 v16, 1.0
v_mov_b32 v17, 1.0
s_mov_b32 s33, 0xbfb8aa3b
v_mul_f32 v40, s33, v38
v_mul_f32 v46, s33, v44
v_mul_f32 v52, s33, v50
v_mul_f32 v58, s33, v56
PFN 132,36,60
PFN 134,36,62
PMB 18,40,132
PMB 20,40,134
v_exp_f32 v18, v18
v_exp_f32 v19, v19
v_exp_f32 v20, v20
v_exp_f32 v21, v21
PMB 132,38,132
PMB 134,38,134
PA 18,18,16
PA 20,20,16
v_rcp_f32 v18, v18
v_rcp_f32 v19, v19
v_rcp_f32 v20, v20
v_rcp_f32 v21, v21
s_nop 0
PM 132,132,18
PM 134,134,20
CV 132,132,133
CV 133,134,135
PFN 136,42,60
PFN 138,42,62
PMB 22,46,136
PMB 24,46,138
v_exp_f32 v22, v22
v_exp_f32 v23, v23
v_exp_f32 v24, v24
v_exp_f32 v25, v25
PMB 136,44,136
PMB 138,44,138
PA 22,22,16
PA 24,24,16
v_rcp_f32 v22, v22
v_rcp_f32 v23, v23
v_rcp_f32 v24, v24
v_rcp_f32 v25, v25
s_nop 0
PM 136,136,22
PM 138,138,24
CV 136,136,137
CV 137,138,139
PFN 140,48,60
PFN 142,48,62
PMB 18,52,140
PMB 20,52,142
v_exp_f32 v18, v18
v_exp_f32 v19, v19
v_exp_f32 v20, v20
v_exp_f32 v21, v21
PMB 140,50,140
PMB 142,50,142
PA 18,18,16
PA 20,20,16
v_rcp_f32 v18, v18
v_rcp_f32 v19, v19
v_rcp_f32 v20, v20
v_rcp_f32 v21, v21
s_nop 0
PM 140,140,18
PM 142,142,20
CV 140,140,141
CV 141,142,143
PFN 144,54,60
PFN 146,54,62
PMB 22,58,144
PMB 24,58,146
v_exp_f32 v22, v22
v_exp_f32 v23, v23
v_exp_f32 v24, v24
v_exp_f32 v25, v25
PMB 144,56,144
PMB 146,56,146
PA 22,22,16
PA 24,24,16
v_rcp_f32 v22, v22
v_rcp_f32 v23, v23
v_rcp_f32 v24, v24
v_rcp_f32 v25, v25
s_nop 0
PM 144,144,22
PM 146,146,24
CV 144,144,145
CV 145,146,147
PFN 148,36,64
PFN 150,36,66
PMB 18,40,148
PMB 20,40,150
v_exp_f32 v18, v18
v_exp_f32 v19, v19
v_exp_f32 v20, v20
v_exp_f32 v21, v21
PMB 148,38,148
PMB 150,38,150
PA 18,18,16
PA 20,20,16
v_rcp_f32 v18, v18
v_rcp_f32 v19, v19
v_rcp_f32 v20, v20
v_rcp_f32 v21, v21
s_nop 0
PM 148,148,18
PM 150,150,20
CV 148,148,149
CV 149,150,151
PFN 152,42,64
PFN 154,42,66
PMB 22,46,152
PMB 24,46,154
v_exp_f32 v22, v22
v_exp_f32 v23, v23
v_exp_f32 v24, v24
v_exp_f32 v25, v25
PMB 152,44,152
PMB 154,44,154
PA 22,22,16
PA 24,24,16
v_rcp_f32 v22, v22
v_rcp_f32 v23, v23
v_rcp_f32 v24, v24
v_rcp_f32 v25, v25
s_nop 0
PM 152,152,22
PM 154,154,24
CV 152,152,153
CV 153,154,155
PFN 156,48,64
PFN 158,48,66
PMB 18,52,156
PMB 20,52,158
v_exp_f32 v18, v18
v_exp_f32 v19, v19
v_exp_f32 v20, v20
v_exp_f32 v21, v21
PMB 156,50,156
PMB 158,50,158
PA 18,18,16
PA 20,20,16
v_rcp_f32 v18, v18
v_rcp_f32 v19, v19
v_rcp_f32 v20, v20
v_rcp_f32 v21, v21
s_nop 0
PM 156,156,18
PM 158,158,20
CV 156,156,157
CV 157,158,159
PFN 160,54,64
PFN 162,54,66
PMB 22,58,160
PMB 24,58,162
v_exp_f32 v22, v22
v_exp_f32 v23, v23
v_exp_f32 v24, v24
v_exp_f32 v25, v25
PMB 160,56,160
PMB 162,56,162
PA 22,22,16
PA 24,24,16
v_rcp_f32 v22, v22
v_rcp_f32 v23, v23
v_rcp_f32 v24, v24
v_rcp_f32 v25, v25
s_nop 0
PM 160,160,22
PM 162,162,24
CV 160,160,161
CV 161,162,163
PFN 164,36,68
PFN 166,36,70
PMB 18,40,164
PMB 20,40,166
v_exp_f32 v18, v18
v_exp_f32 v19, v19
v_exp_f32 v20, v20
v_exp_f32 v21, v21
PMB 164,38,164
PMB 166,38,166
PA 18,18,16
PA 20,20,16
v_rcp_f32 v18, v18
v_rcp_f32 v19, v19
v_rcp_f32 v20, v20
v_rcp_f32 v21, v21
s_nop 0
PM 164,164,18
PM 166,166,20
CV 164,164,165
CV 165,166,167
PFN 168,42,68
PFN 170,42,70
PMB 22,46,168
PMB 24,46,170
v_exp_f32 v22, v22
v_exp_f32 v23, v23
v_exp_f32 v24, v24
v_exp_f32 v25, v25
PMB 168,44,168
PMB 170,44,170
PA 22,22,16
PA 24,24,16
v_rcp_f32 v22, v22
v_rcp_f32 v23, v23
v_rcp_f32 v24, v24
v_rcp_f32 v25, v25
s_nop 0
PM 168,168,22
PM 170,170,24
CV 168,168,169
CV 169,170,171
PFN 172,48,68
PFN 174,48,70
PMB 18,52,172
PMB 20,52,174
v_exp_f32 v18, v18
v_exp_f32 v19, v19
v_exp_f32 v20, v20
v_exp_f32 v21, v21
PMB 172,50,172
PMB 174,50,174
PA 18,18,16
PA 20,20,16
v_rcp_f32 v18, v18
v_rcp_f32 v19, v19
v_rcp_f32 v20, v20
v_rcp_f32 v21, v21
s_nop 0
PM 172,172,18
PM 174,174,20
CV 172,172,173
CV 173,174,175
PFN 176,54,68
PFN 178,54,70
PMB 22,58,176
PMB 24,58,178
v_exp_f32 v22, v22
v_exp_f32 v23, v23
v_exp_f32 v24, v24
v_exp_f32 v25, v25
PMB 176,56,176
PMB 178,56,178
PA 22,22,16
PA 24,24,16
v_rcp_f32 v22, v22
v_rcp_f32 v23, v23
v_rcp_f32 v24, v24
v_rcp_f32 v25, v25
s_nop 0
PM 176,176,22
PM 178,178,24
CV 176,176,177
CV 177,178,179
PFN 180,36,72
PFN 182,36,74
PMB 18,40,180
PMB 20,40,182
v_exp_f32 v18, v18
v_exp_f32 v19, v19
v_exp_f32 v20, v20
v_exp_f32 v21, v21
PMB 180,38,180
PMB 182,38,182
PA 18,18,16
PA 20,20,16
v_rcp_f32 v18, v18
v_rcp_f32 v19, v19
v_rcp_f32 v20, v20
v_rcp_f32 v21, v21
s_nop 0
PM 180,180,18
PM 182,182,20
CV 180,180,181
CV 181,182,183
PFN 184,42,72
PFN 186,42,74
PMB 22,46,184
PMB 24,46,186
v_exp_f32 v22, v22
v_exp_f32 v23, v23
v_exp_f32 v24, v24
v_exp_f32 v25, v25
PMB 184,44,184
PMB 186,44,186
PA 22,22,16
PA 24,24,16
v_rcp_f32 v22, v22
v_rcp_f32 v23, v23
v_rcp_f32 v24, v24
v_rcp_f32 v25, v25
s_nop 0
PM 184,184,22
PM 186,186,24
CV 184,184,185
CV 185,186,187
PFN 188,48,72
PFN 190,48,74
PMB 18,52,188
PMB 20,52,190
v_exp_f32 v18, v18
v_exp_f32 v19, v19
v_exp_f32 v20, v20
v_exp_f32 v21, v21
PMB 188,50,188
PMB 190,50,190
PA 18,18,16
PA 20,20,16
v_rcp_f32 v18, v18
v_rcp_f32 v19, v19
v_rcp_f32 v20, v20
v_rcp_f32 v21, v21
s_nop 0
PM 188,188,18
PM 190,190,20
CV 188,188,189
CV 189,190,191
PFN 192,54,72
PFN 194,54,74
PMB 22,58,192
PMB 24,58,194
v_exp_f32 v22, v22
v_exp_f32 v23, v23
v_exp_f32 v24, v24
v_exp_f32 v25, v25
PMB 192,56,192
PMB 194,56,194
PA 22,22,16
PA 24,24,16
v_rcp_f32 v22, v22
v_rcp_f32 v23, v23
v_rcp_f32 v24, v24
v_rcp_f32 v25, v25
s_nop 0
PM 192,192,22
PM 194,194,24
CV 192,192,193
CV 193,194,195
s_mul_i32 s33, s24, 108
s_mul_i32 s34, s25, 7
s_add_u32 s33, s33, s34
s_lshl_b32 s33, s33, 12
v_lshlrev_b32 v14, 4, v1
s_add_u32 s34, s33, 229376
buffer_store_dwordx2 v[132:133], v14, s[16:19], s34 offen
s_add_u32 s34, s33, 230400
buffer_store_dwordx2 v[136:137], v14, s[16:19], s34 offen
s_add_u32 s34, s33, 231424
buffer_store_dwordx2 v[140:141], v14, s[16:19], s34 offen
s_add_u32 s34, s33, 232448
buffer_store_dwordx2 v[144:145], v14, s[16:19], s34 offen
s_add_u32 s34, s33, 229384
buffer_store_dwordx2 v[148:149], v14, s[16:19], s34 offen
s_add_u32 s34, s33, 230408
buffer_store_dwordx2 v[152:153], v14, s[16:19], s34 offen
s_add_u32 s34, s33, 231432
buffer_store_dwordx2 v[156:157], v14, s[16:19], s34 offen
s_add_u32 s34, s33, 232456
buffer_store_dwordx2 v[160:161], v14, s[16:19], s34 offen
s_add_u32 s34, s33, 233472
buffer_store_dwordx2 v[164:165], v14, s[16:19], s34 offen
s_add_u32 s34, s33, 234496
buffer_store_dwordx2 v[168:169], v14, s[16:19], s34 offen
s_add_u32 s34, s33, 235520
buffer_store_dwordx2 v[172:173], v14, s[16:19], s34 offen
s_add_u32 s34, s33, 236544
buffer_store_dwordx2 v[176:177], v14, s[16:19], s34 offen
s_add_u32 s34, s33, 233480
buffer_store_dwordx2 v[180:181], v14, s[16:19], s34 offen
s_add_u32 s34, s33, 234504
buffer_store_dwordx2 v[184:185], v14, s[16:19], s34 offen
s_add_u32 s34, s33, 235528
buffer_store_dwordx2 v[188:189], v14, s[16:19], s34 offen
s_add_u32 s34, s33, 236552
buffer_store_dwordx2 v[192:193], v14, s[16:19], s34 offen
s_endpgm
K1_FFN6:
v_lshrrev_b32 v14, 3, v1
v_and_b32 v15, 7, v1
v_xor_b32 v15, v15, v14
v_lshlrev_b32 v15, 4, v15
s_mov_b32 s30, 0
s_mov_b32 s31, 0
s_mov_b32 s29, 0
s_mov_b32 s28, 0
s_mov_b32 s43, 221184
s_mov_b32 s38, 128
s_mov_b32 s39, 49152
s_add_i32 s33, s32, 48
v_add_u32 v2, s33, v14
v_max_i32 v2, 0, v2
v_mul_u32_u24 v2, 1280, v2
v_add_u32 v2, v2, v15
s_waitcnt lgkmcnt(0)
s_mov_b32 s8, s4
s_mov_b32 s9, s5
s_mov_b32 s52, s62
s_mov_b32 s53, s63
s_mov_b32 s12, s60
s_mov_b32 s13, s61
s_add_u32 m0, s29, 6144
s_nop 0
buffer_load_dwordx4 v2, s[8:11], s30 offen lds
s_add_i32 s33, s32, 112
v_add_u32 v3, s33, v14
v_max_i32 v3, 0, v3
v_mul_u32_u24 v3, 1280, v3
v_add_u32 v3, v3, v15
s_add_u32 m0, s29, 14336
s_nop 0
buffer_load_dwordx4 v3, s[8:11], s30 offen lds
v_add_u32 v16, 256, v1
v_mul_u32_u24 v17, 2185, v16
v_lshrrev_b32 v17, 16, v17
v_mul_u32_u24 v18, 30, v17
v_sub_u32 v18, v16, v18
v_and_b32 v19, 0x33, v17
v_and_b32 v20, 4, v17
v_lshl_or_b32 v19, v20, 1, v19
v_bfe_u32 v20, v17, 3, 1
v_lshl_or_b32 v19, v20, 2, v19
v_lshlrev_b32 v18, 4, v18
v_mul_u32_u24 v4, 3456, v19
v_add3_u32 v4, v4, v18, s36
s_add_u32 m0, s29, 22528
s_nop 0
buffer_load_dwordx4 v4, s[12:15], s31 offen lds
v_add_u32 v16, 768, v1
v_mul_u32_u24 v17, 2185, v16
v_lshrrev_b32 v17, 16, v17
v_mul_u32_u24 v18, 30, v17
v_sub_u32 v18, v16, v18
v_and_b32 v19, 0x33, v17
v_and_b32 v20, 4, v17
v_lshl_or_b32 v19, v20, 1, v19
v_bfe_u32 v20, v17, 3, 1
v_lshl_or_b32 v19, v20, 2, v19
v_lshlrev_b32 v18, 4, v18
v_mul_u32_u24 v5, 3456, v19
v_add3_u32 v5, v5, v18, s36
s_add_u32 m0, s29, 30720
s_nop 0
buffer_load_dwordx4 v5, s[12:15], s31 offen lds
v_add_u32 v16, 1280, v1
v_mul_u32_u24 v17, 2185, v16
v_lshrrev_b32 v17, 16, v17
v_mul_u32_u24 v18, 30, v17
v_sub_u32 v18, v16, v18
v_and_b32 v19, 0x33, v17
v_and_b32 v20, 4, v17
v_lshl_or_b32 v19, v20, 1, v19
v_bfe_u32 v20, v17, 3, 1
v_lshl_or_b32 v19, v20, 2, v19
v_lshlrev_b32 v18, 4, v18
v_mul_u32_u24 v6, 3456, v19
v_add3_u32 v6, v6, v18, s36
s_add_u32 m0, s29, 38912
s_nop 0
buffer_load_dwordx4 v6, s[12:15], s31 offen lds
v_add_u32 v16, 1792, v1
v_mul_u32_u24 v17, 2185, v16
v_lshrrev_b32 v17, 16, v17
v_mul_u32_u24 v18, 30, v17
v_sub_u32 v18, v16, v18
v_and_b32 v19, 0x33, v17
v_and_b32 v20, 4, v17
v_lshl_or_b32 v19, v20, 1, v19
v_bfe_u32 v20, v17, 3, 1
v_lshl_or_b32 v19, v20, 2, v19
v_lshlrev_b32 v18, 4, v18
v_mul_u32_u24 v7, 3456, v19
v_add3_u32 v7, v7, v18, s36
s_add_u32 m0, s29, 47104
s_nop 0
buffer_load_dwordx4 v7, s[12:15], s31 offen lds
s_add_u32 s30, s30, s38
s_add_u32 s31, s31, s43
s_add_u32 s29, s29, s39
s_cmp_eq_u32 s29, 147456
s_cselect_b32 s29, 0, s29
s_cmp_eq_u32 s30, 1280
s_cselect_b32 s30, 0, s30
s_cselect_b32 s31, 0, s31
s_cselect_b32 s38, 0, s38
s_cselect_b32 s43, 0, s43
s_cselect_b32 s39, 0, s39
s_cselect_b32 s29, 0x30000, s29
s_cselect_b32 s10, 0, s10
s_cselect_b32 s14, 0, s14
s_add_u32 m0, s29, 6144
s_nop 0
buffer_load_dwordx4 v2, s[8:11], s30 offen lds
s_add_u32 m0, s29, 14336
s_nop 0
buffer_load_dwordx4 v3, s[8:11], s30 offen lds
s_add_u32 m0, s29, 22528
s_nop 0
buffer_load_dwordx4 v4, s[12:15], s31 offen lds
s_add_u32 m0, s29, 30720
s_nop 0
buffer_load_dwordx4 v5, s[12:15], s31 offen lds
s_add_u32 m0, s29, 38912
s_nop 0
buffer_load_dwordx4 v6, s[12:15], s31 offen lds
s_add_u32 m0, s29, 47104
s_nop 0
buffer_load_dwordx4 v7, s[12:15], s31 offen lds
s_add_u32 s30, s30, s38
s_add_u32 s31, s31, s43
s_add_u32 s29, s29, s39
s_cmp_eq_u32 s29, 147456
s_cselect_b32 s29, 0, s29
s_cmp_eq_u32 s30, 1280
s_cselect_b32 s30, 0, s30
s_cselect_b32 s31, 0, s31
s_cselect_b32 s38, 0, s38
s_cselect_b32 s43, 0, s43
s_cselect_b32 s39, 0, s39
s_cselect_b32 s29, 0x30000, s29
s_cselect_b32 s10, 0, s10
s_cselect_b32 s14, 0, s14
s_lshr_b32 s33, s37, 3
s_and_b32 s34, s37, 3
s_bfe_u32 s35, s37, 0x10002
s_mov_b32 s67, 0x00020000
s_mov_b32 s74, 2
s_cmp_ge_u32 s33, 16
s_cbranch_scc1 TC31
s_mov_b32 s64, s4
s_mov_b32 s65, s5
s_mov_b32 s66, 2621440
s_mov_b32 s69, 128
s_lshl_b32 s35, s35, 10
s_lshl_b32 s33, s33, 6
s_add_u32 s33, s33, s35
v_add_u32 v220, s33, v1
v_mul_u32_u24 v220, 1280, v220
s_branch TC33
TC31:
s_cmp_ge_u32 s33, 25
s_cbranch_scc1 TC32
s_mov_b32 s64, s6
s_mov_b32 s65, s7
s_mov_b32 s66, 2457600
s_mov_b32 s69, 245760
s_sub_u32 s33, s33, 16
s_lshl_b32 s33, s33, 6
v_add_u32 v16, s33, v1
v_mul_u32_u24 v17, 7282, v16
v_lshrrev_b32 v17, 16, v17
v_mul_u32_u24 v18, 9, v17
v_sub_u32 v18, v16, v18
v_mul_u32_u24 v19, 21846, v18
v_lshrrev_b32 v19, 16, v19
v_mul_u32_u24 v20, 3, v19
v_sub_u32 v20, v18, v20
v_mul_u32_u24 v220, 3840, v17
v_mul_u32_u24 v19, 1280, v19
v_lshlrev_b32 v20, 7, v20
v_add3_u32 v220, v220, v19, v20
s_mul_i32 s34, s34, 320
s_and_b32 s34, s34, 0xffffff80
v_add_u32 v220, s34, v220
s_branch TC33
TC32:
s_mov_b32 s64, s60
s_mov_b32 s65, s61
s_mov_b32 s66, 2211840
s_mov_b32 s69, 221184
s_sub_u32 s33, s33, 25
s_lshl_b32 s33, s33, 6
v_add_u32 v16, s33, v1
v_mul_u32_u24 v17, 9363, v16
v_lshrrev_b32 v17, 16, v17
v_mul_u32_u24 v18, 7, v17
v_sub_u32 v18, v16, v18
v_mul_u32_u24 v220, 3456, v17
v_lshl_add_u32 v220, v18, 7, v220
s_mul_i32 s34, s34, 896
v_add_u32 v220, s34, v220
TC33:
s_lshl_b32 s68, s69, 1
buffer_load_dword v221, v220, s[64:67], s68 offen
s_add_u32 s68, s68, s69
s_add_u32 s74, s74, 1
s_cmp_ge_u32 s74, 10
s_cselect_b32 s66, 0, s66
s_cselect_b32 s68, 0, s68
s_cselect_b32 s69, 0, s69
buffer_load_dword v221, v220, s[64:67], s68 offen
s_add_u32 s68, s68, s69
s_add_u32 s74, s74, 1
s_cmp_ge_u32 s74, 10
s_cselect_b32 s66, 0, s66
s_cselect_b32 s68, 0, s68
s_cselect_b32 s69, 0, s69
v_and_b32 v14, 15, v1
v_lshrrev_b32 v15, 4, v1
v_and_b32 v16, 7, v14
v_xor_b32 v16, v16, v15
v_lshlrev_b32 v16, 4, v16
v_lshl_add_u32 v11, v14, 7, v16
v_xor_b32 v12, 64, v11
v_cmp_eq_u32 s[44:45], 0, v14
v_lshrrev_b32 v16, 1, v15
v_lshlrev_b32 v16, 4, v16
v_and_b32 v17, 1, v15
v_lshl_add_u32 v16, v17, 2, v16
v_bfe_u32 v17, v1, 2, 2
v_add_u32 v16, v16, v17
v_mul_u32_u24 v16, 480, v16
v_and_b32 v17, 3, v1
v_lshl_add_u32 v16, v17, 3, v16
v_add_u32 v13, 18432, v16
v_mov_b32 v132, 0
v_mov_b32 v133, 0
v_mov_b32 v134, 0
v_mov_b32 v135, 0
v_mov_b32 v136, 0
v_mov_b32 v137, 0
v_mov_b32 v138, 0
v_mov_b32 v139, 0
v_mov_b32 v140, 0
v_mov_b32 v141, 0
v_mov_b32 v142, 0
v_mov_b32 v143, 0
v_mov_b32 v144, 0
v_mov_b32 v145, 0
v_mov_b32 v146, 0
v_mov_b32 v147, 0
v_mov_b32 v148, 0
v_mov_b32 v149, 0
v_mov_b32 v150, 0
v_mov_b32 v151, 0
v_mov_b32 v152, 0
v_mov_b32 v153, 0
v_mov_b32 v154, 0
v_mov_b32 v155, 0
v_mov_b32 v156, 0
v_mov_b32 v157, 0
v_mov_b32 v158, 0
v_mov_b32 v159, 0
v_mov_b32 v160, 0
v_mov_b32 v161, 0
v_mov_b32 v162, 0
v_mov_b32 v163, 0
v_mov_b32 v164, 0
v_mov_b32 v165, 0
v_mov_b32 v166, 0
v_mov_b32 v167, 0
v_mov_b32 v168, 0
v_mov_b32 v169, 0
v_mov_b32 v170, 0
v_mov_b32 v171, 0
v_mov_b32 v172, 0
v_mov_b32 v173, 0
v_mov_b32 v174, 0
v_mov_b32 v175, 0
v_mov_b32 v176, 0
v_mov_b32 v177, 0
v_mov_b32 v178, 0
v_mov_b32 v179, 0
v_mov_b32 v180, 0
v_mov_b32 v181, 0
v_mov_b32 v182, 0
v_mov_b32 v183, 0
v_mov_b32 v184, 0
v_mov_b32 v185, 0
v_mov_b32 v186, 0
v_mov_b32 v187, 0
v_mov_b32 v188, 0
v_mov_b32 v189, 0
v_mov_b32 v190, 0
v_mov_b32 v191, 0
v_mov_b32 v192, 0
v_mov_b32 v193, 0
v_mov_b32 v194, 0
v_mov_b32 v195, 0
v_mov_b32 v196, 0
v_mov_b32 v197, 0
v_mov_b32 v198, 0
v_mov_b32 v199, 0
v_mov_b32 v32, 0x3f803f80
v_mov_b32 v33, 0x3f803f80
v_mov_b32 v34, 0x3f803f80
v_mov_b32 v35, 0x3f803f80
s_waitcnt vmcnt(8)
s_barrier
v_add_u32 v8, s28, v11
v_add_u32 v9, s28, v12
v_add_u32 v10, s28, v13
RX 36,8,10240
RX 40,8,12288
RX 44,8,14336
RX 48,8,16384
TR 52,10,256
TR 54,10,4096
TR 56,10,288
TR 58,10,4128
TR 60,10,320
TR 62,10,4160
TR 64,10,32
TR 66,10,3872
TR 68,10,64
TR 70,10,3904
TR 72,10,96
TR 74,10,3936
s_add_u32 m0, s29, 6144
s_nop 0
buffer_load_dwordx4 v2, s[8:11], s30 offen lds
s_add_u32 m0, s29, 14336
s_nop 0
buffer_load_dwordx4 v3, s[8:11], s30 offen lds
s_add_u32 m0, s29, 22528
s_nop 0
buffer_load_dwordx4 v4, s[12:15], s31 offen lds
s_add_u32 m0, s29, 30720
s_nop 0
buffer_load_dwordx4 v5, s[12:15], s31 offen lds
s_add_u32 m0, s29, 38912
s_nop 0
buffer_load_dwordx4 v6, s[12:15], s31 offen lds
s_add_u32 m0, s29, 47104
s_nop 0
buffer_load_dwordx4 v7, s[12:15], s31 offen lds
s_add_u32 s30, s30, s38
s_add_u32 s31, s31, s43
s_add_u32 s29, s29, s39
s_cmp_eq_u32 s29, 147456
s_cselect_b32 s29, 0, s29
s_cmp_eq_u32 s30, 1280
s_cselect_b32 s30, 0, s30
s_cselect_b32 s31, 0, s31
s_cselect_b32 s38, 0, s38
s_cselect_b32 s43, 0, s43
s_cselect_b32 s39, 0, s39
s_cselect_b32 s29, 0x30000, s29
s_cselect_b32 s10, 0, s10
s_cselect_b32 s14, 0, s14
buffer_load_dword v221, v220, s[64:67], s68 offen
s_add_u32 s68, s68, s69
s_add_u32 s74, s74, 1
s_cmp_ge_u32 s74, 10
s_cselect_b32 s66, 0, s66
s_cselect_b32 s68, 0, s68
s_cselect_b32 s69, 0, s69
buffer_load_dword v221, v220, s[64:67], s68 offen
s_add_u32 s68, s68, s69
s_add_u32 s74, s74, 1
s_cmp_ge_u32 s74, 10
s_cselect_b32 s66, 0, s66
s_cselect_b32 s68, 0, s68
s_cselect_b32 s69, 0, s69
s_mov_b32 s27, 0
s_waitcnt lgkmcnt(0)
K1Lffn6:
M 132,52,36
RX 84,9,10240
RX 88,9,12288
M 136,52,40
RX 92,9,14336
RX 96,9,16384
M 140,52,44
TR 100,10,15616
M 144,52,48
TR 102,10,19456
M 148,56,36
TR 104,10,15648
M 152,56,40
TR 106,10,19488
M 156,56,44
TR 108,10,15680
M 160,56,48
TR 110,10,19520
M 164,60,36
TR 112,10,15392
M 168,60,40
TR 114,10,19232
M 172,60,44
TR 116,10,15424
M 176,60,48
TR 118,10,19264
M 180,64,32
TR 120,10,15456
M 184,68,32
TR 122,10,19296
M 188,72,32
s_add_u32 s28, s28, 49152
s_cmp_eq_u32 s28, 147456
s_cselect_b32 s28, 0, s28
M 192,32,44
v_add_u32 v8, s28, v11
v_add_u32 v9, s28, v12
v_add_u32 v10, s28, v13
M 196,44,44
s_cmp_eq_u32 s27, 9
s_cbranch_scc1 K1Effn6
s_waitcnt vmcnt(10) lgkmcnt(0)
s_barrier
M 132,100,84
s_add_u32 m0, s29, 6144
RX 36,8,10240
buffer_load_dwordx4 v2, s[8:11], s30 offen lds
M 136,100,88
s_add_u32 m0, s29, 14336
RX 40,8,12288
buffer_load_dwordx4 v3, s[8:11], s30 offen lds
M 140,100,92
s_add_u32 m0, s29, 22528
RX 44,8,14336
buffer_load_dwordx4 v4, s[12:15], s31 offen lds
M 144,100,96
s_add_u32 m0, s29, 30720
RX 48,8,16384
buffer_load_dwordx4 v5, s[12:15], s31 offen lds
M 148,104,84
s_add_u32 m0, s29, 38912
TR 52,10,256
buffer_load_dwordx4 v6, s[12:15], s31 offen lds
M 152,104,88
s_add_u32 m0, s29, 47104
TR 54,10,4096
buffer_load_dwordx4 v7, s[12:15], s31 offen lds
M 156,104,92
TR 56,10,288
TR 58,10,4128
M 160,104,96
TR 60,10,320
TR 62,10,4160
M 164,108,84
TR 64,10,32
M 168,108,88
TR 66,10,3872
M 172,108,92
TR 68,10,64
M 176,108,96
TR 70,10,3904
M 180,112,32
TR 72,10,96
M 184,116,32
TR 74,10,3936
M 188,120,32
buffer_load_dword v221, v220, s[64:67], s68 offen
s_add_u32 s68, s68, s69
s_add_u32 s74, s74, 1
M 192,32,92
s_cmp_ge_u32 s74, 10
s_cselect_b32 s66, 0, s66
s_cselect_b32 s68, 0, s68
M 196,92,92
s_cselect_b32 s69, 0, s69
buffer_load_dword v221, v220, s[64:67], s68 offen
s_add_u32 s68, s68, s69
s_add_u32 s74, s74, 1
s_cmp_ge_u32 s74, 10
s_cselect_b32 s66, 0, s66
s_cselect_b32 s68, 0, s68
s_cselect_b32 s69, 0, s69
s_add_u32 s30, s30, s38
s_add_u32 s31, s31, s43
s_add_u32 s29, s29, s39
s_cmp_eq_u32 s29, 147456
s_cselect_b32 s29, 0, s29
s_cmp_eq_u32 s30, 1280
s_cselect_b32 s30, 0, s30
s_cselect_b32 s31, 0, s31
s_cselect_b32 s38, 0, s38
s_cselect_b32 s43, 0, s43
s_cselect_b32 s39, 0, s39
s_cselect_b32 s29, 0x30000, s29
s_cselect_b32 s10, 0, s10
s_cselect_b32 s14, 0, s14
s_add_u32 s27, s27, 1
s_waitcnt lgkmcnt(0)
s_branch K1Lffn6
K1Effn6:
s_waitcnt lgkmcnt(0)
M 132,100,84
M 136,100,88
M 140,100,92
M 144,100,96
M 148,104,84
M 152,104,88
M 156,104,92
M 160,104,96
M 164,108,84
M 168,108,88
M 172,108,92
M 176,108,96
M 180,112,32
M 184,116,32
M 188,120,32
M 192,32,92
M 196,92,92
s_waitcnt vmcnt(0)
s_nop 7
s_nop 3
v_and_b32 v14, 15, v1
v_lshrrev_b32 v15, 4, v1
v_lshrrev_b32 v16, 2, v14
v_and_b32 v17, 3, v14
v_cmp_eq_u32 s[46:47], v16, v15
v_cmp_eq_u32 s[48:49], 1, v17
v_cmp_eq_u32 s[54:55], 2, v17
v_cmp_eq_u32 s[56:57], 3, v17
v_lshlrev_b32 v18, 2, v14
v_add_u32 v18, 98304, v18
s_mov_b32 s33, 0x3acccccd
s_mov_b32 s34, 0x3727c5ac
v_cndmask_b32 v196, v196, v197, s[48:49]
v_cndmask_b32 v196, v196, v198, s[54:55]
v_cndmask_b32 v196, v196, v199, s[56:57]
v_mul_f32 v192, s33, v192
v_mul_f32 v196, s33, v196
v_fma_f32 v196, -v192, v192, v196
v_max_f32 v196, 0, v196
v_add_f32 v196, s34, v196
v_rsq_f32 v196, v196
s_mov_b64 exec, s[46:47]
ds_write_b32 v18, v192 offset:448
ds_write_b32 v18, v196 offset:1024
s_mov_b64 exec, -1
v_add_u32 v19, 98304, v1
s_mov_b64 exec, s[44:45]
ds_write_b128 v19, v[180:183] offset:1216
ds_write_b128 v19, v[184:187] offset:1280
ds_write_b128 v19, v[188:191] offset:1344
s_mov_b64 exec, -1
s_waitcnt lgkmcnt(0)
s_barrier
v_and_b32 v14, 15, v1
v_lshlrev_b32 v14, 2, v14
v_lshrrev_b32 v15, 4, v1
v_lshlrev_b32 v15, 4, v15
v_add_u32 v14, 98304, v14
v_add_u32 v15, 98304, v15
ds_read_b32 v36, v14 offset:320
ds_read_b32 v38, v14 offset:896
ds_read_b32 v42, v14 offset:384
ds_read_b32 v44, v14 offset:960
ds_read_b32 v48, v14 offset:448
ds_read_b32 v50, v14 offset:1024
ds_read_b32 v54, v14 offset:512
ds_read_b32 v56, v14 offset:1088
ds_read_b128 v[60:63], v15 offset:1664
ds_read_b128 v[64:67], v15 offset:1728
ds_read_b128 v[68:71], v15 offset:1792
s_waitcnt lgkmcnt(0)
v_mov_b32 v16, 1.0
v_mov_b32 v17, 1.0
s_mov_b32 s33, 0xbfb8aa3b
v_mul_f32 v40, s33, v38
v_mul_f32 v46, s33, v44
v_mul_f32 v52, s33, v50
v_mul_f32 v58, s33, v56
PFN 132,36,60
PFN 134,36,62
PMB 18,40,132
PMB 20,40,134
v_exp_f32 v18, v18
v_exp_f32 v19, v19
v_exp_f32 v20, v20
v_exp_f32 v21, v21
PMB 132,38,132
PMB 134,38,134
PA 18,18,16
PA 20,20,16
v_rcp_f32 v18, v18
v_rcp_f32 v19, v19
v_rcp_f32 v20, v20
v_rcp_f32 v21, v21
s_nop 0
PM 132,132,18
PM 134,134,20
CV 132,132,133
CV 133,134,135
PFN 136,42,60
PFN 138,42,62
PMB 22,46,136
PMB 24,46,138
v_exp_f32 v22, v22
v_exp_f32 v23, v23
v_exp_f32 v24, v24
v_exp_f32 v25, v25
PMB 136,44,136
PMB 138,44,138
PA 22,22,16
PA 24,24,16
v_rcp_f32 v22, v22
v_rcp_f32 v23, v23
v_rcp_f32 v24, v24
v_rcp_f32 v25, v25
s_nop 0
PM 136,136,22
PM 138,138,24
CV 136,136,137
CV 137,138,139
PFN 140,48,60
PFN 142,48,62
PMB 18,52,140
PMB 20,52,142
v_exp_f32 v18, v18
v_exp_f32 v19, v19
v_exp_f32 v20, v20
v_exp_f32 v21, v21
PMB 140,50,140
PMB 142,50,142
PA 18,18,16
PA 20,20,16
v_rcp_f32 v18, v18
v_rcp_f32 v19, v19
v_rcp_f32 v20, v20
v_rcp_f32 v21, v21
s_nop 0
PM 140,140,18
PM 142,142,20
CV 140,140,141
CV 141,142,143
PFN 144,54,60
PFN 146,54,62
PMB 22,58,144
PMB 24,58,146
v_exp_f32 v22, v22
v_exp_f32 v23, v23
v_exp_f32 v24, v24
v_exp_f32 v25, v25
PMB 144,56,144
PMB 146,56,146
PA 22,22,16
PA 24,24,16
v_rcp_f32 v22, v22
v_rcp_f32 v23, v23
v_rcp_f32 v24, v24
v_rcp_f32 v25, v25
s_nop 0
PM 144,144,22
PM 146,146,24
CV 144,144,145
CV 145,146,147
PFN 148,36,64
PFN 150,36,66
PMB 18,40,148
PMB 20,40,150
v_exp_f32 v18, v18
v_exp_f32 v19, v19
v_exp_f32 v20, v20
v_exp_f32 v21, v21
PMB 148,38,148
PMB 150,38,150
PA 18,18,16
PA 20,20,16
v_rcp_f32 v18, v18
v_rcp_f32 v19, v19
v_rcp_f32 v20, v20
v_rcp_f32 v21, v21
s_nop 0
PM 148,148,18
PM 150,150,20
CV 148,148,149
CV 149,150,151
PFN 152,42,64
PFN 154,42,66
PMB 22,46,152
PMB 24,46,154
v_exp_f32 v22, v22
v_exp_f32 v23, v23
v_exp_f32 v24, v24
v_exp_f32 v25, v25
PMB 152,44,152
PMB 154,44,154
PA 22,22,16
PA 24,24,16
v_rcp_f32 v22, v22
v_rcp_f32 v23, v23
v_rcp_f32 v24, v24
v_rcp_f32 v25, v25
s_nop 0
PM 152,152,22
PM 154,154,24
CV 152,152,153
CV 153,154,155
PFN 156,48,64
PFN 158,48,66
PMB 18,52,156
PMB 20,52,158
v_exp_f32 v18, v18
v_exp_f32 v19, v19
v_exp_f32 v20, v20
v_exp_f32 v21, v21
PMB 156,50,156
PMB 158,50,158
PA 18,18,16
PA 20,20,16
v_rcp_f32 v18, v18
v_rcp_f32 v19, v19
v_rcp_f32 v20, v20
v_rcp_f32 v21, v21
s_nop 0
PM 156,156,18
PM 158,158,20
CV 156,156,157
CV 157,158,159
PFN 160,54,64
PFN 162,54,66
PMB 22,58,160
PMB 24,58,162
v_exp_f32 v22, v22
v_exp_f32 v23, v23
v_exp_f32 v24, v24
v_exp_f32 v25, v25
PMB 160,56,160
PMB 162,56,162
PA 22,22,16
PA 24,24,16
v_rcp_f32 v22, v22
v_rcp_f32 v23, v23
v_rcp_f32 v24, v24
v_rcp_f32 v25, v25
s_nop 0
PM 160,160,22
PM 162,162,24
CV 160,160,161
CV 161,162,163
PFN 164,36,68
PFN 166,36,70
PMB 18,40,164
PMB 20,40,166
v_exp_f32 v18, v18
v_exp_f32 v19, v19
v_exp_f32 v20, v20
v_exp_f32 v21, v21
PMB 164,38,164
PMB 166,38,166
PA 18,18,16
PA 20,20,16
v_rcp_f32 v18, v18
v_rcp_f32 v19, v19
v_rcp_f32 v20, v20
v_rcp_f32 v21, v21
s_nop 0
PM 164,164,18
PM 166,166,20
CV 164,164,165
CV 165,166,167
PFN 168,42,68
PFN 170,42,70
PMB 22,46,168
PMB 24,46,170
v_exp_f32 v22, v22
v_exp_f32 v23, v23
v_exp_f32 v24, v24
v_exp_f32 v25, v25
PMB 168,44,168
PMB 170,44,170
PA 22,22,16
PA 24,24,16
v_rcp_f32 v22, v22
v_rcp_f32 v23, v23
v_rcp_f32 v24, v24
v_rcp_f32 v25, v25
s_nop 0
PM 168,168,22
PM 170,170,24
CV 168,168,169
CV 169,170,171
PFN 172,48,68
PFN 174,48,70
PMB 18,52,172
PMB 20,52,174
v_exp_f32 v18, v18
v_exp_f32 v19, v19
v_exp_f32 v20, v20
v_exp_f32 v21, v21
PMB 172,50,172
PMB 174,50,174
PA 18,18,16
PA 20,20,16
v_rcp_f32 v18, v18
v_rcp_f32 v19, v19
v_rcp_f32 v20, v20
v_rcp_f32 v21, v21
s_nop 0
PM 172,172,18
PM 174,174,20
CV 172,172,173
CV 173,174,175
PFN 176,54,68
PFN 178,54,70
PMB 22,58,176
PMB 24,58,178
v_exp_f32 v22, v22
v_exp_f32 v23, v23
v_exp_f32 v24, v24
v_exp_f32 v25, v25
PMB 176,56,176
PMB 178,56,178
PA 22,22,16
PA 24,24,16
v_rcp_f32 v22, v22
v_rcp_f32 v23, v23
v_rcp_f32 v24, v24
v_rcp_f32 v25, v25
s_nop 0
PM 176,176,22
PM 178,178,24
CV 176,176,177
CV 177,178,179
s_mul_i32 s33, s24, 108
s_mul_i32 s34, s25, 7
s_add_u32 s33, s33, s34
s_lshl_b32 s33, s33, 12
v_lshlrev_b32 v14, 4, v1
s_add_u32 s34, s33, 237568
buffer_store_dwordx2 v[132:133], v14, s[16:19], s34 offen
s_add_u32 s34, s33, 238592
buffer_store_dwordx2 v[136:137], v14, s[16:19], s34 offen
s_add_u32 s34, s33, 239616
buffer_store_dwordx2 v[140:141], v14, s[16:19], s34 offen
s_add_u32 s34, s33, 240640
buffer_store_dwordx2 v[144:145], v14, s[16:19], s34 offen
s_add_u32 s34, s33, 237576
buffer_store_dwordx2 v[148:149], v14, s[16:19], s34 offen
s_add_u32 s34, s33, 238600
buffer_store_dwordx2 v[152:153], v14, s[16:19], s34 offen
s_add_u32 s34, s33, 239624
buffer_store_dwordx2 v[156:157], v14, s[16:19], s34 offen
s_add_u32 s34, s33, 240648
buffer_store_dwordx2 v[160:161], v14, s[16:19], s34 offen
s_cmp_eq_u32 s25, 7
s_cbranch_scc1 SK34
s_add_u32 s34, s33, 241664
buffer_store_dwordx2 v[164:165], v14, s[16:19], s34 offen
s_add_u32 s34, s33, 242688
buffer_store_dwordx2 v[168:169], v14, s[16:19], s34 offen
s_add_u32 s34, s33, 243712
buffer_store_dwordx2 v[172:173], v14, s[16:19], s34 offen
s_add_u32 s34, s33, 244736
buffer_store_dwordx2 v[176:177], v14, s[16:19], s34 offen
SK34:
s_endpgm
K1_FFN7:
v_lshrrev_b32 v14, 3, v1
v_and_b32 v15, 7, v1
v_xor_b32 v15, v15, v14
v_lshlrev_b32 v15, 4, v15
s_mov_b32 s30, 0
s_mov_b32 s31, 0
s_mov_b32 s29, 0
s_mov_b32 s28, 0
s_mov_b32 s43, 221184
s_mov_b32 s38, 128
s_mov_b32 s39, 49152
s_add_i32 s33, s32, 56
v_add_u32 v2, s33, v14
v_max_i32 v2, 0, v2
v_mul_u32_u24 v2, 1280, v2
v_add_u32 v2, v2, v15
s_waitcnt lgkmcnt(0)
s_mov_b32 s8, s4
s_mov_b32 s9, s5
s_mov_b32 s52, s62
s_mov_b32 s53, s63
s_mov_b32 s12, s60
s_mov_b32 s13, s61
s_add_u32 m0, s29, 7168
s_nop 0
buffer_load_dwordx4 v2, s[8:11], s30 offen lds
s_add_i32 s33, s32, 120
v_add_u32 v3, s33, v14
v_max_i32 v3, 0, v3
v_mul_u32_u24 v3, 1280, v3
v_add_u32 v3, v3, v15
s_add_u32 m0, s29, 15360
s_nop 0
buffer_load_dwordx4 v3, s[8:11], s30 offen lds
v_add_u32 v16, 320, v1
v_mul_u32_u24 v17, 2185, v16
v_lshrrev_b32 v17, 16, v17
v_mul_u32_u24 v18, 30, v17
v_sub_u32 v18, v16, v18
v_and_b32 v19, 0x33, v17
v_and_b32 v20, 4, v17
v_lshl_or_b32 v19, v20, 1, v19
v_bfe_u32 v20, v17, 3, 1
v_lshl_or_b32 v19, v20, 2, v19
v_lshlrev_b32 v18, 4, v18
v_mul_u32_u24 v4, 3456, v19
v_add3_u32 v4, v4, v18, s36
s_add_u32 m0, s29, 23552
s_nop 0
buffer_load_dwordx4 v4, s[12:15], s31 offen lds
v_add_u32 v16, 832, v1
v_mul_u32_u24 v17, 2185, v16
v_lshrrev_b32 v17, 16, v17
v_mul_u32_u24 v18, 30, v17
v_sub_u32 v18, v16, v18
v_and_b32 v19, 0x33, v17
v_and_b32 v20, 4, v17
v_lshl_or_b32 v19, v20, 1, v19
v_bfe_u32 v20, v17, 3, 1
v_lshl_or_b32 v19, v20, 2, v19
v_lshlrev_b32 v18, 4, v18
v_mul_u32_u24 v5, 3456, v19
v_add3_u32 v5, v5, v18, s36
s_add_u32 m0, s29, 31744
s_nop 0
buffer_load_dwordx4 v5, s[12:15], s31 offen lds
v_add_u32 v16, 1344, v1
v_mul_u32_u24 v17, 2185, v16
v_lshrrev_b32 v17, 16, v17
v_mul_u32_u24 v18, 30, v17
v_sub_u32 v18, v16, v18
v_and_b32 v19, 0x33, v17
v_and_b32 v20, 4, v17
v_lshl_or_b32 v19, v20, 1, v19
v_bfe_u32 v20, v17, 3, 1
v_lshl_or_b32 v19, v20, 2, v19
v_lshlrev_b32 v18, 4, v18
v_mul_u32_u24 v6, 3456, v19
v_add3_u32 v6, v6, v18, s36
s_add_u32 m0, s29, 39936
s_nop 0
buffer_load_dwordx4 v6, s[12:15], s31 offen lds
v_add_u32 v16, 1856, v1
v_mul_u32_u24 v17, 2185, v16
v_lshrrev_b32 v17, 16, v17
v_mul_u32_u24 v18, 30, v17
v_sub_u32 v18, v16, v18
v_and_b32 v19, 0x33, v17
v_and_b32 v20, 4, v17
v_lshl_or_b32 v19, v20, 1, v19
v_bfe_u32 v20, v17, 3, 1
v_lshl_or_b32 v19, v20, 2, v19
v_lshlrev_b32 v18, 4, v18
v_mul_u32_u24 v7, 3456, v19
v_add3_u32 v7, v7, v18, s36
s_add_u32 m0, s29, 48128
s_nop 0
buffer_load_dwordx4 v7, s[12:15], s31 offen lds
s_add_u32 s30, s30, s38
s_add_u32 s31, s31, s43
s_add_u32 s29, s29, s39
s_cmp_eq_u32 s29, 147456
s_cselect_b32 s29, 0, s29
s_cmp_eq_u32 s30, 1280
s_cselect_b32 s30, 0, s30
s_cselect_b32 s31, 0, s31
s_cselect_b32 s38, 0, s38
s_cselect_b32 s43, 0, s43
s_cselect_b32 s39, 0, s39
s_cselect_b32 s29, 0x30000, s29
s_cselect_b32 s10, 0, s10
s_cselect_b32 s14, 0, s14
s_add_u32 m0, s29, 7168
s_nop 0
buffer_load_dwordx4 v2, s[8:11], s30 offen lds
s_add_u32 m0, s29, 15360
s_nop 0
buffer_load_dwordx4 v3, s[8:11], s30 offen lds
s_add_u32 m0, s29, 23552
s_nop 0
buffer_load_dwordx4 v4, s[12:15], s31 offen lds
s_add_u32 m0, s29, 31744
s_nop 0
buffer_load_dwordx4 v5, s[12:15], s31 offen lds
s_add_u32 m0, s29, 39936
s_nop 0
buffer_load_dwordx4 v6, s[12:15], s31 offen lds
s_add_u32 m0, s29, 48128
s_nop 0
buffer_load_dwordx4 v7, s[12:15], s31 offen lds
s_add_u32 s30, s30, s38
s_add_u32 s31, s31, s43
s_add_u32 s29, s29, s39
s_cmp_eq_u32 s29, 147456
s_cselect_b32 s29, 0, s29
s_cmp_eq_u32 s30, 1280
s_cselect_b32 s30, 0, s30
s_cselect_b32 s31, 0, s31
s_cselect_b32 s38, 0, s38
s_cselect_b32 s43, 0, s43
s_cselect_b32 s39, 0, s39
s_cselect_b32 s29, 0x30000, s29
s_cselect_b32 s10, 0, s10
s_cselect_b32 s14, 0, s14
v_and_b32 v14, 15, v1
v_lshrrev_b32 v15, 4, v1
v_and_b32 v16, 7, v14
v_xor_b32 v16, v16, v15
v_lshlrev_b32 v16, 4, v16
v_lshl_add_u32 v11, v14, 7, v16
v_xor_b32 v12, 64, v11
v_cmp_eq_u32 s[44:45], 0, v14
v_lshrrev_b32 v16, 1, v15
v_lshlrev_b32 v16, 4, v16
v_and_b32 v17, 1, v15
v_lshl_add_u32 v16, v17, 2, v16
v_bfe_u32 v17, v1, 2, 2
v_add_u32 v16, v16, v17
v_mul_u32_u24 v16, 480, v16
v_and_b32 v17, 3, v1
v_lshl_add_u32 v16, v17, 3, v16
v_add_u32 v13, 18432, v16
v_mov_b32 v132, 0
v_mov_b32 v133, 0
v_mov_b32 v134, 0
v_mov_b32 v135, 0
v_mov_b32 v136, 0
v_mov_b32 v137, 0
v_mov_b32 v138, 0
v_mov_b32 v139, 0
v_mov_b32 v140, 0
v_mov_b32 v141, 0
v_mov_b32 v142, 0
v_mov_b32 v143, 0
v_mov_b32 v144, 0
v_mov_b32 v145, 0
v_mov_b32 v146, 0
v_mov_b32 v147, 0
v_mov_b32 v148, 0
v_mov_b32 v149, 0
v_mov_b32 v150, 0
v_mov_b32 v151, 0
v_mov_b32 v152, 0
v_mov_b32 v153, 0
v_mov_b32 v154, 0
v_mov_b32 v155, 0
v_mov_b32 v156, 0
v_mov_b32 v157, 0
v_mov_b32 v158, 0
v_mov_b32 v159, 0
v_mov_b32 v160, 0
v_mov_b32 v161, 0
v_mov_b32 v162, 0
v_mov_b32 v163, 0
v_mov_b32 v164, 0
v_mov_b32 v165, 0
v_mov_b32 v166, 0
v_mov_b32 v167, 0
v_mov_b32 v168, 0
v_mov_b32 v169, 0
v_mov_b32 v170, 0
v_mov_b32 v171, 0
v_mov_b32 v172, 0
v_mov_b32 v173, 0
v_mov_b32 v174, 0
v_mov_b32 v175, 0
v_mov_b32 v176, 0
v_mov_b32 v177, 0
v_mov_b32 v178, 0
v_mov_b32 v179, 0
v_mov_b32 v180, 0
v_mov_b32 v181, 0
v_mov_b32 v182, 0
v_mov_b32 v183, 0
v_mov_b32 v184, 0
v_mov_b32 v185, 0
v_mov_b32 v186, 0
v_mov_b32 v187, 0
v_mov_b32 v188, 0
v_mov_b32 v189, 0
v_mov_b32 v190, 0
v_mov_b32 v191, 0
v_mov_b32 v192, 0
v_mov_b32 v193, 0
v_mov_b32 v194, 0
v_mov_b32 v195, 0
v_mov_b32 v196, 0
v_mov_b32 v197, 0
v_mov_b32 v198, 0
v_mov_b32 v199, 0
v_mov_b32 v32, 0x3f803f80
v_mov_b32 v33, 0x3f803f80
v_mov_b32 v34, 0x3f803f80
v_mov_b32 v35, 0x3f803f80
s_waitcnt vmcnt(6)
s_barrier
v_add_u32 v8, s28, v11
v_add_u32 v9, s28, v12
v_add_u32 v10, s28, v13
RX 36,8,10240
RX 40,8,12288
RX 44,8,14336
RX 48,8,16384
TR 52,10,352
TR 54,10,4192
TR 56,10,384
TR 58,10,4224
TR 60,10,416
TR 62,10,4256
TR 64,10,160
TR 66,10,4000
TR 68,10,192
TR 70,10,4032
TR 72,10,224
TR 74,10,4064
s_add_u32 m0, s29, 7168
s_nop 0
buffer_load_dwordx4 v2, s[8:11], s30 offen lds
s_add_u32 m0, s29, 15360
s_nop 0
buffer_load_dwordx4 v3, s[8:11], s30 offen lds
s_add_u32 m0, s29, 23552
s_nop 0
buffer_load_dwordx4 v4, s[12:15], s31 offen lds
s_add_u32 m0, s29, 31744
s_nop 0
buffer_load_dwordx4 v5, s[12:15], s31 offen lds
s_add_u32 m0, s29, 39936
s_nop 0
buffer_load_dwordx4 v6, s[12:15], s31 offen lds
s_add_u32 m0, s29, 48128
s_nop 0
buffer_load_dwordx4 v7, s[12:15], s31 offen lds
s_add_u32 s30, s30, s38
s_add_u32 s31, s31, s43
s_add_u32 s29, s29, s39
s_cmp_eq_u32 s29, 147456
s_cselect_b32 s29, 0, s29
s_cmp_eq_u32 s30, 1280
s_cselect_b32 s30, 0, s30
s_cselect_b32 s31, 0, s31
s_cselect_b32 s38, 0, s38
s_cselect_b32 s43, 0, s43
s_cselect_b32 s39, 0, s39
s_cselect_b32 s29, 0x30000, s29
s_cselect_b32 s10, 0, s10
s_cselect_b32 s14, 0, s14
s_mov_b32 s27, 0
s_waitcnt lgkmcnt(0)
K1Lffn7:
M 132,52,36
RX 84,9,10240
RX 88,9,12288
M 136,52,40
RX 92,9,14336
RX 96,9,16384
M 140,52,44
TR 100,10,15712
M 144,52,48
TR 102,10,19552
M 148,56,36
TR 104,10,15744
M 152,56,40
TR 106,10,19584
M 156,56,44
TR 108,10,15776
M 160,56,48
TR 110,10,19616
M 164,60,36
TR 112,10,15520
M 168,60,40
TR 114,10,19360
M 172,60,44
TR 116,10,15552
M 176,60,48
TR 118,10,19392
M 180,64,32
TR 120,10,15584
M 184,68,32
TR 122,10,19424
M 188,72,32
s_add_u32 s28, s28, 49152
s_cmp_eq_u32 s28, 147456
s_cselect_b32 s28, 0, s28
M 192,32,48
v_add_u32 v8, s28, v11
v_add_u32 v9, s28, v12
v_add_u32 v10, s28, v13
M 196,48,48
s_cmp_eq_u32 s27, 9
s_cbranch_scc1 K1Effn7
s_waitcnt vmcnt(6) lgkmcnt(0)
s_barrier
M 132,100,84
s_add_u32 m0, s29, 7168
RX 36,8,10240
buffer_load_dwordx4 v2, s[8:11], s30 offen lds
M 136,100,88
s_add_u32 m0, s29, 15360
RX 40,8,12288
buffer_load_dwordx4 v3, s[8:11], s30 offen lds
M 140,100,92
s_add_u32 m0, s29, 23552
RX 44,8,14336
buffer_load_dwordx4 v4, s[12:15], s31 offen lds
M 144,100,96
s_add_u32 m0, s29, 31744
RX 48,8,16384
buffer_load_dwordx4 v5, s[12:15], s31 offen lds
M 148,104,84
s_add_u32 m0, s29, 39936
TR 52,10,352
buffer_load_dwordx4 v6, s[12:15], s31 offen lds
M 152,104,88
s_add_u32 m0, s29, 48128
TR 54,10,4192
buffer_load_dwordx4 v7, s[12:15], s31 offen lds
M 156,104,92
TR 56,10,384
TR 58,10,4224
M 160,104,96
TR 60,10,416
TR 62,10,4256
M 164,108,84
TR 64,10,160
M 168,108,88
TR 66,10,4000
M 172,108,92
TR 68,10,192
M 176,108,96
TR 70,10,4032
M 180,112,32
TR 72,10,224
M 184,116,32
TR 74,10,4064
M 188,120,32
s_add_u32 s30, s30, s38
s_add_u32 s31, s31, s43
s_add_u32 s29, s29, s39
M 192,32,96
s_cmp_eq_u32 s29, 147456
s_cselect_b32 s29, 0, s29
s_cmp_eq_u32 s30, 1280
M 196,96,96
s_cselect_b32 s30, 0, s30
s_cselect_b32 s31, 0, s31
s_cselect_b32 s38, 0, s38
s_cselect_b32 s43, 0, s43
s_cselect_b32 s39, 0, s39
s_cselect_b32 s29, 0x30000, s29
s_cselect_b32 s10, 0, s10
s_cselect_b32 s14, 0, s14
s_add_u32 s27, s27, 1
s_waitcnt lgkmcnt(0)
s_branch K1Lffn7
K1Effn7:
s_waitcnt lgkmcnt(0)
M 132,100,84
M 136,100,88
M 140,100,92
M 144,100,96
M 148,104,84
M 152,104,88
M 156,104,92
M 160,104,96
M 164,108,84
M 168,108,88
M 172,108,92
M 176,108,96
M 180,112,32
M 184,116,32
M 188,120,32
M 192,32,96
M 196,96,96
s_waitcnt vmcnt(0)
s_nop 7
s_nop 3
v_and_b32 v14, 15, v1
v_lshrrev_b32 v15, 4, v1
v_lshrrev_b32 v16, 2, v14
v_and_b32 v17, 3, v14
v_cmp_eq_u32 s[46:47], v16, v15
v_cmp_eq_u32 s[48:49], 1, v17
v_cmp_eq_u32 s[54:55], 2, v17
v_cmp_eq_u32 s[56:57], 3, v17
v_lshlrev_b32 v18, 2, v14
v_add_u32 v18, 98304, v18
s_mov_b32 s33, 0x3acccccd
s_mov_b32 s34, 0x3727c5ac
v_cndmask_b32 v196, v196, v197, s[48:49]
v_cndmask_b32 v196, v196, v198, s[54:55]
v_cndmask_b32 v196, v196, v199, s[56:57]
v_mul_f32 v192, s33, v192
v_mul_f32 v196, s33, v196
v_fma_f32 v196, -v192, v192, v196
v_max_f32 v196, 0, v196
v_add_f32 v196, s34, v196
v_rsq_f32 v196, v196
s_mov_b64 exec, s[46:47]
ds_write_b32 v18, v192 offset:512
ds_write_b32 v18, v196 offset:1088
s_mov_b64 exec, -1
v_add_u32 v19, 98304, v1
s_mov_b64 exec, s[44:45]
ds_write_b128 v19, v[180:183] offset:1472
ds_write_b128 v19, v[184:187] offset:1536
ds_write_b128 v19, v[188:191] offset:1600
s_mov_b64 exec, -1
s_waitcnt lgkmcnt(0)
s_barrier
v_and_b32 v14, 15, v1
v_lshlrev_b32 v14, 2, v14
v_lshrrev_b32 v15, 4, v1
v_lshlrev_b32 v15, 4, v15
v_add_u32 v14, 98304, v14
v_add_u32 v15, 98304, v15
ds_read_b32 v36, v14 offset:320
ds_read_b32 v38, v14 offset:896
ds_read_b32 v42, v14 offset:384
ds_read_b32 v44, v14 offset:960
ds_read_b32 v48, v14 offset:448
ds_read_b32 v50, v14 offset:1024
ds_read_b32 v54, v14 offset:512
ds_read_b32 v56, v14 offset:1088
ds_read_b128 v[60:63], v15 offset:1856
ds_read_b128 v[64:67], v15 offset:1920
ds_read_b128 v[68:71], v15 offset:1984
s_waitcnt lgkmcnt(0)
v_mov_b32 v16, 1.0
v_mov_b32 v17, 1.0
s_mov_b32 s33, 0xbfb8aa3b
v_mul_f32 v40, s33, v38
v_mul_f32 v46, s33, v44
v_mul_f32 v52, s33, v50
v_mul_f32 v58, s33, v56
PFN 132,36,60
PFN 134,36,62
PMB 18,40,132
PMB 20,40,134
v_exp_f32 v18, v18
v_exp_f32 v19, v19
v_exp_f32 v20, v20
v_exp_f32 v21, v21
PMB 132,38,132
PMB 134,38,134
PA 18,18,16
PA 20,20,16
v_rcp_f32 v18, v18
v_rcp_f32 v19, v19
v_rcp_f32 v20, v20
v_rcp_f32 v21, v21
s_nop 0
PM 132,132,18
PM 134,134,20
CV 132,132,133
CV 133,134,135
PFN 136,42,60
PFN 138,42,62
PMB 22,46,136
PMB 24,46,138
v_exp_f32 v22, v22
v_exp_f32 v23, v23
v_exp_f32 v24, v24
v_exp_f32 v25, v25
PMB 136,44,136
PMB 138,44,138
PA 22,22,16
PA 24,24,16
v_rcp_f32 v22, v22
v_rcp_f32 v23, v23
v_rcp_f32 v24, v24
v_rcp_f32 v25, v25
s_nop 0
PM 136,136,22
PM 138,138,24
CV 136,136,137
CV 137,138,139
PFN 140,48,60
PFN 142,48,62
PMB 18,52,140
PMB 20,52,142
v_exp_f32 v18, v18
v_exp_f32 v19, v19
v_exp_f32 v20, v20
v_exp_f32 v21, v21
PMB 140,50,140
PMB 142,50,142
PA 18,18,16
PA 20,20,16
v_rcp_f32 v18, v18
v_rcp_f32 v19, v19
v_rcp_f32 v20, v20
v_rcp_f32 v21, v21
s_nop 0
PM 140,140,18
PM 142,142,20
CV 140,140,141
CV 141,142,143
PFN 144,54,60
PFN 146,54,62
PMB 22,58,144
PMB 24,58,146
v_exp_f32 v22, v22
v_exp_f32 v23, v23
v_exp_f32 v24, v24
v_exp_f32 v25, v25
PMB 144,56,144
PMB 146,56,146
PA 22,22,16
PA 24,24,16
v_rcp_f32 v22, v22
v_rcp_f32 v23, v23
v_rcp_f32 v24, v24
v_rcp_f32 v25, v25
s_nop 0
PM 144,144,22
PM 146,146,24
CV 144,144,145
CV 145,146,147
PFN 148,36,64
PFN 150,36,66
PMB 18,40,148
PMB 20,40,150
v_exp_f32 v18, v18
v_exp_f32 v19, v19
v_exp_f32 v20, v20
v_exp_f32 v21, v21
PMB 148,38,148
PMB 150,38,150
PA 18,18,16
PA 20,20,16
v_rcp_f32 v18, v18
v_rcp_f32 v19, v19
v_rcp_f32 v20, v20
v_rcp_f32 v21, v21
s_nop 0
PM 148,148,18
PM 150,150,20
CV 148,148,149
CV 149,150,151
PFN 152,42,64
PFN 154,42,66
PMB 22,46,152
PMB 24,46,154
v_exp_f32 v22, v22
v_exp_f32 v23, v23
v_exp_f32 v24, v24
v_exp_f32 v25, v25
PMB 152,44,152
PMB 154,44,154
PA 22,22,16
PA 24,24,16
v_rcp_f32 v22, v22
v_rcp_f32 v23, v23
v_rcp_f32 v24, v24
v_rcp_f32 v25, v25
s_nop 0
PM 152,152,22
PM 154,154,24
CV 152,152,153
CV 153,154,155
PFN 156,48,64
PFN 158,48,66
PMB 18,52,156
PMB 20,52,158
v_exp_f32 v18, v18
v_exp_f32 v19, v19
v_exp_f32 v20, v20
v_exp_f32 v21, v21
PMB 156,50,156
PMB 158,50,158
PA 18,18,16
PA 20,20,16
v_rcp_f32 v18, v18
v_rcp_f32 v19, v19
v_rcp_f32 v20, v20
v_rcp_f32 v21, v21
s_nop 0
PM 156,156,18
PM 158,158,20
CV 156,156,157
CV 157,158,159
PFN 160,54,64
PFN 162,54,66
PMB 22,58,160
PMB 24,58,162
v_exp_f32 v22, v22
v_exp_f32 v23, v23
v_exp_f32 v24, v24
v_exp_f32 v25, v25
PMB 160,56,160
PMB 162,56,162
PA 22,22,16
PA 24,24,16
v_rcp_f32 v22, v22
v_rcp_f32 v23, v23
v_rcp_f32 v24, v24
v_rcp_f32 v25, v25
s_nop 0
PM 160,160,22
PM 162,162,24
CV 160,160,161
CV 161,162,163
PFN 164,36,68
PFN 166,36,70
PMB 18,40,164
PMB 20,40,166
v_exp_f32 v18, v18
v_exp_f32 v19, v19
v_exp_f32 v20, v20
v_exp_f32 v21, v21
PMB 164,38,164
PMB 166,38,166
PA 18,18,16
PA 20,20,16
v_rcp_f32 v18, v18
v_rcp_f32 v19, v19
v_rcp_f32 v20, v20
v_rcp_f32 v21, v21
s_nop 0
PM 164,164,18
PM 166,166,20
CV 164,164,165
CV 165,166,167
PFN 168,42,68
PFN 170,42,70
PMB 22,46,168
PMB 24,46,170
v_exp_f32 v22, v22
v_exp_f32 v23, v23
v_exp_f32 v24, v24
v_exp_f32 v25, v25
PMB 168,44,168
PMB 170,44,170
PA 22,22,16
PA 24,24,16
v_rcp_f32 v22, v22
v_rcp_f32 v23, v23
v_rcp_f32 v24, v24
v_rcp_f32 v25, v25
s_nop 0
PM 168,168,22
PM 170,170,24
CV 168,168,169
CV 169,170,171
PFN 172,48,68
PFN 174,48,70
PMB 18,52,172
PMB 20,52,174
v_exp_f32 v18, v18
v_exp_f32 v19, v19
v_exp_f32 v20, v20
v_exp_f32 v21, v21
PMB 172,50,172
PMB 174,50,174
PA 18,18,16
PA 20,20,16
v_rcp_f32 v18, v18
v_rcp_f32 v19, v19
v_rcp_f32 v20, v20
v_rcp_f32 v21, v21
s_nop 0
PM 172,172,18
PM 174,174,20
CV 172,172,173
CV 173,174,175
PFN 176,54,68
PFN 178,54,70
PMB 22,58,176
PMB 24,58,178
v_exp_f32 v22, v22
v_exp_f32 v23, v23
v_exp_f32 v24, v24
v_exp_f32 v25, v25
PMB 176,56,176
PMB 178,56,178
PA 22,22,16
PA 24,24,16
v_rcp_f32 v22, v22
v_rcp_f32 v23, v23
v_rcp_f32 v24, v24
v_rcp_f32 v25, v25
s_nop 0
PM 176,176,22
PM 178,178,24
CV 176,176,177
CV 177,178,179
s_mul_i32 s33, s24, 108
s_mul_i32 s34, s25, 7
s_add_u32 s33, s33, s34
s_lshl_b32 s33, s33, 12
v_lshlrev_b32 v14, 4, v1
s_cmp_eq_u32 s25, 7
s_cbranch_scc1 SK35
s_add_u32 s34, s33, 241672
buffer_store_dwordx2 v[132:133], v14, s[16:19], s34 offen
s_add_u32 s34, s33, 242696
buffer_store_dwordx2 v[136:137], v14, s[16:19], s34 offen
s_add_u32 s34, s33, 243720
buffer_store_dwordx2 v[140:141], v14, s[16:19], s34 offen
s_add_u32 s34, s33, 244744
buffer_store_dwordx2 v[144:145], v14, s[16:19], s34 offen
s_add_u32 s34, s33, 245760
buffer_store_dwordx2 v[148:149], v14, s[16:19], s34 offen
s_add_u32 s34, s33, 246784
buffer_store_dwordx2 v[152:153], v14, s[16:19], s34 offen
s_add_u32 s34, s33, 247808
buffer_store_dwordx2 v[156:157], v14, s[16:19], s34 offen
s_add_u32 s34, s33, 248832
buffer_store_dwordx2 v[160:161], v14, s[16:19], s34 offen
s_add_u32 s34, s33, 245768
buffer_store_dwordx2 v[164:165], v14, s[16:19], s34 offen
s_add_u32 s34, s33, 246792
buffer_store_dwordx2 v[168:169], v14, s[16:19], s34 offen
s_add_u32 s34, s33, 247816
buffer_store_dwordx2 v[172:173], v14, s[16:19], s34 offen
s_add_u32 s34, s33, 248840
buffer_store_dwordx2 v[176:177], v14, s[16:19], s34 offen
SK35:
s_endpgm
.globl k2_out_kernel
.p2align 8
.type k2_out_kernel,@function
k2_out_kernel:
s_cmp_ge_u32 s2, 256
s_cbranch_scc1 K2_EXIT
s_load_dwordx2 s[12:13], s[0:1], 0
s_load_dwordx2 s[16:17], s[0:1], 48
s_load_dwordx2 s[8:9], s[0:1], 64
s_and_b32 s20, s2, 7
s_lshr_b32 s21, s2, 3
s_lshr_b32 s22, s20, 1
s_lshl_b32 s24, s22, 3
s_and_b32 s22, s21, 7
s_add_u32 s24, s24, s22
s_and_b32 s22, s20, 1
s_lshl_b32 s25, s22, 2
s_lshr_b32 s22, s21, 3
s_add_u32 s25, s25, s22
v_lshrrev_b32 v2, 6, v0
v_and_b32 v1, 63, v0
s_mov_b32 s10, 14680064
v_readfirstlane_b32 s26, v2
s_mov_b32 s11, 0x00020000
s_mov_b32 s14, 2621440
s_mov_b32 s15, 0x00020000
s_mov_b32 s18, 2621440
s_mov_b32 s19, 0x00020000
v_lshlrev_b32 v2, 4, v1
v_add_u32 v3, 4096, v2
v_and_b32 v4, 15, v1
v_lshrrev_b32 v5, 4, v1
s_lshl_b32 s27, s24, 6
s_lshl_b32 s28, s26, 4
s_add_u32 s27, s27, s28
v_add_u32 v4, s27, v4
v_mul_u32_u24 v4, 1280, v4
v_lshlrev_b32 v5, 3, v5
s_mul_i32 s28, s25, 160
v_add3_u32 v4, v4, v5, s28
s_cmp_eq_u32 s26, 0
s_cbranch_scc1 K2_S
s_mul_i32 s28, s24, 54
s_sub_u32 s29, s26, 1
s_mul_i32 s29, s29, 18
s_add_u32 s28, s28, s29
s_lshl_b32 s30, s28, 12
s_mul_i32 s28, s25, 54
s_add_u32 s28, s28, s29
s_mul_i32 s31, s28, 5120
s_add_u32 s31, s31, 10485760
s_waitcnt lgkmcnt(0)
buffer_load_dwordx4 v[100:103], v2, s[8:11], s30 offen offset:0
buffer_load_dwordx4 v[104:107], v2, s[8:11], s30 offen offset:1024
buffer_load_dwordx4 v[108:111], v2, s[8:11], s30 offen offset:2048
buffer_load_dwordx4 v[112:115], v2, s[8:11], s30 offen offset:3072
buffer_load_dwordx4 v[116:119], v2, s[8:11], s31 offen offset:0
buffer_load_dwordx4 v[120:123], v2, s[8:11], s31 offen offset:1024
buffer_load_dwordx4 v[124:127], v2, s[8:11], s31 offen offset:2048
buffer_load_dwordx4 v[128:131], v2, s[8:11], s31 offen offset:3072
buffer_load_dwordx4 v[132:135], v3, s[8:11], s31 offen
s_add_u32 s30, s30, 4096
s_add_u32 s31, s31, 5120
buffer_load_dwordx4 v[136:139], v2, s[8:11], s30 offen offset:0
buffer_load_dwordx4 v[140:143], v2, s[8:11], s30 offen offset:1024
buffer_load_dwordx4 v[144:147], v2, s[8:11], s30 offen offset:2048
buffer_load_dwordx4 v[148:151], v2, s[8:11], s30 offen offset:3072
buffer_load_dwordx4 v[152:155], v2, s[8:11], s31 offen offset:0
buffer_load_dwordx4 v[156:159], v2, s[8:11], s31 offen offset:1024
buffer_load_dwordx4 v[160:163], v2, s[8:11], s31 offen offset:2048
buffer_load_dwordx4 v[164:167], v2, s[8:11], s31 offen offset:3072
buffer_load_dwordx4 v[168:171], v3, s[8:11], s31 offen
s_add_u32 s30, s30, 4096
s_add_u32 s31, s31, 5120
buffer_load_dwordx4 v[172:175], v2, s[8:11], s30 offen offset:0
buffer_load_dwordx4 v[176:179], v2, s[8:11], s30 offen offset:1024
buffer_load_dwordx4 v[180:183], v2, s[8:11], s30 offen offset:2048
buffer_load_dwordx4 v[184:187], v2, s[8:11], s30 offen offset:3072
buffer_load_dwordx4 v[188:191], v2, s[8:11], s31 offen offset:0
buffer_load_dwordx4 v[192:195], v2, s[8:11], s31 offen offset:1024
buffer_load_dwordx4 v[196:199], v2, s[8:11], s31 offen offset:2048
buffer_load_dwordx4 v[200:203], v2, s[8:11], s31 offen offset:3072
buffer_load_dwordx4 v[204:207], v3, s[8:11], s31 offen
s_add_u32 s30, s30, 4096
s_add_u32 s31, s31, 5120
buffer_load_dwordx2 v[8:9], v4, s[12:15], 0 offen offset:0
buffer_load_dwordx2 v[10:11], v4, s[12:15], 0 offen offset:32
buffer_load_dwordx2 v[12:13], v4, s[12:15], 0 offen offset:64
buffer_load_dwordx2 v[14:15], v4, s[12:15], 0 offen offset:96
buffer_load_dwordx2 v[16:17], v4, s[12:15], 0 offen offset:128
buffer_load_dwordx4 v[208:211], v2, s[8:11], s30 offen offset:0
buffer_load_dwordx4 v[212:215], v2, s[8:11], s30 offen offset:1024
buffer_load_dwordx4 v[216:219], v2, s[8:11], s30 offen offset:2048
buffer_load_dwordx4 v[220:223], v2, s[8:11], s30 offen offset:3072
buffer_load_dwordx4 v[224:227], v2, s[8:11], s31 offen offset:0
buffer_load_dwordx4 v[228:231], v2, s[8:11], s31 offen offset:1024
buffer_load_dwordx4 v[232:235], v2, s[8:11], s31 offen offset:2048
buffer_load_dwordx4 v[236:239], v2, s[8:11], s31 offen offset:3072
buffer_load_dwordx4 v[240:243], v3, s[8:11], s31 offen
s_add_u32 s30, s30, 4096
s_add_u32 s31, s31, 5120
s_waitcnt vmcnt(32)
MZ 20,116,100
MZ 40,116,104
MZ 60,116,108
MZ 80,116,112
MZ 24,120,100
MZ 44,120,104
MZ 64,120,108
MZ 84,120,112
MZ 28,124,100
MZ 48,124,104
MZ 68,124,108
MZ 88,124,112
MZ 32,128,100
MZ 52,128,104
MZ 72,128,108
MZ 92,128,112
MZ 36,132,100
MZ 56,132,104
MZ 76,132,108
MZ 96,132,112
buffer_load_dwordx4 v[100:103], v2, s[8:11], s30 offen offset:0
buffer_load_dwordx4 v[104:107], v2, s[8:11], s30 offen offset:1024
buffer_load_dwordx4 v[108:111], v2, s[8:11], s30 offen offset:2048
buffer_load_dwordx4 v[112:115], v2, s[8:11], s30 offen offset:3072
buffer_load_dwordx4 v[116:119], v2, s[8:11], s31 offen offset:0
buffer_load_dwordx4 v[120:123], v2, s[8:11], s31 offen offset:1024
buffer_load_dwordx4 v[124:127], v2, s[8:11], s31 offen offset:2048
buffer_load_dwordx4 v[128:131], v2, s[8:11], s31 offen offset:3072
buffer_load_dwordx4 v[132:135], v3, s[8:11], s31 offen
s_add_u32 s30, s30, 4096
s_add_u32 s31, s31, 5120
s_waitcnt vmcnt(32)
M 20,152,136
M 40,152,140
M 60,152,144
M 80,152,148
M 24,156,136
M 44,156,140
M 64,156,144
M 84,156,148
M 28,160,136
M 48,160,140
M 68,160,144
M 88,160,148
M 32,164,136
M 52,164,140
M 72,164,144
M 92,164,148
M 36,168,136
M 56,168,140
M 76,168,144
M 96,168,148
buffer_load_dwordx4 v[136:139], v2, s[8:11], s30 offen offset:0
buffer_load_dwordx4 v[140:143], v2, s[8:11], s30 offen offset:1024
buffer_load_dwordx4 v[144:147], v2, s[8:11], s30 offen offset:2048
buffer_load_dwordx4 v[148:151], v2, s[8:11], s30 offen offset:3072
buffer_load_dwordx4 v[152:155], v2, s[8:11], s31 offen offset:0
buffer_load_dwordx4 v[156:159], v2, s[8:11], s31 offen offset:1024
buffer_load_dwordx4 v[160:163], v2, s[8:11], s31 offen offset:2048
buffer_load_dwordx4 v[164:167], v2, s[8:11], s31 offen offset:3072
buffer_load_dwordx4 v[168:171], v3, s[8:11], s31 offen
s_add_u32 s30, s30, 4096
s_add_u32 s31, s31, 5120
s_waitcnt vmcnt(32)
M 20,188,172
M 40,188,176
M 60,188,180
M 80,188,184
M 24,192,172
M 44,192,176
M 64,192,180
M 84,192,184
M 28,196,172
M 48,196,176
M 68,196,180
M 88,196,184
M 32,200,172
M 52,200,176
M 72,200,180
M 92,200,184
M 36,204,172
M 56,204,176
M 76,204,180
M 96,204,184
buffer_load_dwordx4 v[172:175], v2, s[8:11], s30 offen offset:0
buffer_load_dwordx4 v[176:179], v2, s[8:11], s30 offen offset:1024
buffer_load_dwordx4 v[180:183], v2, s[8:11], s30 offen offset:2048
buffer_load_dwordx4 v[184:187], v2, s[8:11], s30 offen offset:3072
buffer_load_dwordx4 v[188:191], v2, s[8:11], s31 offen offset:0
buffer_load_dwordx4 v[192:195], v2, s[8:11], s31 offen offset:1024
buffer_load_dwordx4 v[196:199], v2, s[8:11], s31 offen offset:2048
buffer_load_dwordx4 v[200:203], v2, s[8:11], s31 offen offset:3072
buffer_load_dwordx4 v[204:207], v3, s[8:11], s31 offen
s_add_u32 s30, s30, 4096
s_add_u32 s31, s31, 5120
s_waitcnt vmcnt(27)
M 20,224,208
M 40,224,212
M 60,224,216
M 80,224,220
M 24,228,208
M 44,228,212
M 64,228,216
M 84,228,220
M 28,232,208
M 48,232,212
M 68,232,216
M 88,232,220
M 32,236,208
M 52,236,212
M 72,236,216
M 92,236,220
M 36,240,208
M 56,240,212
M 76,240,216
M 96,240,220
buffer_load_dwordx4 v[208:211], v2, s[8:11], s30 offen offset:0
buffer_load_dwordx4 v[212:215], v2, s[8:11], s30 offen offset:1024
buffer_load_dwordx4 v[216:219], v2, s[8:11], s30 offen offset:2048
buffer_load_dwordx4 v[220:223], v2, s[8:11], s30 offen offset:3072
buffer_load_dwordx4 v[224:227], v2, s[8:11], s31 offen offset:0
buffer_load_dwordx4 v[228:231], v2, s[8:11], s31 offen offset:1024
buffer_load_dwordx4 v[232:235], v2, s[8:11], s31 offen offset:2048
buffer_load_dwordx4 v[236:239], v2, s[8:11], s31 offen offset:3072
buffer_load_dwordx4 v[240:243], v3, s[8:11], s31 offen
s_add_u32 s30, s30, 4096
s_add_u32 s31, s31, 5120
s_waitcnt vmcnt(27)
M 20,116,100
M 40,116,104
M 60,116,108
M 80,116,112
M 24,120,100
M 44,120,104
M 64,120,108
M 84,120,112
M 28,124,100
M 48,124,104
M 68,124,108
M 88,124,112
M 32,128,100
M 52,128,104
M 72,128,108
M 92,128,112
M 36,132,100
M 56,132,104
M 76,132,108
M 96,132,112
buffer_load_dwordx4 v[100:103], v2, s[8:11], s30 offen offset:0
buffer_load_dwordx4 v[104:107], v2, s[8:11], s30 offen offset:1024
buffer_load_dwordx4 v[108:111], v2, s[8:11], s30 offen offset:2048
buffer_load_dwordx4 v[112:115], v2, s[8:11], s30 offen offset:3072
buffer_load_dwordx4 v[116:119], v2, s[8:11], s31 offen offset:0
buffer_load_dwordx4 v[120:123], v2, s[8:11], s31 offen offset:1024
buffer_load_dwordx4 v[124:127], v2, s[8:11], s31 offen offset:2048
buffer_load_dwordx4 v[128:131], v2, s[8:11], s31 offen offset:3072
buffer_load_dwordx4 v[132:135], v3, s[8:11], s31 offen
s_add_u32 s30, s30, 4096
s_add_u32 s31, s31, 5120
s_waitcnt vmcnt(27)
M 20,152,136
M 40,152,140
M 60,152,144
M 80,152,148
M 24,156,136
M 44,156,140
M 64,156,144
M 84,156,148
M 28,160,136
M 48,160,140
M 68,160,144
M 88,160,148
M 32,164,136
M 52,164,140
M 72,164,144
M 92,164,148
M 36,168,136
M 56,168,140
M 76,168,144
M 96,168,148
buffer_load_dwordx4 v[136:139], v2, s[8:11], s30 offen offset:0
buffer_load_dwordx4 v[140:143], v2, s[8:11], s30 offen offset:1024
buffer_load_dwordx4 v[144:147], v2, s[8:11], s30 offen offset:2048
buffer_load_dwordx4 v[148:151], v2, s[8:11], s30 offen offset:3072
buffer_load_dwordx4 v[152:155], v2, s[8:11], s31 offen offset:0
buffer_load_dwordx4 v[156:159], v2, s[8:11], s31 offen offset:1024
buffer_load_dwordx4 v[160:163], v2, s[8:11], s31 offen offset:2048
buffer_load_dwordx4 v[164:167], v2, s[8:11], s31 offen offset:3072
buffer_load_dwordx4 v[168:171], v3, s[8:11], s31 offen
s_add_u32 s30, s30, 4096
s_add_u32 s31, s31, 5120
s_waitcnt vmcnt(27)
M 20,188,172
M 40,188,176
M 60,188,180
M 80,188,184
M 24,192,172
M 44,192,176
M 64,192,180
M 84,192,184
M 28,196,172
M 48,196,176
M 68,196,180
M 88,196,184
M 32,200,172
M 52,200,176
M 72,200,180
M 92,200,184
M 36,204,172
M 56,204,176
M 76,204,180
M 96,204,184
buffer_load_dwordx4 v[172:175], v2, s[8:11], s30 offen offset:0
buffer_load_dwordx4 v[176:179], v2, s[8:11], s30 offen offset:1024
buffer_load_dwordx4 v[180:183], v2, s[8:11], s30 offen offset:2048
buffer_load_dwordx4 v[184:187], v2, s[8:11], s30 offen offset:3072
buffer_load_dwordx4 v[188:191], v2, s[8:11], s31 offen offset:0
buffer_load_dwordx4 v[192:195], v2, s[8:11], s31 offen offset:1024
buffer_load_dwordx4 v[196:199], v2, s[8:11], s31 offen offset:2048
buffer_load_dwordx4 v[200:203], v2, s[8:11], s31 offen offset:3072
buffer_load_dwordx4 v[204:207], v3, s[8:11], s31 offen
s_add_u32 s30, s30, 4096
s_add_u32 s31, s31, 5120
s_waitcnt vmcnt(27)
M 20,224,208
M 40,224,212
M 60,224,216
M 80,224,220
M 24,228,208
M 44,228,212
M 64,228,216
M 84,228,220
M 28,232,208
M 48,232,212
M 68,232,216
M 88,232,220
M 32,236,208
M 52,236,212
M 72,236,216
M 92,236,220
M 36,240,208
M 56,240,212
M 76,240,216
M 96,240,220
buffer_load_dwordx4 v[208:211], v2, s[8:11], s30 offen offset:0
buffer_load_dwordx4 v[212:215], v2, s[8:11], s30 offen offset:1024
buffer_load_dwordx4 v[216:219], v2, s[8:11], s30 offen offset:2048
buffer_load_dwordx4 v[220:223], v2, s[8:11], s30 offen offset:3072
buffer_load_dwordx4 v[224:227], v2, s[8:11], s31 offen offset:0
buffer_load_dwordx4 v[228:231], v2, s[8:11], s31 offen offset:1024
buffer_load_dwordx4 v[232:235], v2, s[8:11], s31 offen offset:2048
buffer_load_dwordx4 v[236:239], v2, s[8:11], s31 offen offset:3072
buffer_load_dwordx4 v[240:243], v3, s[8:11], s31 offen
s_add_u32 s30, s30, 4096
s_add_u32 s31, s31, 5120
s_waitcnt vmcnt(27)
M 20,116,100
M 40,116,104
M 60,116,108
M 80,116,112
M 24,120,100
M 44,120,104
M 64,120,108
M 84,120,112
M 28,124,100
M 48,124,104
M 68,124,108
M 88,124,112
M 32,128,100
M 52,128,104
M 72,128,108
M 92,128,112
M 36,132,100
M 56,132,104
M 76,132,108
M 96,132,112
buffer_load_dwordx4 v[100:103], v2, s[8:11], s30 offen offset:0
buffer_load_dwordx4 v[104:107], v2, s[8:11], s30 offen offset:1024
buffer_load_dwordx4 v[108:111], v2, s[8:11], s30 offen offset:2048
buffer_load_dwordx4 v[112:115], v2, s[8:11], s30 offen offset:3072
buffer_load_dwordx4 v[116:119], v2, s[8:11], s31 offen offset:0
buffer_load_dwordx4 v[120:123], v2, s[8:11], s31 offen offset:1024
buffer_load_dwordx4 v[124:127], v2, s[8:11], s31 offen offset:2048
buffer_load_dwordx4 v[128:131], v2, s[8:11], s31 offen offset:3072
buffer_load_dwordx4 v[132:135], v3, s[8:11], s31 offen
s_add_u32 s30, s30, 4096
s_add_u32 s31, s31, 5120
s_waitcnt vmcnt(27)
M 20,152,136
M 40,152,140
M 60,152,144
M 80,152,148
M 24,156,136
M 44,156,140
M 64,156,144
M 84,156,148
M 28,160,136
M 48,160,140
M 68,160,144
M 88,160,148
M 32,164,136
M 52,164,140
M 72,164,144
M 92,164,148
M 36,168,136
M 56,168,140
M 76,168,144
M 96,168,148
buffer_load_dwordx4 v[136:139], v2, s[8:11], s30 offen offset:0
buffer_load_dwordx4 v[140:143], v2, s[8:11], s30 offen offset:1024
buffer_load_dwordx4 v[144:147], v2, s[8:11], s30 offen offset:2048
buffer_load_dwordx4 v[148:151], v2, s[8:11], s30 offen offset:3072
buffer_load_dwordx4 v[152:155], v2, s[8:11], s31 offen offset:0
buffer_load_dwordx4 v[156:159], v2, s[8:11], s31 offen offset:1024
buffer_load_dwordx4 v[160:163], v2, s[8:11], s31 offen offset:2048
buffer_load_dwordx4 v[164:167], v2, s[8:11], s31 offen offset:3072
buffer_load_dwordx4 v[168:171], v3, s[8:11], s31 offen
s_add_u32 s30, s30, 4096
s_add_u32 s31, s31, 5120
s_waitcnt vmcnt(27)
M 20,188,172
M 40,188,176
M 60,188,180
M 80,188,184
M 24,192,172
M 44,192,176
M 64,192,180
M 84,192,184
M 28,196,172
M 48,196,176
M 68,196,180
M 88,196,184
M 32,200,172
M 52,200,176
M 72,200,180
M 92,200,184
M 36,204,172
M 56,204,176
M 76,204,180
M 96,204,184
buffer_load_dwordx4 v[172:175], v2, s[8:11], s30 offen offset:0
buffer_load_dwordx4 v[176:179], v2, s[8:11], s30 offen offset:1024
buffer_load_dwordx4 v[180:183], v2, s[8:11], s30 offen offset:2048
buffer_load_dwordx4 v[184:187], v2, s[8:11], s30 offen offset:3072
buffer_load_dwordx4 v[188:191], v2, s[8:11], s31 offen offset:0
buffer_load_dwordx4 v[192:195], v2, s[8:11], s31 offen offset:1024
buffer_load_dwordx4 v[196:199], v2, s[8:11], s31 offen offset:2048
buffer_load_dwordx4 v[200:203], v2, s[8:11], s31 offen offset:3072
buffer_load_dwordx4 v[204:207], v3, s[8:11], s31 offen
s_add_u32 s30, s30, 4096
s_add_u32 s31, s31, 5120
s_waitcnt vmcnt(27)
M 20,224,208
M 40,224,212
M 60,224,216
M 80,224,220
M 24,228,208
M 44,228,212
M 64,228,216
M 84,228,220
M 28,232,208
M 48,232,212
M 68,232,216
M 88,232,220
M 32,236,208
M 52,236,212
M 72,236,216
M 92,236,220
M 36,240,208
M 56,240,212
M 76,240,216
M 96,240,220
buffer_load_dwordx4 v[208:211], v2, s[8:11], s30 offen offset:0
buffer_load_dwordx4 v[212:215], v2, s[8:11], s30 offen offset:1024
buffer_load_dwordx4 v[216:219], v2, s[8:11], s30 offen offset:2048
buffer_load_dwordx4 v[220:223], v2, s[8:11], s30 offen offset:3072
buffer_load_dwordx4 v[224:227], v2, s[8:11], s31 offen offset:0
buffer_load_dwordx4 v[228:231], v2, s[8:11], s31 offen offset:1024
buffer_load_dwordx4 v[232:235], v2, s[8:11], s31 offen offset:2048
buffer_load_dwordx4 v[236:239], v2, s[8:11], s31 offen offset:3072
buffer_load_dwordx4 v[240:243], v3, s[8:11], s31 offen
s_add_u32 s30, s30, 4096
s_add_u32 s31, s31, 5120
s_waitcnt vmcnt(27)
M 20,116,100
M 40,116,104
M 60,116,108
M 80,116,112
M 24,120,100
M 44,120,104
M 64,120,108
M 84,120,112
M 28,124,100
M 48,124,104
M 68,124,108
M 88,124,112
M 32,128,100
M 52,128,104
M 72,128,108
M 92,128,112
M 36,132,100
M 56,132,104
M 76,132,108
M 96,132,112
buffer_load_dwordx4 v[100:103], v2, s[8:11], s30 offen offset:0
buffer_load_dwordx4 v[104:107], v2, s[8:11], s30 offen offset:1024
buffer_load_dwordx4 v[108:111], v2, s[8:11], s30 offen offset:2048
buffer_load_dwordx4 v[112:115], v2, s[8:11], s30 offen offset:3072
buffer_load_dwordx4 v[116:119], v2, s[8:11], s31 offen offset:0
buffer_load_dwordx4 v[120:123], v2, s[8:11], s31 offen offset:1024
buffer_load_dwordx4 v[124:127], v2, s[8:11], s31 offen offset:2048
buffer_load_dwordx4 v[128:131], v2, s[8:11], s31 offen offset:3072
buffer_load_dwordx4 v[132:135], v3, s[8:11], s31 offen
s_add_u32 s30, s30, 4096
s_add_u32 s31, s31, 5120
s_waitcnt vmcnt(27)
M 20,152,136
M 40,152,140
M 60,152,144
M 80,152,148
M 24,156,136
M 44,156,140
M 64,156,144
M 84,156,148
M 28,160,136
M 48,160,140
M 68,160,144
M 88,160,148
M 32,164,136
M 52,164,140
M 72,164,144
M 92,164,148
M 36,168,136
M 56,168,140
M 76,168,144
M 96,168,148
buffer_load_dwordx4 v[136:139], v2, s[8:11], s30 offen offset:0
buffer_load_dwordx4 v[140:143], v2, s[8:11], s30 offen offset:1024
buffer_load_dwordx4 v[144:147], v2, s[8:11], s30 offen offset:2048
buffer_load_dwordx4 v[148:151], v2, s[8:11], s30 offen offset:3072
buffer_load_dwordx4 v[152:155], v2, s[8:11], s31 offen offset:0
buffer_load_dwordx4 v[156:159], v2, s[8:11], s31 offen offset:1024
buffer_load_dwordx4 v[160:163], v2, s[8:11], s31 offen offset:2048
buffer_load_dwordx4 v[164:167], v2, s[8:11], s31 offen offset:3072
buffer_load_dwordx4 v[168:171], v3, s[8:11], s31 offen
s_add_u32 s30, s30, 4096
s_add_u32 s31, s31, 5120
s_waitcnt vmcnt(27)
M 20,188,172
M 40,188,176
M 60,188,180
M 80,188,184
M 24,192,172
M 44,192,176
M 64,192,180
M 84,192,184
M 28,196,172
M 48,196,176
M 68,196,180
M 88,196,184
M 32,200,172
M 52,200,176
M 72,200,180
M 92,200,184
M 36,204,172
M 56,204,176
M 76,204,180
M 96,204,184
s_waitcnt vmcnt(18)
M 20,224,208
M 40,224,212
M 60,224,216
M 80,224,220
M 24,228,208
M 44,228,212
M 64,228,216
M 84,228,220
M 28,232,208
M 48,232,212
M 68,232,216
M 88,232,220
M 32,236,208
M 52,236,212
M 72,236,216
M 92,236,220
M 36,240,208
M 56,240,212
M 76,240,216
M 96,240,220
s_waitcnt vmcnt(9)
M 20,116,100
M 40,116,104
M 60,116,108
M 80,116,112
M 24,120,100
M 44,120,104
M 64,120,108
M 84,120,112
M 28,124,100
M 48,124,104
M 68,124,108
M 88,124,112
M 32,128,100
M 52,128,104
M 72,128,108
M 92,128,112
M 36,132,100
M 56,132,104
M 76,132,108
M 96,132,112
s_waitcnt vmcnt(0)
M 20,152,136
M 40,152,140
M 60,152,144
M 80,152,148
M 24,156,136
M 44,156,140
M 64,156,144
M 84,156,148
M 28,160,136
M 48,160,140
M 68,160,144
M 88,160,148
M 32,164,136
M 52,164,140
M 72,164,144
M 92,164,148
M 36,168,136
M 56,168,140
M 76,168,144
M 96,168,148
s_branch K2_RED
K2_S:
s_mul_i32 s28, s24, 20
s_lshl_b32 s30, s28, 12
s_add_u32 s30, s30, 7340032
s_mul_i32 s28, s25, 20
s_mul_i32 s31, s28, 5120
s_add_u32 s31, s31, 13631488
s_waitcnt lgkmcnt(0)
buffer_load_dwordx4 v[100:103], v2, s[8:11], s30 offen offset:0
buffer_load_dwordx4 v[104:107], v2, s[8:11], s30 offen offset:1024
buffer_load_dwordx4 v[108:111], v2, s[8:11], s30 offen offset:2048
buffer_load_dwordx4 v[112:115], v2, s[8:11], s30 offen offset:3072
buffer_load_dwordx4 v[116:119], v2, s[8:11], s31 offen offset:0
buffer_load_dwordx4 v[120:123], v2, s[8:11], s31 offen offset:1024
buffer_load_dwordx4 v[124:127], v2, s[8:11], s31 offen offset:2048
buffer_load_dwordx4 v[128:131], v2, s[8:11], s31 offen offset:3072
buffer_load_dwordx4 v[132:135], v3, s[8:11], s31 offen
s_add_u32 s30, s30, 4096
s_add_u32 s31, s31, 5120
buffer_load_dwordx4 v[136:139], v2, s[8:11], s30 offen offset:0
buffer_load_dwordx4 v[140:143], v2, s[8:11], s30 offen offset:1024
buffer_load_dwordx4 v[144:147], v2, s[8:11], s30 offen offset:2048
buffer_load_dwordx4 v[148:151], v2, s[8:11], s30 offen offset:3072
buffer_load_dwordx4 v[152:155], v2, s[8:11], s31 offen offset:0
buffer_load_dwordx4 v[156:159], v2, s[8:11], s31 offen offset:1024
buffer_load_dwordx4 v[160:163], v2, s[8:11], s31 offen offset:2048
buffer_load_dwordx4 v[164:167], v2, s[8:11], s31 offen offset:3072
buffer_load_dwordx4 v[168:171], v3, s[8:11], s31 offen
s_add_u32 s30, s30, 4096
s_add_u32 s31, s31, 5120
buffer_load_dwordx4 v[172:175], v2, s[8:11], s30 offen offset:0
buffer_load_dwordx4 v[176:179], v2, s[8:11], s30 offen offset:1024
buffer_load_dwordx4 v[180:183], v2, s[8:11], s30 offen offset:2048
buffer_load_dwordx4 v[184:187], v2, s[8:11], s30 offen offset:3072
buffer_load_dwordx4 v[188:191], v2, s[8:11], s31 offen offset:0
buffer_load_dwordx4 v[192:195], v2, s[8:11], s31 offen offset:1024
buffer_load_dwordx4 v[196:199], v2, s[8:11], s31 offen offset:2048
buffer_load_dwordx4 v[200:203], v2, s[8:11], s31 offen offset:3072
buffer_load_dwordx4 v[204:207], v3, s[8:11], s31 offen
s_add_u32 s30, s30, 4096
s_add_u32 s31, s31, 5120
buffer_load_dwordx2 v[8:9], v4, s[12:15], 0 offen offset:0
buffer_load_dwordx2 v[10:11], v4, s[12:15], 0 offen offset:32
buffer_load_dwordx2 v[12:13], v4, s[12:15], 0 offen offset:64
buffer_load_dwordx2 v[14:15], v4, s[12:15], 0 offen offset:96
buffer_load_dwordx2 v[16:17], v4, s[12:15], 0 offen offset:128
buffer_load_dwordx4 v[208:211], v2, s[8:11], s30 offen offset:0
buffer_load_dwordx4 v[212:215], v2, s[8:11], s30 offen offset:1024
buffer_load_dwordx4 v[216:219], v2, s[8:11], s30 offen offset:2048
buffer_load_dwordx4 v[220:223], v2, s[8:11], s30 offen offset:3072
buffer_load_dwordx4 v[224:227], v2, s[8:11], s31 offen offset:0
buffer_load_dwordx4 v[228:231], v2, s[8:11], s31 offen offset:1024
buffer_load_dwordx4 v[232:235], v2, s[8:11], s31 offen offset:2048
buffer_load_dwordx4 v[236:239], v2, s[8:11], s31 offen offset:3072
buffer_load_dwordx4 v[240:243], v3, s[8:11], s31 offen
s_add_u32 s30, s30, 4096
s_add_u32 s31, s31, 5120
s_waitcnt vmcnt(32)
MZ 20,116,100
MZ 40,116,104
MZ 60,116,108
MZ 80,116,112
MZ 24,120,100
MZ 44,120,104
MZ 64,120,108
MZ 84,120,112
MZ 28,124,100
MZ 48,124,104
MZ 68,124,108
MZ 88,124,112
MZ 32,128,100
MZ 52,128,104
MZ 72,128,108
MZ 92,128,112
MZ 36,132,100
MZ 56,132,104
MZ 76,132,108
MZ 96,132,112
buffer_load_dwordx4 v[100:103], v2, s[8:11], s30 offen offset:0
buffer_load_dwordx4 v[104:107], v2, s[8:11], s30 offen offset:1024
buffer_load_dwordx4 v[108:111], v2, s[8:11], s30 offen offset:2048
buffer_load_dwordx4 v[112:115], v2, s[8:11], s30 offen offset:3072
buffer_load_dwordx4 v[116:119], v2, s[8:11], s31 offen offset:0
buffer_load_dwordx4 v[120:123], v2, s[8:11], s31 offen offset:1024
buffer_load_dwordx4 v[124:127], v2, s[8:11], s31 offen offset:2048
buffer_load_dwordx4 v[128:131], v2, s[8:11], s31 offen offset:3072
buffer_load_dwordx4 v[132:135], v3, s[8:11], s31 offen
s_add_u32 s30, s30, 4096
s_add_u32 s31, s31, 5120
s_waitcnt vmcnt(32)
M 20,152,136
M 40,152,140
M 60,152,144
M 80,152,148
M 24,156,136
M 44,156,140
M 64,156,144
M 84,156,148
M 28,160,136
M 48,160,140
M 68,160,144
M 88,160,148
M 32,164,136
M 52,164,140
M 72,164,144
M 92,164,148
M 36,168,136
M 56,168,140
M 76,168,144
M 96,168,148
buffer_load_dwordx4 v[136:139], v2, s[8:11], s30 offen offset:0
buffer_load_dwordx4 v[140:143], v2, s[8:11], s30 offen offset:1024
buffer_load_dwordx4 v[144:147], v2, s[8:11], s30 offen offset:2048
buffer_load_dwordx4 v[148:151], v2, s[8:11], s30 offen offset:3072
buffer_load_dwordx4 v[152:155], v2, s[8:11], s31 offen offset:0
buffer_load_dwordx4 v[156:159], v2, s[8:11], s31 offen offset:1024
buffer_load_dwordx4 v[160:163], v2, s[8:11], s31 offen offset:2048
buffer_load_dwordx4 v[164:167], v2, s[8:11], s31 offen offset:3072
buffer_load_dwordx4 v[168:171], v3, s[8:11], s31 offen
s_add_u32 s30, s30, 4096
s_add_u32 s31, s31, 5120
s_waitcnt vmcnt(32)
M 20,188,172
M 40,188,176
M 60,188,180
M 80,188,184
M 24,192,172
M 44,192,176
M 64,192,180
M 84,192,184
M 28,196,172
M 48,196,176
M 68,196,180
M 88,196,184
M 32,200,172
M 52,200,176
M 72,200,180
M 92,200,184
M 36,204,172
M 56,204,176
M 76,204,180
M 96,204,184
buffer_load_dwordx4 v[172:175], v2, s[8:11], s30 offen offset:0
buffer_load_dwordx4 v[176:179], v2, s[8:11], s30 offen offset:1024
buffer_load_dwordx4 v[180:183], v2, s[8:11], s30 offen offset:2048
buffer_load_dwordx4 v[184:187], v2, s[8:11], s30 offen offset:3072
buffer_load_dwordx4 v[188:191], v2, s[8:11], s31 offen offset:0
buffer_load_dwordx4 v[192:195], v2, s[8:11], s31 offen offset:1024
buffer_load_dwordx4 v[196:199], v2, s[8:11], s31 offen offset:2048
buffer_load_dwordx4 v[200:203], v2, s[8:11], s31 offen offset:3072
buffer_load_dwordx4 v[204:207], v3, s[8:11], s31 offen
s_add_u32 s30, s30, 4096
s_add_u32 s31, s31, 5120
s_waitcnt vmcnt(27)
M 20,224,208
M 40,224,212
M 60,224,216
M 80,224,220
M 24,228,208
M 44,228,212
M 64,228,216
M 84,228,220
M 28,232,208
M 48,232,212
M 68,232,216
M 88,232,220
M 32,236,208
M 52,236,212
M 72,236,216
M 92,236,220
M 36,240,208
M 56,240,212
M 76,240,216
M 96,240,220
buffer_load_dwordx4 v[208:211], v2, s[8:11], s30 offen offset:0
buffer_load_dwordx4 v[212:215], v2, s[8:11], s30 offen offset:1024
buffer_load_dwordx4 v[216:219], v2, s[8:11], s30 offen offset:2048
buffer_load_dwordx4 v[220:223], v2, s[8:11], s30 offen offset:3072
buffer_load_dwordx4 v[224:227], v2, s[8:11], s31 offen offset:0
buffer_load_dwordx4 v[228:231], v2, s[8:11], s31 offen offset:1024
buffer_load_dwordx4 v[232:235], v2, s[8:11], s31 offen offset:2048
buffer_load_dwordx4 v[236:239], v2, s[8:11], s31 offen offset:3072
buffer_load_dwordx4 v[240:243], v3, s[8:11], s31 offen
s_add_u32 s30, s30, 4096
s_add_u32 s31, s31, 5120
s_waitcnt vmcnt(27)
M 20,116,100
M 40,116,104
M 60,116,108
M 80,116,112
M 24,120,100
M 44,120,104
M 64,120,108
M 84,120,112
M 28,124,100
M 48,124,104
M 68,124,108
M 88,124,112
M 32,128,100
M 52,128,104
M 72,128,108
M 92,128,112
M 36,132,100
M 56,132,104
M 76,132,108
M 96,132,112
buffer_load_dwordx4 v[100:103], v2, s[8:11], s30 offen offset:0
buffer_load_dwordx4 v[104:107], v2, s[8:11], s30 offen offset:1024
buffer_load_dwordx4 v[108:111], v2, s[8:11], s30 offen offset:2048
buffer_load_dwordx4 v[112:115], v2, s[8:11], s30 offen offset:3072
buffer_load_dwordx4 v[116:119], v2, s[8:11], s31 offen offset:0
buffer_load_dwordx4 v[120:123], v2, s[8:11], s31 offen offset:1024
buffer_load_dwordx4 v[124:127], v2, s[8:11], s31 offen offset:2048
buffer_load_dwordx4 v[128:131], v2, s[8:11], s31 offen offset:3072
buffer_load_dwordx4 v[132:135], v3, s[8:11], s31 offen
s_add_u32 s30, s30, 4096
s_add_u32 s31, s31, 5120
s_waitcnt vmcnt(27)
M 20,152,136
M 40,152,140
M 60,152,144
M 80,152,148
M 24,156,136
M 44,156,140
M 64,156,144
M 84,156,148
M 28,160,136
M 48,160,140
M 68,160,144
M 88,160,148
M 32,164,136
M 52,164,140
M 72,164,144
M 92,164,148
M 36,168,136
M 56,168,140
M 76,168,144
M 96,168,148
buffer_load_dwordx4 v[136:139], v2, s[8:11], s30 offen offset:0
buffer_load_dwordx4 v[140:143], v2, s[8:11], s30 offen offset:1024
buffer_load_dwordx4 v[144:147], v2, s[8:11], s30 offen offset:2048
buffer_load_dwordx4 v[148:151], v2, s[8:11], s30 offen offset:3072
buffer_load_dwordx4 v[152:155], v2, s[8:11], s31 offen offset:0
buffer_load_dwordx4 v[156:159], v2, s[8:11], s31 offen offset:1024
buffer_load_dwordx4 v[160:163], v2, s[8:11], s31 offen offset:2048
buffer_load_dwordx4 v[164:167], v2, s[8:11], s31 offen offset:3072
buffer_load_dwordx4 v[168:171], v3, s[8:11], s31 offen
s_add_u32 s30, s30, 4096
s_add_u32 s31, s31, 5120
s_waitcnt vmcnt(27)
M 20,188,172
M 40,188,176
M 60,188,180
M 80,188,184
M 24,192,172
M 44,192,176
M 64,192,180
M 84,192,184
M 28,196,172
M 48,196,176
M 68,196,180
M 88,196,184
M 32,200,172
M 52,200,176
M 72,200,180
M 92,200,184
M 36,204,172
M 56,204,176
M 76,204,180
M 96,204,184
buffer_load_dwordx4 v[172:175], v2, s[8:11], s30 offen offset:0
buffer_load_dwordx4 v[176:179], v2, s[8:11], s30 offen offset:1024
buffer_load_dwordx4 v[180:183], v2, s[8:11], s30 offen offset:2048
buffer_load_dwordx4 v[184:187], v2, s[8:11], s30 offen offset:3072
buffer_load_dwordx4 v[188:191], v2, s[8:11], s31 offen offset:0
buffer_load_dwordx4 v[192:195], v2, s[8:11], s31 offen offset:1024
buffer_load_dwordx4 v[196:199], v2, s[8:11], s31 offen offset:2048
buffer_load_dwordx4 v[200:203], v2, s[8:11], s31 offen offset:3072
buffer_load_dwordx4 v[204:207], v3, s[8:11], s31 offen
s_add_u32 s30, s30, 4096
s_add_u32 s31, s31, 5120
s_waitcnt vmcnt(27)
M 20,224,208
M 40,224,212
M 60,224,216
M 80,224,220
M 24,228,208
M 44,228,212
M 64,228,216
M 84,228,220
M 28,232,208
M 48,232,212
M 68,232,216
M 88,232,220
M 32,236,208
M 52,236,212
M 72,236,216
M 92,236,220
M 36,240,208
M 56,240,212
M 76,240,216
M 96,240,220
buffer_load_dwordx4 v[208:211], v2, s[8:11], s30 offen offset:0
buffer_load_dwordx4 v[212:215], v2, s[8:11], s30 offen offset:1024
buffer_load_dwordx4 v[216:219], v2, s[8:11], s30 offen offset:2048
buffer_load_dwordx4 v[220:223], v2, s[8:11], s30 offen offset:3072
buffer_load_dwordx4 v[224:227], v2, s[8:11], s31 offen offset:0
buffer_load_dwordx4 v[228:231], v2, s[8:11], s31 offen offset:1024
buffer_load_dwordx4 v[232:235], v2, s[8:11], s31 offen offset:2048
buffer_load_dwordx4 v[236:239], v2, s[8:11], s31 offen offset:3072
buffer_load_dwordx4 v[240:243], v3, s[8:11], s31 offen
s_add_u32 s30, s30, 4096
s_add_u32 s31, s31, 5120
s_waitcnt vmcnt(27)
M 20,116,100
M 40,116,104
M 60,116,108
M 80,116,112
M 24,120,100
M 44,120,104
M 64,120,108
M 84,120,112
M 28,124,100
M 48,124,104
M 68,124,108
M 88,124,112
M 32,128,100
M 52,128,104
M 72,128,108
M 92,128,112
M 36,132,100
M 56,132,104
M 76,132,108
M 96,132,112
buffer_load_dwordx4 v[100:103], v2, s[8:11], s30 offen offset:0
buffer_load_dwordx4 v[104:107], v2, s[8:11], s30 offen offset:1024
buffer_load_dwordx4 v[108:111], v2, s[8:11], s30 offen offset:2048
buffer_load_dwordx4 v[112:115], v2, s[8:11], s30 offen offset:3072
buffer_load_dwordx4 v[116:119], v2, s[8:11], s31 offen offset:0
buffer_load_dwordx4 v[120:123], v2, s[8:11], s31 offen offset:1024
buffer_load_dwordx4 v[124:127], v2, s[8:11], s31 offen offset:2048
buffer_load_dwordx4 v[128:131], v2, s[8:11], s31 offen offset:3072
buffer_load_dwordx4 v[132:135], v3, s[8:11], s31 offen
s_add_u32 s30, s30, 4096
s_add_u32 s31, s31, 5120
s_waitcnt vmcnt(27)
M 20,152,136
M 40,152,140
M 60,152,144
M 80,152,148
M 24,156,136
M 44,156,140
M 64,156,144
M 84,156,148
M 28,160,136
M 48,160,140
M 68,160,144
M 88,160,148
M 32,164,136
M 52,164,140
M 72,164,144
M 92,164,148
M 36,168,136
M 56,168,140
M 76,168,144
M 96,168,148
buffer_load_dwordx4 v[136:139], v2, s[8:11], s30 offen offset:0
buffer_load_dwordx4 v[140:143], v2, s[8:11], s30 offen offset:1024
buffer_load_dwordx4 v[144:147], v2, s[8:11], s30 offen offset:2048
buffer_load_dwordx4 v[148:151], v2, s[8:11], s30 offen offset:3072
buffer_load_dwordx4 v[152:155], v2, s[8:11], s31 offen offset:0
buffer_load_dwordx4 v[156:159], v2, s[8:11], s31 offen offset:1024
buffer_load_dwordx4 v[160:163], v2, s[8:11], s31 offen offset:2048
buffer_load_dwordx4 v[164:167], v2, s[8:11], s31 offen offset:3072
buffer_load_dwordx4 v[168:171], v3, s[8:11], s31 offen
s_add_u32 s30, s30, 4096
s_add_u32 s31, s31, 5120
s_waitcnt vmcnt(27)
M 20,188,172
M 40,188,176
M 60,188,180
M 80,188,184
M 24,192,172
M 44,192,176
M 64,192,180
M 84,192,184
M 28,196,172
M 48,196,176
M 68,196,180
M 88,196,184
M 32,200,172
M 52,200,176
M 72,200,180
M 92,200,184
M 36,204,172
M 56,204,176
M 76,204,180
M 96,204,184
buffer_load_dwordx4 v[172:175], v2, s[8:11], s30 offen offset:0
buffer_load_dwordx4 v[176:179], v2, s[8:11], s30 offen offset:1024
buffer_load_dwordx4 v[180:183], v2, s[8:11], s30 offen offset:2048
buffer_load_dwordx4 v[184:187], v2, s[8:11], s30 offen offset:3072
buffer_load_dwordx4 v[188:191], v2, s[8:11], s31 offen offset:0
buffer_load_dwordx4 v[192:195], v2, s[8:11], s31 offen offset:1024
buffer_load_dwordx4 v[196:199], v2, s[8:11], s31 offen offset:2048
buffer_load_dwordx4 v[200:203], v2, s[8:11], s31 offen offset:3072
buffer_load_dwordx4 v[204:207], v3, s[8:11], s31 offen
s_add_u32 s30, s30, 4096
s_add_u32 s31, s31, 5120
s_waitcnt vmcnt(27)
M 20,224,208
M 40,224,212
M 60,224,216
M 80,224,220
M 24,228,208
M 44,228,212
M 64,228,216
M 84,228,220
M 28,232,208
M 48,232,212
M 68,232,216
M 88,232,220
M 32,236,208
M 52,236,212
M 72,236,216
M 92,236,220
M 36,240,208
M 56,240,212
M 76,240,216
M 96,240,220
buffer_load_dwordx4 v[208:211], v2, s[8:11], s30 offen offset:0
buffer_load_dwordx4 v[212:215], v2, s[8:11], s30 offen offset:1024
buffer_load_dwordx4 v[216:219], v2, s[8:11], s30 offen offset:2048
buffer_load_dwordx4 v[220:223], v2, s[8:11], s30 offen offset:3072
buffer_load_dwordx4 v[224:227], v2, s[8:11], s31 offen offset:0
buffer_load_dwordx4 v[228:231], v2, s[8:11], s31 offen offset:1024
buffer_load_dwordx4 v[232:235], v2, s[8:11], s31 offen offset:2048
buffer_load_dwordx4 v[236:239], v2, s[8:11], s31 offen offset:3072
buffer_load_dwordx4 v[240:243], v3, s[8:11], s31 offen
s_add_u32 s30, s30, 4096
s_add_u32 s31, s31, 5120
s_waitcnt vmcnt(27)
M 20,116,100
M 40,116,104
M 60,116,108
M 80,116,112
M 24,120,100
M 44,120,104
M 64,120,108
M 84,120,112
M 28,124,100
M 48,124,104
M 68,124,108
M 88,124,112
M 32,128,100
M 52,128,104
M 72,128,108
M 92,128,112
M 36,132,100
M 56,132,104
M 76,132,108
M 96,132,112
buffer_load_dwordx4 v[100:103], v2, s[8:11], s30 offen offset:0
buffer_load_dwordx4 v[104:107], v2, s[8:11], s30 offen offset:1024
buffer_load_dwordx4 v[108:111], v2, s[8:11], s30 offen offset:2048
buffer_load_dwordx4 v[112:115], v2, s[8:11], s30 offen offset:3072
buffer_load_dwordx4 v[116:119], v2, s[8:11], s31 offen offset:0
buffer_load_dwordx4 v[120:123], v2, s[8:11], s31 offen offset:1024
buffer_load_dwordx4 v[124:127], v2, s[8:11], s31 offen offset:2048
buffer_load_dwordx4 v[128:131], v2, s[8:11], s31 offen offset:3072
buffer_load_dwordx4 v[132:135], v3, s[8:11], s31 offen
s_add_u32 s30, s30, 4096
s_add_u32 s31, s31, 5120
s_waitcnt vmcnt(27)
M 20,152,136
M 40,152,140
M 60,152,144
M 80,152,148
M 24,156,136
M 44,156,140
M 64,156,144
M 84,156,148
M 28,160,136
M 48,160,140
M 68,160,144
M 88,160,148
M 32,164,136
M 52,164,140
M 72,164,144
M 92,164,148
M 36,168,136
M 56,168,140
M 76,168,144
M 96,168,148
buffer_load_dwordx4 v[136:139], v2, s[8:11], s30 offen offset:0
buffer_load_dwordx4 v[140:143], v2, s[8:11], s30 offen offset:1024
buffer_load_dwordx4 v[144:147], v2, s[8:11], s30 offen offset:2048
buffer_load_dwordx4 v[148:151], v2, s[8:11], s30 offen offset:3072
buffer_load_dwordx4 v[152:155], v2, s[8:11], s31 offen offset:0
buffer_load_dwordx4 v[156:159], v2, s[8:11], s31 offen offset:1024
buffer_load_dwordx4 v[160:163], v2, s[8:11], s31 offen offset:2048
buffer_load_dwordx4 v[164:167], v2, s[8:11], s31 offen offset:3072
buffer_load_dwordx4 v[168:171], v3, s[8:11], s31 offen
s_add_u32 s30, s30, 4096
s_add_u32 s31, s31, 5120
s_waitcnt vmcnt(27)
M 20,188,172
M 40,188,176
M 60,188,180
M 80,188,184
M 24,192,172
M 44,192,176
M 64,192,180
M 84,192,184
M 28,196,172
M 48,196,176
M 68,196,180
M 88,196,184
M 32,200,172
M 52,200,176
M 72,200,180
M 92,200,184
M 36,204,172
M 56,204,176
M 76,204,180
M 96,204,184
buffer_load_dwordx4 v[172:175], v2, s[8:11], s30 offen offset:0
buffer_load_dwordx4 v[176:179], v2, s[8:11], s30 offen offset:1024
buffer_load_dwordx4 v[180:183], v2, s[8:11], s30 offen offset:2048
buffer_load_dwordx4 v[184:187], v2, s[8:11], s30 offen offset:3072
buffer_load_dwordx4 v[188:191], v2, s[8:11], s31 offen offset:0
buffer_load_dwordx4 v[192:195], v2, s[8:11], s31 offen offset:1024
buffer_load_dwordx4 v[196:199], v2, s[8:11], s31 offen offset:2048
buffer_load_dwordx4 v[200:203], v2, s[8:11], s31 offen offset:3072
buffer_load_dwordx4 v[204:207], v3, s[8:11], s31 offen
s_add_u32 s30, s30, 4096
s_add_u32 s31, s31, 5120
s_waitcnt vmcnt(27)
M 20,224,208
M 40,224,212
M 60,224,216
M 80,224,220
M 24,228,208
M 44,228,212
M 64,228,216
M 84,228,220
M 28,232,208
M 48,232,212
M 68,232,216
M 88,232,220
M 32,236,208
M 52,236,212
M 72,236,216
M 92,236,220
M 36,240,208
M 56,240,212
M 76,240,216
M 96,240,220
buffer_load_dwordx4 v[208:211], v2, s[8:11], s30 offen offset:0
buffer_load_dwordx4 v[212:215], v2, s[8:11], s30 offen offset:1024
buffer_load_dwordx4 v[216:219], v2, s[8:11], s30 offen offset:2048
buffer_load_dwordx4 v[220:223], v2, s[8:11], s30 offen offset:3072
buffer_load_dwordx4 v[224:227], v2, s[8:11], s31 offen offset:0
buffer_load_dwordx4 v[228:231], v2, s[8:11], s31 offen offset:1024
buffer_load_dwordx4 v[232:235], v2, s[8:11], s31 offen offset:2048
buffer_load_dwordx4 v[236:239], v2, s[8:11], s31 offen offset:3072
buffer_load_dwordx4 v[240:243], v3, s[8:11], s31 offen
s_add_u32 s30, s30, 4096
s_add_u32 s31, s31, 5120
s_waitcnt vmcnt(27)
M 20,116,100
M 40,116,104
M 60,116,108
M 80,116,112
M 24,120,100
M 44,120,104
M 64,120,108
M 84,120,112
M 28,124,100
M 48,124,104
M 68,124,108
M 88,124,112
M 32,128,100
M 52,128,104
M 72,128,108
M 92,128,112
M 36,132,100
M 56,132,104
M 76,132,108
M 96,132,112
s_waitcnt vmcnt(18)
M 20,152,136
M 40,152,140
M 60,152,144
M 80,152,148
M 24,156,136
M 44,156,140
M 64,156,144
M 84,156,148
M 28,160,136
M 48,160,140
M 68,160,144
M 88,160,148
M 32,164,136
M 52,164,140
M 72,164,144
M 92,164,148
M 36,168,136
M 56,168,140
M 76,168,144
M 96,168,148
s_waitcnt vmcnt(9)
M 20,188,172
M 40,188,176
M 60,188,180
M 80,188,184
M 24,192,172
M 44,192,176
M 64,192,180
M 84,192,184
M 28,196,172
M 48,196,176
M 68,196,180
M 88,196,184
M 32,200,172
M 52,200,176
M 72,200,180
M 92,200,184
M 36,204,172
M 56,204,176
M 76,204,180
M 96,204,184
s_waitcnt vmcnt(0)
M 20,224,208
M 40,224,212
M 60,224,216
M 80,224,220
M 24,228,208
M 44,228,212
M 64,228,216
M 84,228,220
M 28,232,208
M 48,232,212
M 68,232,216
M 88,232,220
M 32,236,208
M 52,236,212
M 72,236,216
M 92,236,220
M 36,240,208
M 56,240,212
M 76,240,216
M 96,240,220
K2_RED:
s_mul_i32 s28, s26, 20480
v_add_u32 v5, s28, v2
s_nop 7
s_cmp_eq_u32 s26, 0
s_cbranch_scc1 KW36
ds_write_b128 v5, v[20:23] offset:0
ds_write_b128 v5, v[24:27] offset:1024
ds_write_b128 v5, v[28:31] offset:2048
ds_write_b128 v5, v[32:35] offset:3072
ds_write_b128 v5, v[36:39] offset:4096
KW36:
s_cmp_eq_u32 s26, 1
s_cbranch_scc1 KW37
ds_write_b128 v5, v[40:43] offset:5120
ds_write_b128 v5, v[44:47] offset:6144
ds_write_b128 v5, v[48:51] offset:7168
ds_write_b128 v5, v[52:55] offset:8192
ds_write_b128 v5, v[56:59] offset:9216
KW37:
s_cmp_eq_u32 s26, 2
s_cbranch_scc1 KW38
ds_write_b128 v5, v[60:63] offset:10240
ds_write_b128 v5, v[64:67] offset:11264
ds_write_b128 v5, v[68:71] offset:12288
ds_write_b128 v5, v[72:75] offset:13312
ds_write_b128 v5, v[76:79] offset:14336
KW38:
s_cmp_eq_u32 s26, 3
s_cbranch_scc1 KW39
ds_write_b128 v5, v[80:83] offset:15360
ds_write_b128 v5, v[84:87] offset:16384
ds_write_b128 v5, v[88:91] offset:17408
ds_write_b128 v5, v[92:95] offset:18432
ds_write_b128 v5, v[96:99] offset:19456
KW39:
s_mul_i32 s28, s26, 5120
v_add_u32 v6, s28, v2
v_mov_b32 v18, 1.0
v_mov_b32 v19, 1.0
s_mov_b32 s28, 0xbfb8aa3b
v_mov_b32 v7, s28
s_waitcnt lgkmcnt(0)
s_barrier
s_add_u32 s29, s26, 1
s_and_b32 s29, s29, 3
s_mul_i32 s29, s29, 20480
v_add_u32 v161, s29, v6
s_add_u32 s29, s26, 2
s_and_b32 s29, s29, 3
s_mul_i32 s29, s29, 20480
v_add_u32 v162, s29, v6
s_add_u32 s29, s26, 3
s_and_b32 s29, s29, 3
s_mul_i32 s29, s29, 20480
v_add_u32 v163, s29, v6
ds_read_b128 v[100:103], v161 offset:0
ds_read_b128 v[104:107], v161 offset:1024
ds_read_b128 v[108:111], v161 offset:2048
ds_read_b128 v[112:115], v161 offset:3072
ds_read_b128 v[116:119], v161 offset:4096
ds_read_b128 v[120:123], v162 offset:0
ds_read_b128 v[124:127], v162 offset:1024
ds_read_b128 v[128:131], v162 offset:2048
ds_read_b128 v[132:135], v162 offset:3072
ds_read_b128 v[136:139], v162 offset:4096
ds_read_b128 v[140:143], v163 offset:0
ds_read_b128 v[144:147], v163 offset:1024
ds_read_b128 v[148:151], v163 offset:2048
ds_read_b128 v[152:155], v163 offset:3072
ds_read_b128 v[156:159], v163 offset:4096
s_cmp_lg_u32 s26, 0
s_cbranch_scc1 KR40
s_waitcnt lgkmcnt(0)
PA 180,100,120
PA 180,180,140
PA 182,102,122
PA 182,182,142
PA 184,104,124
PA 184,184,144
PA 186,106,126
PA 186,186,146
PA 188,108,128
PA 188,188,148
PA 190,110,130
PA 190,190,150
PA 192,112,132
PA 192,192,152
PA 194,114,134
PA 194,194,154
PA 196,116,136
PA 196,196,156
PA 198,118,138
PA 198,198,158
v_mov_b32 v160, v20
v_mov_b32 v161, v21
v_mov_b32 v162, v22
v_mov_b32 v163, v23
v_mov_b32 v164, v24
v_mov_b32 v165, v25
v_mov_b32 v166, v26
v_mov_b32 v167, v27
v_mov_b32 v168, v28
v_mov_b32 v169, v29
v_mov_b32 v170, v30
v_mov_b32 v171, v31
v_mov_b32 v172, v32
v_mov_b32 v173, v33
v_mov_b32 v174, v34
v_mov_b32 v175, v35
v_mov_b32 v176, v36
v_mov_b32 v177, v37
v_mov_b32 v178, v38
v_mov_b32 v179, v39
s_branch K2_FIN
KR40:
s_cmp_lg_u32 s26, 1
s_cbranch_scc1 KR41
s_waitcnt lgkmcnt(0)
PA 180,40,100
PA 180,180,120
PA 182,42,102
PA 182,182,122
PA 184,44,104
PA 184,184,124
PA 186,46,106
PA 186,186,126
PA 188,48,108
PA 188,188,128
PA 190,50,110
PA 190,190,130
PA 192,52,112
PA 192,192,132
PA 194,54,114
PA 194,194,134
PA 196,56,116
PA 196,196,136
PA 198,58,118
PA 198,198,138
v_mov_b32 v160, v140
v_mov_b32 v161, v141
v_mov_b32 v162, v142
v_mov_b32 v163, v143
v_mov_b32 v164, v144
v_mov_b32 v165, v145
v_mov_b32 v166, v146
v_mov_b32 v167, v147
v_mov_b32 v168, v148
v_mov_b32 v169, v149
v_mov_b32 v170, v150
v_mov_b32 v171, v151
v_mov_b32 v172, v152
v_mov_b32 v173, v153
v_mov_b32 v174, v154
v_mov_b32 v175, v155
v_mov_b32 v176, v156
v_mov_b32 v177, v157
v_mov_b32 v178, v158
v_mov_b32 v179, v159
s_branch K2_FIN
KR41:
s_cmp_lg_u32 s26, 2
s_cbranch_scc1 KR42
s_waitcnt lgkmcnt(0)
PA 180,140,60
PA 180,180,100
PA 182,142,62
PA 182,182,102
PA 184,144,64
PA 184,184,104
PA 186,146,66
PA 186,186,106
PA 188,148,68
PA 188,188,108
PA 190,150,70
PA 190,190,110
PA 192,152,72
PA 192,192,112
PA 194,154,74
PA 194,194,114
PA 196,156,76
PA 196,196,116
PA 198,158,78
PA 198,198,118
v_mov_b32 v160, v120
v_mov_b32 v161, v121
v_mov_b32 v162, v122
v_mov_b32 v163, v123
v_mov_b32 v164, v124
v_mov_b32 v165, v125
v_mov_b32 v166, v126
v_mov_b32 v167, v127
v_mov_b32 v168, v128
v_mov_b32 v169, v129
v_mov_b32 v170, v130
v_mov_b32 v171, v131
v_mov_b32 v172, v132
v_mov_b32 v173, v133
v_mov_b32 v174, v134
v_mov_b32 v175, v135
v_mov_b32 v176, v136
v_mov_b32 v177, v137
v_mov_b32 v178, v138
v_mov_b32 v179, v139
s_branch K2_FIN
KR42:
s_cmp_lg_u32 s26, 3
s_cbranch_scc1 KR43
s_waitcnt lgkmcnt(0)
PA 180,120,140
PA 180,180,80
PA 182,122,142
PA 182,182,82
PA 184,124,144
PA 184,184,84
PA 186,126,146
PA 186,186,86
PA 188,128,148
PA 188,188,88
PA 190,130,150
PA 190,190,90
PA 192,132,152
PA 192,192,92
PA 194,134,154
PA 194,194,94
PA 196,136,156
PA 196,196,96
PA 198,138,158
PA 198,198,98
v_mov_b32 v160, v100
v_mov_b32 v161, v101
v_mov_b32 v162, v102
v_mov_b32 v163, v103
v_mov_b32 v164, v104
v_mov_b32 v165, v105
v_mov_b32 v166, v106
v_mov_b32 v167, v107
v_mov_b32 v168, v108
v_mov_b32 v169, v109
v_mov_b32 v170, v110
v_mov_b32 v171, v111
v_mov_b32 v172, v112
v_mov_b32 v173, v113
v_mov_b32 v174, v114
v_mov_b32 v175, v115
v_mov_b32 v176, v116
v_mov_b32 v177, v117
v_mov_b32 v178, v118
v_mov_b32 v179, v119
s_branch K2_FIN
KR43:
K2_FIN:
v_pk_mul_f32 v[100:101], v[6:7], v[180:181] op_sel:[1,0] op_sel_hi:[1,1]
v_pk_mul_f32 v[102:103], v[6:7], v[182:183] op_sel:[1,0] op_sel_hi:[1,1]
v_pk_mul_f32 v[104:105], v[6:7], v[184:185] op_sel:[1,0] op_sel_hi:[1,1]
v_pk_mul_f32 v[106:107], v[6:7], v[186:187] op_sel:[1,0] op_sel_hi:[1,1]
v_pk_mul_f32 v[108:109], v[6:7], v[188:189] op_sel:[1,0] op_sel_hi:[1,1]
v_pk_mul_f32 v[110:111], v[6:7], v[190:191] op_sel:[1,0] op_sel_hi:[1,1]
v_pk_mul_f32 v[112:113], v[6:7], v[192:193] op_sel:[1,0] op_sel_hi:[1,1]
v_pk_mul_f32 v[114:115], v[6:7], v[194:195] op_sel:[1,0] op_sel_hi:[1,1]
v_pk_mul_f32 v[116:117], v[6:7], v[196:197] op_sel:[1,0] op_sel_hi:[1,1]
v_pk_mul_f32 v[118:119], v[6:7], v[198:199] op_sel:[1,0] op_sel_hi:[1,1]
v_exp_f32 v100, v100
v_exp_f32 v101, v101
v_exp_f32 v102, v102
v_exp_f32 v103, v103
v_exp_f32 v104, v104
v_exp_f32 v105, v105
v_exp_f32 v106, v106
v_exp_f32 v107, v107
v_exp_f32 v108, v108
v_exp_f32 v109, v109
v_exp_f32 v110, v110
v_exp_f32 v111, v111
v_exp_f32 v112, v112
v_exp_f32 v113, v113
v_exp_f32 v114, v114
v_exp_f32 v115, v115
v_exp_f32 v116, v116
v_exp_f32 v117, v117
v_exp_f32 v118, v118
v_exp_f32 v119, v119
s_nop 0
PA 100,100,18
PA 102,102,18
PA 104,104,18
PA 106,106,18
PA 108,108,18
PA 110,110,18
PA 112,112,18
PA 114,114,18
PA 116,116,18
PA 118,118,18
v_rcp_f32 v100, v100
v_rcp_f32 v101, v101
v_rcp_f32 v102, v102
v_rcp_f32 v103, v103
v_rcp_f32 v104, v104
v_rcp_f32 v105, v105
v_rcp_f32 v106, v106
v_rcp_f32 v107, v107
v_rcp_f32 v108, v108
v_rcp_f32 v109, v109
v_rcp_f32 v110, v110
v_rcp_f32 v111, v111
v_rcp_f32 v112, v112
v_rcp_f32 v113, v113
v_rcp_f32 v114, v114
v_rcp_f32 v115, v115
v_rcp_f32 v116, v116
v_rcp_f32 v117, v117
v_rcp_f32 v118, v118
v_rcp_f32 v119, v119
s_nop 0
PM 180,180,100
PM 182,182,102
PM 184,184,104
PM 186,186,106
PM 188,188,108
PM 190,190,110
PM 192,192,112
PM 194,194,114
PM 196,196,116
PM 198,198,118
PM 180,180,160
PM 182,182,162
PM 184,184,164
PM 186,186,166
PM 188,188,168
PM 190,190,170
PM 192,192,172
PM 194,194,174
PM 196,196,176
PM 198,198,178
v_lshlrev_b32 v100, 16, v8
v_and_b32 v101, 0xffff0000, v8
v_lshlrev_b32 v102, 16, v9
v_and_b32 v103, 0xffff0000, v9
v_lshlrev_b32 v104, 16, v10
v_and_b32 v105, 0xffff0000, v10
v_lshlrev_b32 v106, 16, v11
v_and_b32 v107, 0xffff0000, v11
v_lshlrev_b32 v108, 16, v12
v_and_b32 v109, 0xffff0000, v12
v_lshlrev_b32 v110, 16, v13
v_and_b32 v111, 0xffff0000, v13
v_lshlrev_b32 v112, 16, v14
v_and_b32 v113, 0xffff0000, v14
v_lshlrev_b32 v114, 16, v15
v_and_b32 v115, 0xffff0000, v15
v_lshlrev_b32 v116, 16, v16
v_and_b32 v117, 0xffff0000, v16
v_lshlrev_b32 v118, 16, v17
v_and_b32 v119, 0xffff0000, v17
PA 100,100,180
PA 102,102,182
PA 104,104,184
PA 106,106,186
PA 108,108,188
PA 110,110,190
PA 112,112,192
PA 114,114,194
PA 116,116,196
PA 118,118,198
CV 100,100,101
CV 101,102,103
buffer_store_dwordx2 v[100:101], v4, s[16:19], 0 offen offset:0
CV 104,104,105
CV 105,106,107
buffer_store_dwordx2 v[104:105], v4, s[16:19], 0 offen offset:32
CV 108,108,109
CV 109,110,111
buffer_store_dwordx2 v[108:109], v4, s[16:19], 0 offen offset:64
CV 112,112,113
CV 113,114,115
buffer_store_dwordx2 v[112:113], v4, s[16:19], 0 offen offset:96
CV 116,116,117
CV 117,118,119
buffer_store_dwordx2 v[116:117], v4, s[16:19], 0 offen offset:128
K2_EXIT:
s_endpgm
.section .rodata,"a"
.p2align 6
.amdhsa_kernel k1_proj_kernel
  .amdhsa_next_free_vgpr 256
  .amdhsa_next_free_sgpr 96
  .amdhsa_accum_offset 256
  .amdhsa_group_segment_fixed_size 0
  .amdhsa_kernarg_size 72
  .amdhsa_user_sgpr_count 2
  .amdhsa_user_sgpr_kernarg_segment_ptr 1
  .amdhsa_system_sgpr_workgroup_id_x 1
.end_amdhsa_kernel
.p2align 6
.amdhsa_kernel k2_out_kernel
  .amdhsa_next_free_vgpr 256
  .amdhsa_next_free_sgpr 96
  .amdhsa_accum_offset 256
  .amdhsa_group_segment_fixed_size 0
  .amdhsa_kernarg_size 72
  .amdhsa_user_sgpr_count 2
  .amdhsa_user_sgpr_kernarg_segment_ptr 1
  .amdhsa_system_sgpr_workgroup_id_x 1
.end_amdhsa_kernel
```
